```python
import torch

def _softmax(x, axis=-1):
    return torch.softmax(x, dim=axis)
def _gelu(x):
    return torch.nn.functional.gelu(x, approximate="tanh")
def _silu(x):
    return torch.nn.functional.silu(x)
def _sigmoid(x):
    return torch.sigmoid(x)
def _layernorm(x, axis=-1, eps=1e-5):
    m = x.mean(dim=axis, keepdim=True)
    v = x.var(dim=axis, keepdim=True, unbiased=False)
    return (x - m) / torch.sqrt(v + eps)
def _scatter_add(tgt, idx, src, axis=0):
    return tgt.clone().index_add_(axis, idx, src)
def _segment_sum(src, seg, n):
    out = torch.zeros((n,) + src.shape[1:], dtype=src.dtype)
    return out.index_add_(0, seg, src)
def _pad(x, pw):
    flat = tuple(v for pair in reversed(pw) for v in pair)
    return torch.nn.functional.pad(x, flat)

kernel_name = 'concat_heads__gqa_block_cached__gqa_block_cached__near_ridge'

def setup_inputs():

    _w = (lambda a: (lambda t: t.to(torch.bfloat16) if t.is_floating_point() else t)(torch.as_tensor(a)))
    def _A_setup():
        B, Sq, D = 16, 64, 640
        Hq, Hkv, Sk, Dh = 32, 32, 512, 192
        assert Hq % Hkv == 0, (Hq, Hkv)
        return {
            "x": _w((lambda *s: torch.randn(*s, dtype=torch.bfloat16) * 0.8)(B, Sq, D)),
            "k_cache": _w((lambda *s: torch.randn(*s, dtype=torch.bfloat16) * 0.8)(B, Hkv, Sk, Dh)),
            "v_cache": _w((lambda *s: torch.randn(*s, dtype=torch.bfloat16) * 0.05)(B, Hkv, Sk, Dh)),
            "wq": _w((lambda *s: torch.randn(*s, dtype=torch.bfloat16) * 0.8)(D, Hq * Dh) * (D ** -0.5)),
            "wo": _w((lambda *s: torch.randn(*s, dtype=torch.bfloat16) * 0.05)(Hq * Dh, D) * ((Hq * Dh) ** -0.5)),
        }
    _A_in = _A_setup()

    def _B_setup():
        B, Sq, D = 16, 64, 640
        Hq, Hkv, Sk, Dh = 32, 32, 512, 192
        assert Hq % Hkv == 0, (Hq, Hkv)
        return {
            "x": _w((lambda *s: torch.randn(*s, dtype=torch.bfloat16) * 0.8)(B, Sq, D)),
            "k_cache": _w((lambda *s: torch.randn(*s, dtype=torch.bfloat16) * 0.8)(B, Hkv, Sk, Dh)),
            "v_cache": _w((lambda *s: torch.randn(*s, dtype=torch.bfloat16) * 0.05)(B, Hkv, Sk, Dh)),
            "wq": _w((lambda *s: torch.randn(*s, dtype=torch.bfloat16) * 0.8)(D, Hq * Dh) * (D ** -0.5)),
            "wo": _w((lambda *s: torch.randn(*s, dtype=torch.bfloat16) * 0.05)(Hq * Dh, D) * ((Hq * Dh) ** -0.5)),
        }
    _B_in = _B_setup()

    return {
        "A_x": _A_in["x"],
        "A_k_cache": _A_in["k_cache"],
        "A_v_cache": _A_in["v_cache"],
        "A_wq": _A_in["wq"],
        "A_wo": _A_in["wo"],
        "B_x": _B_in["x"],
        "B_k_cache": _B_in["k_cache"],
        "B_v_cache": _B_in["v_cache"],
        "B_wq": _B_in["wq"],
        "B_wo": _B_in["wo"],
    }

def reference(A_x, A_k_cache, A_v_cache, A_wq, A_wo, B_x, B_k_cache, B_v_cache, B_wq, B_wo):
    def _A_ref(x, k_cache, v_cache, wq, wo):
        B, Sq, D = x.shape
        Hq, Dh = 32, 192
        Hkv = k_cache.shape[1]
        rep = Hq // Hkv
        q = (lambda x, *d: x.permute(*d))((x @ wq).reshape(B, Sq, Hq, Dh), 0, 2, 1, 3)
        k = (lambda x, n, axis: torch.repeat_interleave(x, n, dim=axis))(k_cache, rep, axis=1)
        v = (lambda x, n, axis: torch.repeat_interleave(x, n, dim=axis))(v_cache, rep, axis=1)
        scores = torch.einsum("bhqd,bhkd->bhqk", q, k) * (Dh ** -0.5)
        p = _softmax(scores, axis=-1)
        o = torch.einsum("bhqk,bhkd->bhqd", p, v)
        return (lambda x, *d: x.permute(*d))(o, 0, 2, 1, 3).reshape(B, Sq, Hq * Dh) @ wo

    def _B_ref(x, k_cache, v_cache, wq, wo):
        B, Sq, D = x.shape
        Hq, Dh = 32, 192
        Hkv = k_cache.shape[1]
        rep = Hq // Hkv
        q = (lambda x, *d: x.permute(*d))((x @ wq).reshape(B, Sq, Hq, Dh), 0, 2, 1, 3)
        k = (lambda x, n, axis: torch.repeat_interleave(x, n, dim=axis))(k_cache, rep, axis=1)
        v = (lambda x, n, axis: torch.repeat_interleave(x, n, dim=axis))(v_cache, rep, axis=1)
        scores = torch.einsum("bhqd,bhkd->bhqk", q, k) * (Dh ** -0.5)
        p = _softmax(scores, axis=-1)
        o = torch.einsum("bhqk,bhkd->bhqd", p, v)
        return (lambda x, *d: x.permute(*d))(o, 0, 2, 1, 3).reshape(B, Sq, Hq * Dh) @ wo

    a = _A_ref(A_x, A_k_cache, A_v_cache, A_wq, A_wo)
    b = _B_ref(B_x, B_k_cache, B_v_cache, B_wq, B_wo)
    return torch.concatenate([a, b], axis=-1)
```

```asm
; @launch grid=(256,1,1) block=(512,1,1) lds=163840
.amdgcn_target "amdgcn-amd-amdhsa--gfx950"
.text
.globl concat_heads__gqa_block_cached__gqa_block_cached__near_ridge_kernel
.p2align 8
.type concat_heads__gqa_block_cached__gqa_block_cached__near_ridge_kernel,@function
concat_heads__gqa_block_cached__gqa_block_cached__near_ridge_kernel:
    s_cmp_ge_u32 s2, 256
    s_cbranch_scc1 L_end
    s_load_dwordx2 s[34:35], s[0:1], 96
    s_load_dwordx4 s[64:67], s[0:1], 80
    s_and_b32 s3, s2, 7
    s_lshr_b32 s5, s3, 2
    s_mul_i32 s32, s5, 40
    s_add_u32 s0, s0, s32
    s_addc_u32 s1, s1, 0
    s_load_dwordx4 s[44:47], s[0:1], 24
    s_load_dwordx2 s[36:37], s[0:1], 0
    s_load_dwordx4 s[40:43], s[0:1], 8
    v_lshrrev_b32 v1, 6, v0
    v_and_b32 v0, 63, v0
    v_readfirstlane_b32 s32, v1
    s_lshr_b32 s4, s2, 3
    s_and_b32 s7, s4, 15
    s_lshr_b32 s4, s4, 4
    s_and_b32 s6, s3, 3
    s_lshl_b32 s6, s6, 1
    s_add_u32 s6, s6, s4
    s_lshl_b32 s57, s32, 4
    v_add_u32 v2, s57, v0
    v_mul_u32_u24 v3, 21846, v2
    v_mul_u32_u24 v6, 1280, v0
    v_lshrrev_b32 v3, 16, v3
    v_mul_u32_u24 v7, 65536, v0
    v_mul_u32_u24 v4, 3, v3
    v_mul_u32_u24 v3, 12288, v3
    v_sub_u32 v4, v2, v4
    s_mul_i32 s48, s7, 491520
    v_lshl_add_u32 v3, v4, 7, v3
    s_mul_i32 s57, s6, 1536
    s_add_u32 s48, s48, s57
    s_cmp_eq_u32 s32, 7
    s_cselect_b32 s49, 8, 16
    s_bfm_b32 s49, s49, 0
    s_mul_i32 s50, s7, 81920
    s_lshl_b32 s51, s7, 3
    s_add_u32 s51, s51, s6
    s_mul_i32 s51, s51, 786432
    s_cmp_eq_u32 s32, 0
    s_cselect_b32 s50, s50, 1073741824
    s_cmp_eq_u32 s32, 1
    s_cselect_b32 s52, s51, 1073741824
    s_cmp_eq_u32 s32, 2
    s_cselect_b32 s53, s51, 1073741824
    s_mov_b32 exec_hi, 0
    s_mov_b32 exec_lo, s49
    s_waitcnt lgkmcnt(0)
    s_mov_b32 s16, s44
    s_and_b32 s17, s45, 0xffff
    s_mov_b32 s18, 7864320
    s_mov_b32 s19, 0x20000
    buffer_load_dword v255, v3, s[16:19], s48 offen
    s_mov_b64 exec, -1
    s_mov_b32 s24, s36
    s_and_b32 s25, s37, 0xffff
    s_mov_b32 s26, 1310720
    s_mov_b32 s27, 0x20000
    buffer_load_dword v255, v6, s[24:27], s50 offen
    s_mov_b64 exec, 4095
    s_mov_b32 s8, s40
    s_and_b32 s9, s41, 0xffff
    s_mov_b32 s10, 100663296
    s_mov_b32 s11, 0x20000
    buffer_load_dword v255, v7, s[8:11], s52 offen nt
    s_mov_b32 s12, s42
    s_and_b32 s13, s43, 0xffff
    s_mov_b32 s14, 100663296
    s_mov_b32 s15, 0x20000
    buffer_load_dword v255, v7, s[12:15], s53 offen nt
    s_mov_b64 exec, -1
    s_mov_b32 s20, s46
    s_and_b32 s21, s47, 0xffff
    s_mov_b32 s22, 7864320
    s_mov_b32 s23, 0x20000
    s_mov_b32 s28, s34
    s_and_b32 s29, s35, 0xffff
    s_mov_b32 s30, 67108864
    s_mov_b32 s31, 0x20000
    s_mov_b32 s36, s66
    s_and_b32 s37, s67, 0xffff
    s_mov_b32 s38, 256
    s_mov_b32 s39, 0x20000
    s_and_b32 s65, s65, 0xffff
    s_mov_b32 s66, 2621440
    s_mov_b32 s67, 0x20000
    s_and_b32 s33, s32, 3
    s_cmp_lt_u32 s32, 4
    s_cbranch_scc1 L_P
    s_and_b32 s57, s33, 1
    s_lshl_b32 s57, s57, 2
    v_add_u32 v32, 0, v0
    v_add_u32 v36, 64, v0
    v_add_u32 v40, 128, v0
    v_lshrrev_b32 v44, 3, v0
    v_mul_u32_u24 v35, 2731, v32
    v_mul_u32_u24 v39, 2731, v36
    v_mul_u32_u24 v43, 2731, v40
    v_and_b32 v44, 6, v44
    v_lshrrev_b32 v33, 16, v35
    v_lshrrev_b32 v37, 16, v39
    v_lshrrev_b32 v41, 16, v43
    v_and_b32 v45, 7, v0
    v_mul_u32_u24 v35, 24, v33
    v_mul_u32_u24 v39, 24, v37
    v_mul_u32_u24 v43, 24, v41
    v_xor_b32 v44, v44, v45
    v_sub_u32 v34, v32, v35
    v_sub_u32 v38, v36, v39
    v_sub_u32 v42, v40, v43
    v_lshrrev_b32 v45, 3, v0
    v_and_or_b32 v35, v33, 2, s57
    v_and_or_b32 v39, v37, 2, s57
    v_and_or_b32 v43, v41, 2, s57
    v_mul_u32_u24 v45, 1280, v45
    v_xor_b32 v34, v34, v35
    v_xor_b32 v38, v38, v39
    v_xor_b32 v42, v42, v43
    v_lshl_add_u32 v131, v44, 4, v45
    v_mul_u32_u24 v33, 12288, v33
    v_mul_u32_u24 v37, 12288, v37
    v_mul_u32_u24 v41, 12288, v41
    v_lshl_add_u32 v33, v34, 4, v33
    v_lshl_add_u32 v37, v38, 4, v37
    v_lshl_add_u32 v41, v42, 4, v41
    v_subrev_u32 v128, 0, v33
    v_subrev_u32 v129, 1024, v37
    v_subrev_u32 v130, 2048, v41
    s_mul_i32 s68, s33, 3072
    s_lshl_b32 s69, s33, 10
    s_mul_i32 s96, s6, 1536
    s_mul_i32 s57, s33, 98304
    s_add_u32 s96, s96, s57
    s_mul_i32 s97, s7, 81920
    s_mul_i32 s57, s33, 10240
    s_add_u32 s97, s97, s57
    s_mul_i32 s98, s7, 81920
    s_mul_i32 s57, s4, 40960
    s_add_u32 s98, s98, s57
    s_mul_i32 s57, s33, 10240
    s_add_u32 s98, s98, s57
    v_lshlrev_b32 v28, 7, v0
    v_add_u32 v29, 8192, v28
    v_mov_b32 v26, 1073741824
    v_cmp_gt_u32 vcc, 16, v0
    s_nop 1
    v_cndmask_b32 v29, v26, v29, vcc
    s_add_u32 m0, s68, 73728
    s_add_u32 s57, s97, 40960
    buffer_load_dwordx4 v128, s[16:19], s96 offen offset:0 lds
    buffer_load_dwordx4 v129, s[16:19], s96 offen offset:1024 lds
    buffer_load_dwordx4 v130, s[16:19], s96 offen offset:2048 lds
    s_add_u32 m0, s69, 122880
    s_add_u32 s96, s96, 393216
    buffer_load_dwordx4 v131, s[24:27], s97 offen lds
    s_add_u32 m0, s69, 126976
    s_add_u32 s97, s97, 128
    buffer_load_dwordx4 v131, s[24:27], s57 offen lds
    s_add_u32 m0, s68, 86016
    s_nop 0
    buffer_load_dwordx4 v128, s[16:19], s96 offen offset:0 lds
    buffer_load_dwordx4 v129, s[16:19], s96 offen offset:1024 lds
    buffer_load_dwordx4 v130, s[16:19], s96 offen offset:2048 lds
    s_add_u32 s96, s96, 393216
    v_add_u32 v32, 0, v0
    v_add_u32 v36, 64, v0
    v_add_u32 v40, 128, v0
    v_mul_u32_u24 v33, 2731, v32
    v_mul_u32_u24 v37, 2731, v36
    v_mul_u32_u24 v41, 2731, v40
    v_lshrrev_b32 v33, 16, v33
    v_lshrrev_b32 v37, 16, v37
    v_lshrrev_b32 v41, 16, v41
    v_and_b32 v33, 6, v33
    v_and_b32 v37, 6, v37
    v_and_b32 v41, 6, v41
    v_xor_b32 v33, v33, v0
    v_xor_b32 v37, v37, v0
    v_xor_b32 v41, v41, v0
    v_lshlrev_b32 v1, 4, v33
    v_lshlrev_b32 v2, 4, v37
    v_lshlrev_b32 v3, 4, v41
    s_mul_i32 s51, s33, 3072
    s_lshl_b32 s52, s7, 3
    s_add_u32 s52, s52, s6
    s_mul_i32 s52, s52, 786432
    s_add_u32 s52, s52, s51
    s_mov_b32 s53, s52
    buffer_load_dword v23, v28, s[24:27], s98 offen
    buffer_load_dword v23, v29, s[24:27], s98 offen
    s_lshl_b32 s44, s5, 4
    s_add_u32 s44, s44, s7
    s_lshl_b32 s45, s44, 10
    s_add_u32 s45, s45, 25165824
    s_lshl_b32 s46, s6, 7
    s_add_u32 s46, s46, s45
    s_lshl_b32 s47, s6, 2
    s_add_u32 s47, s47, s45
    s_and_b32 s57, s33, 1
    s_lshl_b32 s57, s57, 6
    v_add_u32 v24, s57, v0
    v_mul_u32_u24 v25, 21846, v24
    v_lshrrev_b32 v25, 16, v25
    v_mul_u32_u24 v26, 3, v25
    v_sub_u32 v26, v24, v26
    v_mul_u32_u24 v25, 12288, v25
    v_lshl_add_u32 v25, v26, 7, v25
    v_lshlrev_b32 v26, 7, v24
    s_mov_b32 s56, 384
    s_mov_b32 s57, 491520
    s_cmp_ge_u32 s33, 2
    s_cselect_b64 vcc, -1, 0
    s_cselect_b32 s56, 245760, s56
    s_cselect_b32 s57, 15360, s57
    s_cselect_b32 s60, s20, s16
    s_cselect_b32 s61, s21, s17
    s_cselect_b32 s99, 0, 384
    s_mov_b32 s62, 7864320
    s_mov_b32 s63, 0x20000
    v_cndmask_b32 v25, v25, v26, vcc
    v_mov_b32 v26, 1073741824
    v_cmp_gt_u32 vcc, 120, v24
    s_nop 1
    v_cndmask_b32 v22, v26, v25, vcc
    s_mul_i32 s55, s57, s7
    s_mul_i32 s57, s56, s6
    s_lshl_b32 s57, s57, 2
    s_add_u32 s55, s55, s57
    s_add_u32 s55, s55, s99
    s_mov_b32 s100, 393222
    s_mov_b32 s101, 6
    s_cmp_lt_u32 s7, 4
    s_cselect_b32 s100, 6291552, s100
    s_cselect_b32 s101, 0, s101
    s_cselect_b32 s99, s99, 0
    s_cmp_ge_u32 s33, 2
    s_cselect_b32 s100, 100664832, s100
    s_cselect_b32 s101, 394752, s101
    s_and_b32 s57, s33, 1
    s_lshl_b32 s57, s57, 1
    s_lshl_b64 s[100:101], s[100:101], s57
    s_and_b32 s49, s33, 1
    s_lshr_b32 s59, s33, 1
    s_mul_i32 s59, s59, 12288
    s_add_u32 s59, s59, 131072
    s_mul_i32 s57, s49, 6144
    v_and_b32 v24, 15, v0
    v_lshrrev_b32 v25, 4, v0
    v_and_b32 v26, 6, v24
    v_xor_b32 v27, v26, v25
    v_mul_u32_u24 v24, 384, v24
    v_lshl_add_u32 v27, v27, 4, v24
    v_add_u32 v4, s57, v27
    v_xor_b32 v5, 64, v4
    v_bfe_u32 v26, v0, 1, 3
    v_xor_b32 v27, v26, v25
    v_lshl_add_u32 v27, v27, 4, v24
    v_add_u32 v48, s59, v27
    v_xor_b32 v49, 64, v48
    v_lshrrev_b32 v27, 1, v25
    v_xor_b32 v27, v27, v26
    v_lshl_add_u32 v27, v27, 4, v24
    v_and_b32 v26, 1, v25
    v_lshl_add_u32 v27, v26, 3, v27
    v_add_u32 v27, s59, v27
    s_lshl_b32 s59, s49, 6
    v_xor_b32 v27, s59, v27
    s_lshl_b32 s59, s49, 7
    v_add_u32 v50, s59, v27
    v_add_u32 v51, s59, v50
    v_lshrrev_b32 v24, 2, v0
    v_and_b32 v25, 6, v24
    v_bfe_u32 v26, v0, 1, 1
    v_xor_b32 v25, v25, v26
    v_mul_u32_u24 v24, 384, v24
    v_lshl_add_u32 v25, v25, 4, v24
    v_and_b32 v26, 1, v0
    v_lshl_add_u32 v25, v26, 3, v25
    s_lshl_b32 s59, s49, 6
    v_xor_b32 v25, s59, v25
    v_xor_b32 v26, 0, v25
    s_lshl_b32 s59, s49, 7
    v_add_u32 v26, s59, v26
    v_add_u32 v6, s57, v26
    s_sub_u32 s59, 6144, s57
    v_add_u32 v10, s59, v26
    v_xor_b32 v26, 32, v25
    s_lshl_b32 s59, s49, 7
    v_add_u32 v26, s59, v26
    v_add_u32 v7, s57, v26
    s_sub_u32 s59, 6144, s57
    v_add_u32 v11, s59, v26
    v_xor_b32 v26, 64, v25
    s_lshl_b32 s59, s49, 8
    v_add_u32 v26, s59, v26
    v_add_u32 v8, s57, v26
    s_sub_u32 s59, 6144, s57
    v_add_u32 v12, s59, v26
    v_xor_b32 v26, 96, v25
    s_lshl_b32 s59, s49, 8
    v_add_u32 v26, s59, v26
    v_add_u32 v9, s57, v26
    s_sub_u32 s59, 6144, s57
    v_add_u32 v13, s59, v26
    v_lshlrev_b32 v24, 3, v0
    s_lshl_b32 s57, s33, 10
    s_add_u32 s57, s57, 155648
    v_add_u32 v52, s57, v24
    v_xor_b32 v53, 1024, v52
    v_and_b32 v28, 7, v0
    v_lshlrev_b32 v29, 7, v28
    v_lshlrev_b32 v28, 2, v28
    s_mov_b32 s54, 0x3dd53b95
    s_mov_b32 s50, 0
    s_add_u32 m0, s68, 98304
    s_add_u32 s57, s97, 40960
    buffer_load_dwordx4 v128, s[16:19], s96 offen offset:0 lds
    buffer_load_dwordx4 v129, s[16:19], s96 offen offset:1024 lds
    buffer_load_dwordx4 v130, s[16:19], s96 offen offset:2048 lds
    s_add_u32 m0, s69, 155648
    s_add_u32 s96, s96, 393216
    buffer_load_dwordx4 v131, s[24:27], s97 offen lds
    s_add_u32 m0, s69, 159744
    s_add_u32 s97, s97, 128
    buffer_load_dwordx4 v131, s[24:27], s57 offen lds
    s_add_u32 m0, s68, 110592
    s_nop 0
    buffer_load_dwordx4 v128, s[16:19], s96 offen offset:0 lds
    buffer_load_dwordx4 v129, s[16:19], s96 offen offset:1024 lds
    buffer_load_dwordx4 v130, s[16:19], s96 offen offset:2048 lds
    s_add_u32 s96, s96, 393216
    s_waitcnt vmcnt(10) lgkmcnt(0)
    s_barrier
L_Apro:
    s_add_u32 m0, s68, 24576
    s_add_u32 s57, s97, 40960
    buffer_load_dwordx4 v128, s[16:19], s96 offen offset:0 lds
    buffer_load_dwordx4 v129, s[16:19], s96 offen offset:1024 lds
    buffer_load_dwordx4 v130, s[16:19], s96 offen offset:2048 lds
    s_add_u32 m0, s69, 131072
    s_add_u32 s96, s96, 393216
    buffer_load_dwordx4 v131, s[24:27], s97 offen lds
    s_add_u32 m0, s69, 135168
    s_add_u32 s97, s97, 128
    buffer_load_dwordx4 v131, s[24:27], s57 offen lds
    s_add_u32 m0, s68, 36864
    s_nop 0
    buffer_load_dwordx4 v128, s[16:19], s96 offen offset:0 lds
    buffer_load_dwordx4 v129, s[16:19], s96 offen offset:1024 lds
    buffer_load_dwordx4 v130, s[16:19], s96 offen offset:2048 lds
    s_add_u32 s96, s96, 393216
    s_waitcnt vmcnt(8) lgkmcnt(0)
    s_barrier
    s_add_u32 m0, s68, 49152
    s_add_u32 s57, s97, 40960
    buffer_load_dwordx4 v128, s[16:19], s96 offen offset:0 lds
    buffer_load_dwordx4 v129, s[16:19], s96 offen offset:1024 lds
    buffer_load_dwordx4 v130, s[16:19], s96 offen offset:2048 lds
    s_add_u32 m0, s69, 139264
    s_add_u32 s96, s96, 393216
    buffer_load_dwordx4 v131, s[24:27], s97 offen lds
    s_add_u32 m0, s69, 143360
    s_add_u32 s97, s97, 128
    buffer_load_dwordx4 v131, s[24:27], s57 offen lds
    s_add_u32 m0, s68, 61440
    s_nop 0
    buffer_load_dwordx4 v128, s[16:19], s96 offen offset:0 lds
    buffer_load_dwordx4 v129, s[16:19], s96 offen offset:1024 lds
    buffer_load_dwordx4 v130, s[16:19], s96 offen offset:2048 lds
    s_add_u32 s96, s96, 393216
    s_waitcnt vmcnt(8) lgkmcnt(0)
    s_barrier
    s_add_u32 m0, s68, 73728
    s_add_u32 s57, s97, 40960
    buffer_load_dwordx4 v128, s[16:19], s96 offen offset:0 lds
    buffer_load_dwordx4 v129, s[16:19], s96 offen offset:1024 lds
    buffer_load_dwordx4 v130, s[16:19], s96 offen offset:2048 lds
    s_add_u32 m0, s69, 122880
    s_add_u32 s96, s96, 393216
    buffer_load_dwordx4 v131, s[24:27], s97 offen lds
    s_add_u32 m0, s69, 126976
    s_add_u32 s97, s97, 128
    buffer_load_dwordx4 v131, s[24:27], s57 offen lds
    s_add_u32 m0, s68, 86016
    s_nop 0
    buffer_load_dwordx4 v128, s[16:19], s96 offen offset:0 lds
    buffer_load_dwordx4 v129, s[16:19], s96 offen offset:1024 lds
    buffer_load_dwordx4 v130, s[16:19], s96 offen offset:2048 lds
    s_add_u32 s96, s96, 393216
    s_waitcnt vmcnt(8) lgkmcnt(0)
    s_barrier
    s_add_u32 m0, s68, 98304
    s_add_u32 s57, s97, 40960
    buffer_load_dwordx4 v128, s[16:19], s96 offen offset:0 lds
    buffer_load_dwordx4 v129, s[16:19], s96 offen offset:1024 lds
    buffer_load_dwordx4 v130, s[16:19], s96 offen offset:2048 lds
    s_add_u32 m0, s69, 155648
    s_add_u32 s96, s96, 393216
    buffer_load_dwordx4 v131, s[24:27], s97 offen lds
    s_add_u32 m0, s69, 159744
    s_add_u32 s97, s97, 128
    buffer_load_dwordx4 v131, s[24:27], s57 offen lds
    s_add_u32 m0, s68, 110592
    s_nop 0
    buffer_load_dwordx4 v128, s[16:19], s96 offen offset:0 lds
    buffer_load_dwordx4 v129, s[16:19], s96 offen offset:1024 lds
    buffer_load_dwordx4 v130, s[16:19], s96 offen offset:2048 lds
    s_add_u32 s96, s96, 393216
    s_waitcnt vmcnt(8) lgkmcnt(0)
    s_barrier
    s_add_u32 m0, s68, 24576
    s_add_u32 s57, s97, 40960
    buffer_load_dwordx4 v128, s[16:19], s96 offen offset:0 lds
    buffer_load_dwordx4 v129, s[16:19], s96 offen offset:1024 lds
    buffer_load_dwordx4 v130, s[16:19], s96 offen offset:2048 lds
    s_add_u32 m0, s69, 131072
    s_add_u32 s96, s96, 393216
    buffer_load_dwordx4 v131, s[24:27], s97 offen lds
    s_add_u32 m0, s69, 135168
    s_add_u32 s97, s97, 128
    buffer_load_dwordx4 v131, s[24:27], s57 offen lds
    s_add_u32 m0, s68, 36864
    s_nop 0
    buffer_load_dwordx4 v128, s[16:19], s96 offen offset:0 lds
    buffer_load_dwordx4 v129, s[16:19], s96 offen offset:1024 lds
    buffer_load_dwordx4 v130, s[16:19], s96 offen offset:2048 lds
    s_add_u32 s96, s96, 393216
    s_waitcnt vmcnt(8) lgkmcnt(0)
    s_barrier
    s_add_u32 m0, s68, 49152
    s_add_u32 s57, s97, 40960
    buffer_load_dwordx4 v128, s[16:19], s96 offen offset:0 lds
    buffer_load_dwordx4 v129, s[16:19], s96 offen offset:1024 lds
    buffer_load_dwordx4 v130, s[16:19], s96 offen offset:2048 lds
    s_add_u32 m0, s69, 139264
    s_add_u32 s96, s96, 393216
    buffer_load_dwordx4 v131, s[24:27], s97 offen lds
    s_add_u32 m0, s69, 143360
    s_add_u32 s97, s97, 128
    buffer_load_dwordx4 v131, s[24:27], s57 offen lds
    s_add_u32 m0, s68, 61440
    s_nop 0
    buffer_load_dwordx4 v128, s[16:19], s96 offen offset:0 lds
    buffer_load_dwordx4 v129, s[16:19], s96 offen offset:1024 lds
    buffer_load_dwordx4 v130, s[16:19], s96 offen offset:2048 lds
    s_add_u32 s96, s96, 393216
    s_waitcnt vmcnt(8) lgkmcnt(0)
    s_barrier
    s_add_u32 m0, s68, 73728
    s_add_u32 s57, s97, 40960
    buffer_load_dwordx4 v128, s[16:19], s96 offen offset:0 lds
    buffer_load_dwordx4 v129, s[16:19], s96 offen offset:1024 lds
    buffer_load_dwordx4 v130, s[16:19], s96 offen offset:2048 lds
    s_add_u32 m0, s69, 122880
    s_add_u32 s96, s96, 393216
    buffer_load_dwordx4 v131, s[24:27], s97 offen lds
    s_add_u32 m0, s69, 126976
    s_add_u32 s97, s97, 128
    buffer_load_dwordx4 v131, s[24:27], s57 offen lds
    s_add_u32 m0, s68, 86016
    s_nop 0
    buffer_load_dwordx4 v128, s[16:19], s96 offen offset:0 lds
    buffer_load_dwordx4 v129, s[16:19], s96 offen offset:1024 lds
    buffer_load_dwordx4 v130, s[16:19], s96 offen offset:2048 lds
    s_add_u32 s96, s96, 393216
    s_add_u32 m0, s51, 0
    s_nop 0
    buffer_load_dwordx4 v1, s[8:11], s52 offen offset:0 nt lds
    buffer_load_dwordx4 v2, s[8:11], s52 offen offset:1024 nt lds
    buffer_load_dwordx4 v3, s[8:11], s52 offen offset:2048 nt lds
    s_add_u32 m0, s51, 12288
    s_add_u32 s52, s52, 12288
    buffer_load_dwordx4 v1, s[8:11], s52 offen offset:0 nt lds
    buffer_load_dwordx4 v2, s[8:11], s52 offen offset:1024 nt lds
    buffer_load_dwordx4 v3, s[8:11], s52 offen offset:2048 nt lds
    s_add_u32 s52, s52, 12288
    s_waitcnt vmcnt(14) lgkmcnt(0)
    s_barrier
    s_add_u32 m0, s68, 98304
    s_add_u32 s57, s97, 40960
    buffer_load_dwordx4 v128, s[16:19], s96 offen offset:0 lds
    buffer_load_dwordx4 v129, s[16:19], s96 offen offset:1024 lds
    buffer_load_dwordx4 v130, s[16:19], s96 offen offset:2048 lds
    s_add_u32 m0, s69, 155648
    s_add_u32 s96, s96, 393216
    buffer_load_dwordx4 v131, s[24:27], s97 offen lds
    s_add_u32 m0, s69, 159744
    s_add_u32 s97, s97, 128
    buffer_load_dwordx4 v131, s[24:27], s57 offen lds
    s_add_u32 m0, s68, 110592
    s_nop 0
    buffer_load_dwordx4 v128, s[16:19], s96 offen offset:0 lds
    buffer_load_dwordx4 v129, s[16:19], s96 offen offset:1024 lds
    buffer_load_dwordx4 v130, s[16:19], s96 offen offset:2048 lds
    s_add_u32 s96, s96, 393216
    s_waitcnt vmcnt(14) lgkmcnt(0)
    s_barrier
    s_cmp_eq_u32 s99, 0
    s_cselect_b32 s57, 1073741824, s55
    buffer_load_dword v23, v22, s[60:63], s57 offen
    s_add_u32 s55, s55, s99
    s_cmp_eq_u32 s33, 0
    s_cselect_b32 s57, s46, 1073741824
    s_cselect_b32 s59, s47, 1073741824
    buffer_load_dword v54, v28, s[28:31], s57 offen sc1
    buffer_load_dword v55, v29, s[28:31], s59 offen sc1
    s_add_u32 m0, s51, 24576
    s_nop 0
    buffer_load_dwordx4 v1, s[8:11], s52 offen offset:0 nt lds
    buffer_load_dwordx4 v2, s[8:11], s52 offen offset:1024 nt lds
    buffer_load_dwordx4 v3, s[8:11], s52 offen offset:2048 nt lds
    s_add_u32 m0, s51, 36864
    s_add_u32 s52, s52, 12288
    buffer_load_dwordx4 v1, s[8:11], s52 offen offset:0 nt lds
    buffer_load_dwordx4 v2, s[8:11], s52 offen offset:1024 nt lds
    buffer_load_dwordx4 v3, s[8:11], s52 offen offset:2048 nt lds
    s_add_u32 s52, s52, 12288
    s_waitcnt vmcnt(9) lgkmcnt(0)
    s_barrier
    s_waitcnt vmcnt(20) lgkmcnt(0)
    s_barrier
L_Aper:
    s_cmp_eq_u32 s50, 0
    s_cbranch_scc1 L_A0
    s_add_u32 m0, s51, 24576
    s_nop 0
    buffer_load_dwordx4 v1, s[8:11], s52 offen offset:0 nt lds
    buffer_load_dwordx4 v2, s[8:11], s52 offen offset:1024 nt lds
    buffer_load_dwordx4 v3, s[8:11], s52 offen offset:2048 nt lds
    s_add_u32 m0, s51, 36864
    s_add_u32 s52, s52, 12288
    buffer_load_dwordx4 v1, s[8:11], s52 offen offset:0 nt lds
    buffer_load_dwordx4 v2, s[8:11], s52 offen offset:1024 nt lds
    buffer_load_dwordx4 v3, s[8:11], s52 offen offset:2048 nt lds
    s_add_u32 s52, s52, 12288
L_A0:
    ds_read_b128 v[80:83], v48 offset:0
    ds_read_b128 v[84:87], v48 offset:6144
    ds_read_b128 v[88:91], v49 offset:0
    ds_read_b128 v[92:95], v49 offset:6144
    ds_read_b128 v[96:99], v48 offset:128
    ds_read_b128 v[100:103], v48 offset:6272
    ds_read_b128 v[104:107], v49 offset:128
    ds_read_b128 v[108:111], v49 offset:6272
    ds_read_b128 v[112:115], v48 offset:256
    ds_read_b128 v[116:119], v48 offset:6400
    ds_read_b128 v[120:123], v49 offset:256
    ds_read_b128 v[124:127], v49 offset:6400
    ds_read_b128 v[24:27], v4 offset:0
    ds_read_b128 v[28:31], v5 offset:0
    ds_read_b128 v[32:35], v4 offset:128
    ds_read_b128 v[36:39], v5 offset:128
    ds_read_b128 v[40:43], v4 offset:256
    ds_read_b128 v[44:47], v5 offset:256
    s_waitcnt lgkmcnt(5)
    v_mfma_f32_16x16x32_bf16 v[128:131], v[24:27], v[80:83], 0
    s_waitcnt lgkmcnt(4)
    v_mfma_f32_16x16x32_bf16 v[128:131], v[28:31], v[88:91], v[128:131]
    s_waitcnt lgkmcnt(3)
    v_mfma_f32_16x16x32_bf16 v[128:131], v[32:35], v[96:99], v[128:131]
    s_waitcnt lgkmcnt(2)
    v_mfma_f32_16x16x32_bf16 v[128:131], v[36:39], v[104:107], v[128:131]
    s_waitcnt lgkmcnt(1)
    v_mfma_f32_16x16x32_bf16 v[128:131], v[40:43], v[112:115], v[128:131]
    s_waitcnt lgkmcnt(0)
    v_mfma_f32_16x16x32_bf16 v[128:131], v[44:47], v[120:123], v[128:131]
    v_mfma_f32_16x16x32_bf16 v[132:135], v[24:27], v[84:87], 0
    v_mfma_f32_16x16x32_bf16 v[132:135], v[28:31], v[92:95], v[132:135]
    v_mfma_f32_16x16x32_bf16 v[132:135], v[32:35], v[100:103], v[132:135]
    v_mfma_f32_16x16x32_bf16 v[132:135], v[36:39], v[108:111], v[132:135]
    v_mfma_f32_16x16x32_bf16 v[132:135], v[40:43], v[116:119], v[132:135]
    v_mfma_f32_16x16x32_bf16 v[132:135], v[44:47], v[124:127], v[132:135]
    s_waitcnt vmcnt(6) lgkmcnt(0)
    s_barrier
    ds_read_b128 v[24:27], v4 offset:12288
    ds_read_b128 v[28:31], v5 offset:12288
    ds_read_b128 v[32:35], v4 offset:12416
    ds_read_b128 v[36:39], v5 offset:12416
    ds_read_b128 v[40:43], v4 offset:12544
    ds_read_b128 v[44:47], v5 offset:12544
    s_waitcnt lgkmcnt(5)
    v_mfma_f32_16x16x32_bf16 v[136:139], v[24:27], v[80:83], 0
    v_max_f32 v14, v128, v129
    s_waitcnt lgkmcnt(4)
    v_mfma_f32_16x16x32_bf16 v[136:139], v[28:31], v[88:91], v[136:139]
    v_max_f32 v15, v132, v133
    s_waitcnt lgkmcnt(3)
    v_mfma_f32_16x16x32_bf16 v[136:139], v[32:35], v[96:99], v[136:139]
    v_max3_f32 v14, v14, v130, v131
    s_waitcnt lgkmcnt(2)
    v_mfma_f32_16x16x32_bf16 v[136:139], v[36:39], v[104:107], v[136:139]
    v_max3_f32 v15, v15, v134, v135
    s_waitcnt lgkmcnt(1)
    v_mfma_f32_16x16x32_bf16 v[136:139], v[40:43], v[112:115], v[136:139]
    v_xor_b32 v20, 0, v50
    s_waitcnt lgkmcnt(0)
    v_mfma_f32_16x16x32_bf16 v[136:139], v[44:47], v[120:123], v[136:139]
    ds_write_b64 v20, v[56:57] offset:0
    v_mfma_f32_16x16x32_bf16 v[140:143], v[24:27], v[84:87], 0
    ds_write_b64 v20, v[58:59] offset:6144
    v_mfma_f32_16x16x32_bf16 v[140:143], v[28:31], v[92:95], v[140:143]
    v_xor_b32 v21, 32, v50
    v_mfma_f32_16x16x32_bf16 v[140:143], v[32:35], v[100:103], v[140:143]
    ds_write_b64 v21, v[60:61] offset:0
    v_mfma_f32_16x16x32_bf16 v[140:143], v[36:39], v[108:111], v[140:143]
    ds_write_b64 v21, v[62:63] offset:6144
    v_mfma_f32_16x16x32_bf16 v[140:143], v[40:43], v[116:119], v[140:143]
    v_xor_b32 v20, 64, v51
    v_mfma_f32_16x16x32_bf16 v[140:143], v[44:47], v[124:127], v[140:143]
    ds_write_b64 v20, v[64:65] offset:0
    ds_write_b64 v20, v[66:67] offset:6144
    s_waitcnt vmcnt(3) lgkmcnt(0)
    s_barrier
    s_add_u32 m0, s51, 0
    s_nop 0
    buffer_load_dwordx4 v1, s[8:11], s52 offen offset:0 nt lds
    buffer_load_dwordx4 v2, s[8:11], s52 offen offset:1024 nt lds
    buffer_load_dwordx4 v3, s[8:11], s52 offen offset:2048 nt lds
    s_add_u32 m0, s51, 12288
    s_add_u32 s52, s52, 12288
    buffer_load_dwordx4 v1, s[8:11], s52 offen offset:0 nt lds
    buffer_load_dwordx4 v2, s[8:11], s52 offen offset:1024 nt lds
    buffer_load_dwordx4 v3, s[8:11], s52 offen offset:2048 nt lds
    s_add_u32 s52, s52, 12288
    s_lshl_b32 s57, s50, 4
    s_add_u32 s57, s57, 1
    s_bitcmp1_b64 s[100:101], s57
    s_cselect_b32 s57, s55, 1073741824
    s_mov_b32 exec_hi, 0
    buffer_load_dword v23, v22, s[60:63], s57 offen
    s_mov_b64 exec, -1
    ds_read_b128 v[24:27], v4 offset:24576
    ds_read_b128 v[28:31], v5 offset:24576
    ds_read_b128 v[32:35], v4 offset:24704
    ds_read_b128 v[36:39], v5 offset:24704
    ds_read_b128 v[40:43], v4 offset:24832
    ds_read_b128 v[44:47], v5 offset:24832
    s_waitcnt lgkmcnt(5)
    v_mfma_f32_16x16x32_bf16 v[144:147], v[24:27], v[80:83], 0
    v_max3_f32 v14, v14, v136, v137
    s_waitcnt lgkmcnt(4)
    v_mfma_f32_16x16x32_bf16 v[144:147], v[28:31], v[88:91], v[144:147]
    v_max3_f32 v15, v15, v140, v141
    s_waitcnt lgkmcnt(3)
    v_mfma_f32_16x16x32_bf16 v[144:147], v[32:35], v[96:99], v[144:147]
    v_max3_f32 v14, v14, v138, v139
    s_waitcnt lgkmcnt(2)
    v_mfma_f32_16x16x32_bf16 v[144:147], v[36:39], v[104:107], v[144:147]
    v_max3_f32 v15, v15, v142, v143
    s_waitcnt lgkmcnt(1)
    v_mfma_f32_16x16x32_bf16 v[144:147], v[40:43], v[112:115], v[144:147]
    v_xor_b32 v21, 96, v51
    s_waitcnt lgkmcnt(0)
    v_mfma_f32_16x16x32_bf16 v[144:147], v[44:47], v[120:123], v[144:147]
    ds_write_b64 v21, v[68:69] offset:0
    v_mfma_f32_16x16x32_bf16 v[148:151], v[24:27], v[84:87], 0
    ds_write_b64 v21, v[70:71] offset:6144
    v_mfma_f32_16x16x32_bf16 v[148:151], v[28:31], v[92:95], v[148:151]
    v_xor_b32 v20, 0, v50
    v_mfma_f32_16x16x32_bf16 v[148:151], v[32:35], v[100:103], v[148:151]
    ds_write_b64 v20, v[72:73] offset:128
    v_mfma_f32_16x16x32_bf16 v[148:151], v[36:39], v[108:111], v[148:151]
    ds_write_b64 v20, v[74:75] offset:6272
    v_mfma_f32_16x16x32_bf16 v[148:151], v[40:43], v[116:119], v[148:151]
    v_xor_b32 v21, 32, v50
    v_mfma_f32_16x16x32_bf16 v[148:151], v[44:47], v[124:127], v[148:151]
    ds_write_b64 v21, v[76:77] offset:128
    ds_write_b64 v21, v[78:79] offset:6272
    s_waitcnt vmcnt(7) lgkmcnt(0)
    s_barrier
    ds_read_b128 v[24:27], v4 offset:36864
    ds_read_b128 v[28:31], v5 offset:36864
    ds_read_b128 v[32:35], v4 offset:36992
    ds_read_b128 v[36:39], v5 offset:36992
    ds_read_b128 v[40:43], v4 offset:37120
    ds_read_b128 v[44:47], v5 offset:37120
    s_waitcnt lgkmcnt(5)
    v_mfma_f32_16x16x32_bf16 v[152:155], v[24:27], v[80:83], 0
    s_waitcnt lgkmcnt(4)
    v_mfma_f32_16x16x32_bf16 v[152:155], v[28:31], v[88:91], v[152:155]
    s_waitcnt lgkmcnt(3)
    v_mfma_f32_16x16x32_bf16 v[152:155], v[32:35], v[96:99], v[152:155]
    v_max3_f32 v14, v14, v144, v145
    s_waitcnt lgkmcnt(2)
    v_mfma_f32_16x16x32_bf16 v[152:155], v[36:39], v[104:107], v[152:155]
    s_waitcnt lgkmcnt(1)
    v_mfma_f32_16x16x32_bf16 v[152:155], v[40:43], v[112:115], v[152:155]
    s_waitcnt lgkmcnt(0)
    v_mfma_f32_16x16x32_bf16 v[152:155], v[44:47], v[120:123], v[152:155]
    v_max3_f32 v15, v15, v148, v149
    v_mfma_f32_16x16x32_bf16 v[156:159], v[24:27], v[84:87], 0
    v_mfma_f32_16x16x32_bf16 v[156:159], v[28:31], v[92:95], v[156:159]
    v_mfma_f32_16x16x32_bf16 v[156:159], v[32:35], v[100:103], v[156:159]
    v_max3_f32 v14, v14, v146, v147
    v_mfma_f32_16x16x32_bf16 v[156:159], v[36:39], v[108:111], v[156:159]
    v_mfma_f32_16x16x32_bf16 v[156:159], v[40:43], v[116:119], v[156:159]
    v_mfma_f32_16x16x32_bf16 v[156:159], v[44:47], v[124:127], v[156:159]
    v_max3_f32 v15, v15, v150, v151
    s_waitcnt vmcnt(4) lgkmcnt(0)
    s_barrier
    s_add_u32 m0, s51, 24576
    s_nop 0
    buffer_load_dwordx4 v1, s[8:11], s52 offen offset:0 nt lds
    buffer_load_dwordx4 v2, s[8:11], s52 offen offset:1024 nt lds
    buffer_load_dwordx4 v3, s[8:11], s52 offen offset:2048 nt lds
    s_add_u32 m0, s51, 36864
    s_add_u32 s52, s52, 12288
    buffer_load_dwordx4 v1, s[8:11], s52 offen offset:0 nt lds
    buffer_load_dwordx4 v2, s[8:11], s52 offen offset:1024 nt lds
    buffer_load_dwordx4 v3, s[8:11], s52 offen offset:2048 nt lds
    s_add_u32 s52, s52, 12288
    s_lshl_b32 s57, s50, 4
    s_add_u32 s57, s57, 2
    s_bitcmp1_b64 s[100:101], s57
    s_cselect_b32 s57, s55, 1073741824
    s_cselect_b32 s59, s56, 0
    s_mov_b32 exec_lo, 0
    buffer_load_dword v23, v22, s[60:63], s57 offen
    s_mov_b64 exec, -1
    s_add_u32 s55, s55, s59
    ds_read_b128 v[24:27], v4 offset:0
    ds_read_b128 v[28:31], v5 offset:0
    ds_read_b128 v[32:35], v4 offset:128
    ds_read_b128 v[36:39], v5 offset:128
    ds_read_b128 v[40:43], v4 offset:256
    ds_read_b128 v[44:47], v5 offset:256
    s_waitcnt lgkmcnt(5)
    v_mfma_f32_16x16x32_bf16 v[160:163], v[24:27], v[80:83], 0
    s_waitcnt lgkmcnt(4)
    v_mfma_f32_16x16x32_bf16 v[160:163], v[28:31], v[88:91], v[160:163]
    s_waitcnt lgkmcnt(3)
    v_mfma_f32_16x16x32_bf16 v[160:163], v[32:35], v[96:99], v[160:163]
    v_max3_f32 v14, v14, v152, v153
    s_waitcnt lgkmcnt(2)
    v_mfma_f32_16x16x32_bf16 v[160:163], v[36:39], v[104:107], v[160:163]
    s_waitcnt lgkmcnt(1)
    v_mfma_f32_16x16x32_bf16 v[160:163], v[40:43], v[112:115], v[160:163]
    s_waitcnt lgkmcnt(0)
    v_mfma_f32_16x16x32_bf16 v[160:163], v[44:47], v[120:123], v[160:163]
    v_max3_f32 v15, v15, v156, v157
    v_mfma_f32_16x16x32_bf16 v[164:167], v[24:27], v[84:87], 0
    v_mfma_f32_16x16x32_bf16 v[164:167], v[28:31], v[92:95], v[164:167]
    v_mfma_f32_16x16x32_bf16 v[164:167], v[32:35], v[100:103], v[164:167]
    v_max3_f32 v14, v14, v154, v155
    v_mfma_f32_16x16x32_bf16 v[164:167], v[36:39], v[108:111], v[164:167]
    v_mfma_f32_16x16x32_bf16 v[164:167], v[40:43], v[116:119], v[164:167]
    v_mfma_f32_16x16x32_bf16 v[164:167], v[44:47], v[124:127], v[164:167]
    v_max3_f32 v15, v15, v158, v159
    s_waitcnt vmcnt(7) lgkmcnt(0)
    s_barrier
    s_and_b32 s57, s6, 3
    s_xor_b32 s57, s57, s50
    s_or_b32 s57, s57, s33
    s_nop 1
    s_cbranch_scc1 L_sy1
    s_lshl_b32 s45, s44, 3
    v_mov_b32 v20, s45
    v_mov_b32 v21, 1
    s_mov_b64 exec, 1
    buffer_atomic_add v21, v20, s[36:39], 0 offen
    s_mov_b64 exec, -1
L_sy1:
    ds_read_b128 v[24:27], v4 offset:12288
    ds_read_b128 v[28:31], v5 offset:12288
    ds_read_b128 v[32:35], v4 offset:12416
    ds_read_b128 v[36:39], v5 offset:12416
    ds_read_b128 v[40:43], v4 offset:12544
    ds_read_b128 v[44:47], v5 offset:12544
    s_waitcnt lgkmcnt(5)
    v_mfma_f32_16x16x32_bf16 v[168:171], v[24:27], v[80:83], 0
    s_waitcnt lgkmcnt(4)
    v_mfma_f32_16x16x32_bf16 v[168:171], v[28:31], v[88:91], v[168:171]
    s_waitcnt lgkmcnt(3)
    v_mfma_f32_16x16x32_bf16 v[168:171], v[32:35], v[96:99], v[168:171]
    v_max3_f32 v14, v14, v160, v161
    s_waitcnt lgkmcnt(2)
    v_mfma_f32_16x16x32_bf16 v[168:171], v[36:39], v[104:107], v[168:171]
    s_waitcnt lgkmcnt(1)
    v_mfma_f32_16x16x32_bf16 v[168:171], v[40:43], v[112:115], v[168:171]
    s_waitcnt lgkmcnt(0)
    v_mfma_f32_16x16x32_bf16 v[168:171], v[44:47], v[120:123], v[168:171]
    v_max3_f32 v15, v15, v164, v165
    v_mfma_f32_16x16x32_bf16 v[172:175], v[24:27], v[84:87], 0
    v_mfma_f32_16x16x32_bf16 v[172:175], v[28:31], v[92:95], v[172:175]
    v_mfma_f32_16x16x32_bf16 v[172:175], v[32:35], v[100:103], v[172:175]
    v_max3_f32 v14, v14, v162, v163
    v_mfma_f32_16x16x32_bf16 v[172:175], v[36:39], v[108:111], v[172:175]
    v_mfma_f32_16x16x32_bf16 v[172:175], v[40:43], v[116:119], v[172:175]
    v_mfma_f32_16x16x32_bf16 v[172:175], v[44:47], v[124:127], v[172:175]
    v_max3_f32 v15, v15, v166, v167
    s_waitcnt vmcnt(4) lgkmcnt(0)
    s_barrier
    s_add_u32 m0, s51, 0
    s_nop 0
    buffer_load_dwordx4 v1, s[8:11], s52 offen offset:0 nt lds
    buffer_load_dwordx4 v2, s[8:11], s52 offen offset:1024 nt lds
    buffer_load_dwordx4 v3, s[8:11], s52 offen offset:2048 nt lds
    s_add_u32 m0, s51, 12288
    s_add_u32 s52, s52, 12288
    buffer_load_dwordx4 v1, s[8:11], s52 offen offset:0 nt lds
    buffer_load_dwordx4 v2, s[8:11], s52 offen offset:1024 nt lds
    buffer_load_dwordx4 v3, s[8:11], s52 offen offset:2048 nt lds
    s_add_u32 s52, s52, 12288
    s_lshl_b32 s57, s50, 4
    s_add_u32 s57, s57, 3
    s_bitcmp1_b64 s[100:101], s57
    s_cselect_b32 s57, s55, 1073741824
    s_mov_b32 exec_hi, 0
    buffer_load_dword v23, v22, s[60:63], s57 offen
    s_mov_b64 exec, -1
    ds_read_b128 v[24:27], v4 offset:24576
    ds_read_b128 v[28:31], v5 offset:24576
    ds_read_b128 v[32:35], v4 offset:24704
    ds_read_b128 v[36:39], v5 offset:24704
    ds_read_b128 v[40:43], v4 offset:24832
    ds_read_b128 v[44:47], v5 offset:24832
    s_waitcnt lgkmcnt(5)
    v_mfma_f32_16x16x32_bf16 v[176:179], v[24:27], v[80:83], 0
    s_waitcnt lgkmcnt(4)
    v_mfma_f32_16x16x32_bf16 v[176:179], v[28:31], v[88:91], v[176:179]
    s_waitcnt lgkmcnt(3)
    v_mfma_f32_16x16x32_bf16 v[176:179], v[32:35], v[96:99], v[176:179]
    v_max3_f32 v14, v14, v168, v169
    s_waitcnt lgkmcnt(2)
    v_mfma_f32_16x16x32_bf16 v[176:179], v[36:39], v[104:107], v[176:179]
    s_waitcnt lgkmcnt(1)
    v_mfma_f32_16x16x32_bf16 v[176:179], v[40:43], v[112:115], v[176:179]
    s_waitcnt lgkmcnt(0)
    v_mfma_f32_16x16x32_bf16 v[176:179], v[44:47], v[120:123], v[176:179]
    v_max3_f32 v15, v15, v172, v173
    v_mfma_f32_16x16x32_bf16 v[180:183], v[24:27], v[84:87], 0
    v_mfma_f32_16x16x32_bf16 v[180:183], v[28:31], v[92:95], v[180:183]
    v_mfma_f32_16x16x32_bf16 v[180:183], v[32:35], v[100:103], v[180:183]
    v_max3_f32 v14, v14, v170, v171
    v_mfma_f32_16x16x32_bf16 v[180:183], v[36:39], v[108:111], v[180:183]
    v_mfma_f32_16x16x32_bf16 v[180:183], v[40:43], v[116:119], v[180:183]
    v_mfma_f32_16x16x32_bf16 v[180:183], v[44:47], v[124:127], v[180:183]
    v_max3_f32 v15, v15, v174, v175
    s_waitcnt vmcnt(7) lgkmcnt(0)
    s_barrier
    ds_read_b128 v[24:27], v4 offset:36864
    ds_read_b128 v[28:31], v5 offset:36864
    ds_read_b128 v[32:35], v4 offset:36992
    ds_read_b128 v[36:39], v5 offset:36992
    ds_read_b128 v[40:43], v4 offset:37120
    ds_read_b128 v[44:47], v5 offset:37120
    s_waitcnt lgkmcnt(5)
    v_mfma_f32_16x16x32_bf16 v[184:187], v[24:27], v[80:83], 0
    s_waitcnt lgkmcnt(4)
    v_mfma_f32_16x16x32_bf16 v[184:187], v[28:31], v[88:91], v[184:187]
    s_waitcnt lgkmcnt(3)
    v_mfma_f32_16x16x32_bf16 v[184:187], v[32:35], v[96:99], v[184:187]
    v_max3_f32 v14, v14, v176, v177
    s_waitcnt lgkmcnt(2)
    v_mfma_f32_16x16x32_bf16 v[184:187], v[36:39], v[104:107], v[184:187]
    s_waitcnt lgkmcnt(1)
    v_mfma_f32_16x16x32_bf16 v[184:187], v[40:43], v[112:115], v[184:187]
    s_waitcnt lgkmcnt(0)
    v_mfma_f32_16x16x32_bf16 v[184:187], v[44:47], v[120:123], v[184:187]
    v_max3_f32 v15, v15, v180, v181
    v_mfma_f32_16x16x32_bf16 v[188:191], v[24:27], v[84:87], 0
    v_mfma_f32_16x16x32_bf16 v[188:191], v[28:31], v[92:95], v[188:191]
    v_mfma_f32_16x16x32_bf16 v[188:191], v[32:35], v[100:103], v[188:191]
    v_max3_f32 v14, v14, v178, v179
    v_mfma_f32_16x16x32_bf16 v[188:191], v[36:39], v[108:111], v[188:191]
    v_mfma_f32_16x16x32_bf16 v[188:191], v[40:43], v[116:119], v[188:191]
    v_mfma_f32_16x16x32_bf16 v[188:191], v[44:47], v[124:127], v[188:191]
    v_max3_f32 v15, v15, v182, v183
    s_waitcnt vmcnt(4) lgkmcnt(0)
    s_barrier
    s_add_u32 m0, s51, 24576
    s_nop 0
    buffer_load_dwordx4 v1, s[8:11], s52 offen offset:0 nt lds
    buffer_load_dwordx4 v2, s[8:11], s52 offen offset:1024 nt lds
    buffer_load_dwordx4 v3, s[8:11], s52 offen offset:2048 nt lds
    s_add_u32 m0, s51, 36864
    s_add_u32 s52, s52, 12288
    buffer_load_dwordx4 v1, s[8:11], s52 offen offset:0 nt lds
    buffer_load_dwordx4 v2, s[8:11], s52 offen offset:1024 nt lds
    buffer_load_dwordx4 v3, s[8:11], s52 offen offset:2048 nt lds
    s_add_u32 s52, s52, 12288
    s_lshl_b32 s57, s50, 4
    s_add_u32 s57, s57, 4
    s_bitcmp1_b64 s[100:101], s57
    s_cselect_b32 s57, s55, 1073741824
    s_cselect_b32 s59, s56, 0
    s_mov_b32 exec_lo, 0
    buffer_load_dword v23, v22, s[60:63], s57 offen
    s_mov_b64 exec, -1
    s_add_u32 s55, s55, s59
    ds_read_b128 v[24:27], v4 offset:0
    ds_read_b128 v[28:31], v5 offset:0
    ds_read_b128 v[32:35], v4 offset:128
    ds_read_b128 v[36:39], v5 offset:128
    ds_read_b128 v[40:43], v4 offset:256
    ds_read_b128 v[44:47], v5 offset:256
    s_waitcnt lgkmcnt(5)
    v_mfma_f32_16x16x32_bf16 v[192:195], v[24:27], v[80:83], 0
    s_waitcnt lgkmcnt(4)
    v_mfma_f32_16x16x32_bf16 v[192:195], v[28:31], v[88:91], v[192:195]
    s_waitcnt lgkmcnt(3)
    v_mfma_f32_16x16x32_bf16 v[192:195], v[32:35], v[96:99], v[192:195]
    v_max3_f32 v14, v14, v184, v185
    s_waitcnt lgkmcnt(2)
    v_mfma_f32_16x16x32_bf16 v[192:195], v[36:39], v[104:107], v[192:195]
    s_waitcnt lgkmcnt(1)
    v_mfma_f32_16x16x32_bf16 v[192:195], v[40:43], v[112:115], v[192:195]
    s_waitcnt lgkmcnt(0)
    v_mfma_f32_16x16x32_bf16 v[192:195], v[44:47], v[120:123], v[192:195]
    v_max3_f32 v15, v15, v188, v189
    v_mfma_f32_16x16x32_bf16 v[196:199], v[24:27], v[84:87], 0
    v_mfma_f32_16x16x32_bf16 v[196:199], v[28:31], v[92:95], v[196:199]
    v_mfma_f32_16x16x32_bf16 v[196:199], v[32:35], v[100:103], v[196:199]
    v_max3_f32 v14, v14, v186, v187
    v_mfma_f32_16x16x32_bf16 v[196:199], v[36:39], v[108:111], v[196:199]
    v_mfma_f32_16x16x32_bf16 v[196:199], v[40:43], v[116:119], v[196:199]
    v_mfma_f32_16x16x32_bf16 v[196:199], v[44:47], v[124:127], v[196:199]
    v_max3_f32 v15, v15, v190, v191
    s_waitcnt vmcnt(7) lgkmcnt(0)
    s_barrier
    ds_read_b128 v[24:27], v4 offset:12288
    ds_read_b128 v[28:31], v5 offset:12288
    ds_read_b128 v[32:35], v4 offset:12416
    ds_read_b128 v[36:39], v5 offset:12416
    ds_read_b128 v[40:43], v4 offset:12544
    ds_read_b128 v[44:47], v5 offset:12544
    s_waitcnt lgkmcnt(5)
    v_mfma_f32_16x16x32_bf16 v[200:203], v[24:27], v[80:83], 0
    s_waitcnt lgkmcnt(4)
    v_mfma_f32_16x16x32_bf16 v[200:203], v[28:31], v[88:91], v[200:203]
    s_waitcnt lgkmcnt(3)
    v_mfma_f32_16x16x32_bf16 v[200:203], v[32:35], v[96:99], v[200:203]
    v_max3_f32 v14, v14, v192, v193
    s_waitcnt lgkmcnt(2)
    v_mfma_f32_16x16x32_bf16 v[200:203], v[36:39], v[104:107], v[200:203]
    s_waitcnt lgkmcnt(1)
    v_mfma_f32_16x16x32_bf16 v[200:203], v[40:43], v[112:115], v[200:203]
    s_waitcnt lgkmcnt(0)
    v_mfma_f32_16x16x32_bf16 v[200:203], v[44:47], v[120:123], v[200:203]
    v_max3_f32 v15, v15, v196, v197
    v_mfma_f32_16x16x32_bf16 v[204:207], v[24:27], v[84:87], 0
    v_mfma_f32_16x16x32_bf16 v[204:207], v[28:31], v[92:95], v[204:207]
    v_mfma_f32_16x16x32_bf16 v[204:207], v[32:35], v[100:103], v[204:207]
    v_max3_f32 v14, v14, v194, v195
    v_mfma_f32_16x16x32_bf16 v[204:207], v[36:39], v[108:111], v[204:207]
    v_mfma_f32_16x16x32_bf16 v[204:207], v[40:43], v[116:119], v[204:207]
    v_mfma_f32_16x16x32_bf16 v[204:207], v[44:47], v[124:127], v[204:207]
    v_max3_f32 v15, v15, v198, v199
    s_waitcnt vmcnt(4) lgkmcnt(0)
    s_barrier
    s_add_u32 m0, s51, 0
    s_nop 0
    buffer_load_dwordx4 v1, s[8:11], s52 offen offset:0 nt lds
    buffer_load_dwordx4 v2, s[8:11], s52 offen offset:1024 nt lds
    buffer_load_dwordx4 v3, s[8:11], s52 offen offset:2048 nt lds
    s_add_u32 m0, s51, 12288
    s_add_u32 s52, s52, 12288
    buffer_load_dwordx4 v1, s[8:11], s52 offen offset:0 nt lds
    buffer_load_dwordx4 v2, s[8:11], s52 offen offset:1024 nt lds
    buffer_load_dwordx4 v3, s[8:11], s52 offen offset:2048 nt lds
    s_add_u32 s52, s52, 12288
    s_lshl_b32 s57, s50, 4
    s_add_u32 s57, s57, 5
    s_bitcmp1_b64 s[100:101], s57
    s_cselect_b32 s57, s55, 1073741824
    s_mov_b32 exec_hi, 0
    buffer_load_dword v23, v22, s[60:63], s57 offen
    s_mov_b64 exec, -1
    ds_read_b128 v[24:27], v4 offset:24576
    ds_read_b128 v[28:31], v5 offset:24576
    ds_read_b128 v[32:35], v4 offset:24704
    ds_read_b128 v[36:39], v5 offset:24704
    ds_read_b128 v[40:43], v4 offset:24832
    ds_read_b128 v[44:47], v5 offset:24832
    s_waitcnt lgkmcnt(5)
    v_mfma_f32_16x16x32_bf16 v[208:211], v[24:27], v[80:83], 0
    s_waitcnt lgkmcnt(4)
    v_mfma_f32_16x16x32_bf16 v[208:211], v[28:31], v[88:91], v[208:211]
    s_waitcnt lgkmcnt(3)
    v_mfma_f32_16x16x32_bf16 v[208:211], v[32:35], v[96:99], v[208:211]
    v_max3_f32 v14, v14, v200, v201
    s_waitcnt lgkmcnt(2)
    v_mfma_f32_16x16x32_bf16 v[208:211], v[36:39], v[104:107], v[208:211]
    s_waitcnt lgkmcnt(1)
    v_mfma_f32_16x16x32_bf16 v[208:211], v[40:43], v[112:115], v[208:211]
    s_waitcnt lgkmcnt(0)
    v_mfma_f32_16x16x32_bf16 v[208:211], v[44:47], v[120:123], v[208:211]
    v_max3_f32 v15, v15, v204, v205
    v_mfma_f32_16x16x32_bf16 v[212:215], v[24:27], v[84:87], 0
    v_mfma_f32_16x16x32_bf16 v[212:215], v[28:31], v[92:95], v[212:215]
    v_mfma_f32_16x16x32_bf16 v[212:215], v[32:35], v[100:103], v[212:215]
    v_max3_f32 v14, v14, v202, v203
    v_mfma_f32_16x16x32_bf16 v[212:215], v[36:39], v[108:111], v[212:215]
    v_mfma_f32_16x16x32_bf16 v[212:215], v[40:43], v[116:119], v[212:215]
    v_mfma_f32_16x16x32_bf16 v[212:215], v[44:47], v[124:127], v[212:215]
    v_max3_f32 v15, v15, v206, v207
    s_waitcnt vmcnt(7) lgkmcnt(0)
    s_barrier
    ds_read_b128 v[24:27], v4 offset:36864
    ds_read_b128 v[28:31], v5 offset:36864
    ds_read_b128 v[32:35], v4 offset:36992
    ds_read_b128 v[36:39], v5 offset:36992
    ds_read_b128 v[40:43], v4 offset:37120
    ds_read_b128 v[44:47], v5 offset:37120
    s_waitcnt lgkmcnt(5)
    v_mfma_f32_16x16x32_bf16 v[216:219], v[24:27], v[80:83], 0
    s_waitcnt lgkmcnt(4)
    v_mfma_f32_16x16x32_bf16 v[216:219], v[28:31], v[88:91], v[216:219]
    s_waitcnt lgkmcnt(3)
    v_mfma_f32_16x16x32_bf16 v[216:219], v[32:35], v[96:99], v[216:219]
    v_max3_f32 v14, v14, v208, v209
    s_waitcnt lgkmcnt(2)
    v_mfma_f32_16x16x32_bf16 v[216:219], v[36:39], v[104:107], v[216:219]
    s_waitcnt lgkmcnt(1)
    v_mfma_f32_16x16x32_bf16 v[216:219], v[40:43], v[112:115], v[216:219]
    s_waitcnt lgkmcnt(0)
    v_mfma_f32_16x16x32_bf16 v[216:219], v[44:47], v[120:123], v[216:219]
    v_max3_f32 v15, v15, v212, v213
    v_mfma_f32_16x16x32_bf16 v[220:223], v[24:27], v[84:87], 0
    v_mfma_f32_16x16x32_bf16 v[220:223], v[28:31], v[92:95], v[220:223]
    v_mfma_f32_16x16x32_bf16 v[220:223], v[32:35], v[100:103], v[220:223]
    v_max3_f32 v14, v14, v210, v211
    v_mfma_f32_16x16x32_bf16 v[220:223], v[36:39], v[108:111], v[220:223]
    v_mfma_f32_16x16x32_bf16 v[220:223], v[40:43], v[116:119], v[220:223]
    v_mfma_f32_16x16x32_bf16 v[220:223], v[44:47], v[124:127], v[220:223]
    v_max3_f32 v15, v15, v214, v215
    s_waitcnt vmcnt(4) lgkmcnt(0)
    s_barrier
    s_add_u32 m0, s51, 24576
    s_nop 0
    buffer_load_dwordx4 v1, s[8:11], s52 offen offset:0 nt lds
    buffer_load_dwordx4 v2, s[8:11], s52 offen offset:1024 nt lds
    buffer_load_dwordx4 v3, s[8:11], s52 offen offset:2048 nt lds
    s_add_u32 m0, s51, 36864
    s_add_u32 s52, s52, 12288
    buffer_load_dwordx4 v1, s[8:11], s52 offen offset:0 nt lds
    buffer_load_dwordx4 v2, s[8:11], s52 offen offset:1024 nt lds
    buffer_load_dwordx4 v3, s[8:11], s52 offen offset:2048 nt lds
    s_add_u32 s52, s52, 12288
    s_lshl_b32 s57, s50, 4
    s_add_u32 s57, s57, 6
    s_bitcmp1_b64 s[100:101], s57
    s_cselect_b32 s57, s55, 1073741824
    s_cselect_b32 s59, s56, 0
    s_mov_b32 exec_lo, 0
    buffer_load_dword v23, v22, s[60:63], s57 offen
    s_mov_b64 exec, -1
    s_add_u32 s55, s55, s59
    ds_read_b128 v[24:27], v4 offset:0
    ds_read_b128 v[28:31], v5 offset:0
    ds_read_b128 v[32:35], v4 offset:128
    ds_read_b128 v[36:39], v5 offset:128
    ds_read_b128 v[40:43], v4 offset:256
    ds_read_b128 v[44:47], v5 offset:256
    s_waitcnt lgkmcnt(5)
    v_mfma_f32_16x16x32_bf16 v[224:227], v[24:27], v[80:83], 0
    s_waitcnt lgkmcnt(4)
    v_mfma_f32_16x16x32_bf16 v[224:227], v[28:31], v[88:91], v[224:227]
    s_waitcnt lgkmcnt(3)
    v_mfma_f32_16x16x32_bf16 v[224:227], v[32:35], v[96:99], v[224:227]
    v_max3_f32 v14, v14, v216, v217
    s_waitcnt lgkmcnt(2)
    v_mfma_f32_16x16x32_bf16 v[224:227], v[36:39], v[104:107], v[224:227]
    s_waitcnt lgkmcnt(1)
    v_mfma_f32_16x16x32_bf16 v[224:227], v[40:43], v[112:115], v[224:227]
    s_waitcnt lgkmcnt(0)
    v_mfma_f32_16x16x32_bf16 v[224:227], v[44:47], v[120:123], v[224:227]
    v_max3_f32 v15, v15, v220, v221
    v_mfma_f32_16x16x32_bf16 v[228:231], v[24:27], v[84:87], 0
    v_mfma_f32_16x16x32_bf16 v[228:231], v[28:31], v[92:95], v[228:231]
    v_mfma_f32_16x16x32_bf16 v[228:231], v[32:35], v[100:103], v[228:231]
    v_max3_f32 v14, v14, v218, v219
    v_mfma_f32_16x16x32_bf16 v[228:231], v[36:39], v[108:111], v[228:231]
    v_mfma_f32_16x16x32_bf16 v[228:231], v[40:43], v[116:119], v[228:231]
    v_mfma_f32_16x16x32_bf16 v[228:231], v[44:47], v[124:127], v[228:231]
    v_max3_f32 v15, v15, v222, v223
    s_waitcnt vmcnt(7) lgkmcnt(0)
    s_barrier
    ds_read_b128 v[24:27], v4 offset:12288
    ds_read_b128 v[28:31], v5 offset:12288
    ds_read_b128 v[32:35], v4 offset:12416
    ds_read_b128 v[36:39], v5 offset:12416
    ds_read_b128 v[40:43], v4 offset:12544
    ds_read_b128 v[44:47], v5 offset:12544
    s_waitcnt lgkmcnt(5)
    v_mfma_f32_16x16x32_bf16 v[232:235], v[24:27], v[80:83], 0
    s_waitcnt lgkmcnt(4)
    v_mfma_f32_16x16x32_bf16 v[232:235], v[28:31], v[88:91], v[232:235]
    s_waitcnt lgkmcnt(3)
    v_mfma_f32_16x16x32_bf16 v[232:235], v[32:35], v[96:99], v[232:235]
    v_max3_f32 v14, v14, v224, v225
    s_waitcnt lgkmcnt(2)
    v_mfma_f32_16x16x32_bf16 v[232:235], v[36:39], v[104:107], v[232:235]
    s_waitcnt lgkmcnt(1)
    v_mfma_f32_16x16x32_bf16 v[232:235], v[40:43], v[112:115], v[232:235]
    s_waitcnt lgkmcnt(0)
    v_mfma_f32_16x16x32_bf16 v[232:235], v[44:47], v[120:123], v[232:235]
    v_max3_f32 v15, v15, v228, v229
    v_mfma_f32_16x16x32_bf16 v[236:239], v[24:27], v[84:87], 0
    v_mfma_f32_16x16x32_bf16 v[236:239], v[28:31], v[92:95], v[236:239]
    v_mfma_f32_16x16x32_bf16 v[236:239], v[32:35], v[100:103], v[236:239]
    v_max3_f32 v14, v14, v226, v227
    v_mfma_f32_16x16x32_bf16 v[236:239], v[36:39], v[108:111], v[236:239]
    v_mfma_f32_16x16x32_bf16 v[236:239], v[40:43], v[116:119], v[236:239]
    v_mfma_f32_16x16x32_bf16 v[236:239], v[44:47], v[124:127], v[236:239]
    v_max3_f32 v15, v15, v230, v231
    s_waitcnt vmcnt(4) lgkmcnt(0)
    s_barrier
    s_add_u32 m0, s51, 0
    s_nop 0
    buffer_load_dwordx4 v1, s[12:15], s53 offen offset:0 nt lds
    buffer_load_dwordx4 v2, s[12:15], s53 offen offset:1024 nt lds
    buffer_load_dwordx4 v3, s[12:15], s53 offen offset:2048 nt lds
    s_add_u32 m0, s51, 12288
    s_add_u32 s53, s53, 12288
    buffer_load_dwordx4 v1, s[12:15], s53 offen offset:0 nt lds
    buffer_load_dwordx4 v2, s[12:15], s53 offen offset:1024 nt lds
    buffer_load_dwordx4 v3, s[12:15], s53 offen offset:2048 nt lds
    s_add_u32 s53, s53, 12288
    s_lshl_b32 s57, s50, 4
    s_add_u32 s57, s57, 7
    s_bitcmp1_b64 s[100:101], s57
    s_cselect_b32 s57, s55, 1073741824
    s_mov_b32 exec_hi, 0
    buffer_load_dword v23, v22, s[60:63], s57 offen
    s_mov_b64 exec, -1
    ds_read_b128 v[24:27], v4 offset:24576
    ds_read_b128 v[28:31], v5 offset:24576
    ds_read_b128 v[32:35], v4 offset:24704
    ds_read_b128 v[36:39], v5 offset:24704
    ds_read_b128 v[40:43], v4 offset:24832
    ds_read_b128 v[44:47], v5 offset:24832
    s_waitcnt lgkmcnt(5)
    v_mfma_f32_16x16x32_bf16 v[240:243], v[24:27], v[80:83], 0
    s_waitcnt lgkmcnt(4)
    v_mfma_f32_16x16x32_bf16 v[240:243], v[28:31], v[88:91], v[240:243]
    s_waitcnt lgkmcnt(3)
    v_mfma_f32_16x16x32_bf16 v[240:243], v[32:35], v[96:99], v[240:243]
    v_max3_f32 v14, v14, v232, v233
    s_waitcnt lgkmcnt(2)
    v_mfma_f32_16x16x32_bf16 v[240:243], v[36:39], v[104:107], v[240:243]
    s_waitcnt lgkmcnt(1)
    v_mfma_f32_16x16x32_bf16 v[240:243], v[40:43], v[112:115], v[240:243]
    s_waitcnt lgkmcnt(0)
    v_mfma_f32_16x16x32_bf16 v[240:243], v[44:47], v[120:123], v[240:243]
    v_max3_f32 v15, v15, v236, v237
    v_mfma_f32_16x16x32_bf16 v[244:247], v[24:27], v[84:87], 0
    v_mfma_f32_16x16x32_bf16 v[244:247], v[28:31], v[92:95], v[244:247]
    v_mfma_f32_16x16x32_bf16 v[244:247], v[32:35], v[100:103], v[244:247]
    v_max3_f32 v14, v14, v234, v235
    v_mfma_f32_16x16x32_bf16 v[244:247], v[36:39], v[108:111], v[244:247]
    v_mfma_f32_16x16x32_bf16 v[244:247], v[40:43], v[116:119], v[244:247]
    v_mfma_f32_16x16x32_bf16 v[244:247], v[44:47], v[124:127], v[244:247]
    v_max3_f32 v15, v15, v238, v239
    s_waitcnt vmcnt(7) lgkmcnt(0)
    s_barrier
    ds_read_b128 v[24:27], v4 offset:36864
    ds_read_b128 v[28:31], v5 offset:36864
    ds_read_b128 v[32:35], v4 offset:36992
    ds_read_b128 v[36:39], v5 offset:36992
    ds_read_b128 v[40:43], v4 offset:37120
    ds_read_b128 v[44:47], v5 offset:37120
    s_waitcnt lgkmcnt(5)
    v_mfma_f32_16x16x32_bf16 v[248:251], v[24:27], v[80:83], 0
    s_waitcnt lgkmcnt(4)
    v_mfma_f32_16x16x32_bf16 v[248:251], v[28:31], v[88:91], v[248:251]
    s_waitcnt lgkmcnt(3)
    v_mfma_f32_16x16x32_bf16 v[248:251], v[32:35], v[96:99], v[248:251]
    v_max3_f32 v14, v14, v240, v241
    s_waitcnt lgkmcnt(2)
    v_mfma_f32_16x16x32_bf16 v[248:251], v[36:39], v[104:107], v[248:251]
    s_waitcnt lgkmcnt(1)
    v_mfma_f32_16x16x32_bf16 v[248:251], v[40:43], v[112:115], v[248:251]
    s_waitcnt lgkmcnt(0)
    v_mfma_f32_16x16x32_bf16 v[248:251], v[44:47], v[120:123], v[248:251]
    v_max3_f32 v15, v15, v244, v245
    v_mfma_f32_16x16x32_bf16 v[252:255], v[24:27], v[84:87], 0
    v_mfma_f32_16x16x32_bf16 v[252:255], v[28:31], v[92:95], v[252:255]
    v_mfma_f32_16x16x32_bf16 v[252:255], v[32:35], v[100:103], v[252:255]
    v_max3_f32 v14, v14, v242, v243
    v_mfma_f32_16x16x32_bf16 v[252:255], v[36:39], v[108:111], v[252:255]
    v_mfma_f32_16x16x32_bf16 v[252:255], v[40:43], v[116:119], v[252:255]
    v_mfma_f32_16x16x32_bf16 v[252:255], v[44:47], v[124:127], v[252:255]
    v_max3_f32 v15, v15, v246, v247
    v_max3_f32 v14, v14, v248, v249
    s_nop 5
    v_max3_f32 v15, v15, v252, v253
    v_max3_f32 v14, v14, v250, v251
    v_max3_f32 v15, v15, v254, v255
    v_mov_b32 v20, v14
    v_mov_b32 v21, v15
    s_nop 0
    v_permlane32_swap_b32 v14, v20
    v_permlane32_swap_b32 v15, v21
    v_max_f32 v14, v14, v20
    v_max_f32 v15, v15, v21
    v_mov_b32 v20, v14
    v_mov_b32 v21, v15
    s_nop 0
    v_permlane16_swap_b32 v14, v20
    v_permlane16_swap_b32 v15, v21
    v_max_f32 v14, v14, v20
    v_max_f32 v15, v15, v21
    ds_write_b64 v52, v[14:15] offset:4096
    s_waitcnt vmcnt(4) lgkmcnt(0)
    s_barrier
    ds_read_b64 v[20:21], v53 offset:4096
    ds_read_b64_tr_b16 v[24:25], v6 offset:0
    ds_read_b64_tr_b16 v[26:27], v10 offset:0
    ds_read_b64_tr_b16 v[28:29], v7 offset:0
    ds_read_b64_tr_b16 v[30:31], v11 offset:0
    ds_read_b64_tr_b16 v[32:33], v8 offset:0
    ds_read_b64_tr_b16 v[34:35], v12 offset:0
    ds_read_b64_tr_b16 v[36:37], v9 offset:0
    ds_read_b64_tr_b16 v[38:39], v13 offset:0
    ds_read_b64_tr_b16 v[40:41], v6 offset:128
    ds_read_b64_tr_b16 v[42:43], v10 offset:128
    ds_read_b64_tr_b16 v[44:45], v7 offset:128
    ds_read_b64_tr_b16 v[46:47], v11 offset:128
    s_add_u32 m0, s51, 24576
    s_nop 0
    buffer_load_dwordx4 v1, s[12:15], s53 offen offset:0 nt lds
    s_waitcnt lgkmcnt(12)
    v_max_f32 v14, v14, v20
    v_max_f32 v15, v15, v21
    v_mul_f32 v14, s54, v14
    v_mul_f32 v15, s54, v15
    v_fma_f32 v128, v128, s54, -v14
    buffer_load_dwordx4 v2, s[12:15], s53 offen offset:1024 nt lds
    v_fma_f32 v129, v129, s54, -v14
    v_fma_f32 v130, v130, s54, -v14
    v_fma_f32 v131, v131, s54, -v14
    v_fma_f32 v132, v132, s54, -v15
    v_fma_f32 v133, v133, s54, -v15
    v_fma_f32 v134, v134, s54, -v15
    buffer_load_dwordx4 v3, s[12:15], s53 offen offset:2048 nt lds
    v_fma_f32 v135, v135, s54, -v15
    v_exp_f32 v128, v128
    v_exp_f32 v129, v129
    v_exp_f32 v130, v130
    v_exp_f32 v131, v131
    v_exp_f32 v132, v132
    s_add_u32 m0, s51, 36864
    s_add_u32 s53, s53, 12288
    buffer_load_dwordx4 v1, s[12:15], s53 offen offset:0 nt lds
    v_exp_f32 v133, v133
    v_exp_f32 v134, v134
    v_exp_f32 v135, v135
    v_mov_b32 v16, v128
    v_mov_b32 v17, v132
    buffer_load_dwordx4 v2, s[12:15], s53 offen offset:1024 nt lds
    v_add_f32 v16, v16, v129
    v_add_f32 v17, v17, v133
    v_add_f32 v16, v16, v130
    v_add_f32 v17, v17, v134
    v_add_f32 v16, v16, v131
    v_add_f32 v17, v17, v135
    buffer_load_dwordx4 v3, s[12:15], s53 offen offset:2048 nt lds
    v_cvt_pk_bf16_f32 v128, v128, v129
    v_cvt_pk_bf16_f32 v129, v130, v131
    v_cvt_pk_bf16_f32 v132, v132, v133
    v_cvt_pk_bf16_f32 v133, v134, v135
    ds_write_b64 v52, v[128:129] offset:0
    ds_write_b64 v52, v[132:133] offset:512
    s_add_u32 s53, s53, 12288
    s_lshl_b32 s57, s50, 4
    s_add_u32 s57, s57, 8
    s_bitcmp1_b64 s[100:101], s57
    s_cselect_b32 s57, s55, 1073741824
    s_cselect_b32 s59, s56, 0
    s_mov_b32 exec_lo, 0
    buffer_load_dword v23, v22, s[60:63], s57 offen
    s_mov_b64 exec, -1
    s_add_u32 s55, s55, s59
    s_waitcnt lgkmcnt(0)
    s_barrier
    ds_read_b64 v[130:131], v53 offset:0
    ds_read_b64 v[134:135], v53 offset:512
    s_waitcnt lgkmcnt(1)
    v_mfma_f32_16x16x32_bf16 v[80:83], v[24:27], v[128:131], 0
    v_fma_f32 v136, v136, s54, -v14
    v_fma_f32 v137, v137, s54, -v14
    v_fma_f32 v138, v138, s54, -v14
    s_waitcnt lgkmcnt(0)
    v_mfma_f32_16x16x32_bf16 v[84:87], v[24:27], v[132:135], 0
    v_fma_f32 v139, v139, s54, -v14
    v_fma_f32 v140, v140, s54, -v15
    v_fma_f32 v141, v141, s54, -v15
    v_mfma_f32_16x16x32_bf16 v[88:91], v[28:31], v[128:131], 0
    v_fma_f32 v142, v142, s54, -v15
    v_fma_f32 v143, v143, s54, -v15
    v_exp_f32 v136, v136
    v_exp_f32 v137, v137
    v_mfma_f32_16x16x32_bf16 v[92:95], v[28:31], v[132:135], 0
    v_exp_f32 v138, v138
    v_exp_f32 v139, v139
    v_exp_f32 v140, v140
    v_mfma_f32_16x16x32_bf16 v[96:99], v[32:35], v[128:131], 0
    v_exp_f32 v141, v141
    v_exp_f32 v142, v142
    v_exp_f32 v143, v143
    v_mfma_f32_16x16x32_bf16 v[100:103], v[32:35], v[132:135], 0
    v_add_f32 v16, v16, v136
    v_add_f32 v17, v17, v140
    v_add_f32 v16, v16, v137
    v_add_f32 v17, v17, v141
    v_mfma_f32_16x16x32_bf16 v[104:107], v[36:39], v[128:131], 0
    v_add_f32 v16, v16, v138
    v_add_f32 v17, v17, v142
    v_add_f32 v16, v16, v139
    v_mfma_f32_16x16x32_bf16 v[108:111], v[36:39], v[132:135], 0
    v_add_f32 v17, v17, v143
    v_cvt_pk_bf16_f32 v136, v136, v137
    v_cvt_pk_bf16_f32 v137, v138, v139
    v_mfma_f32_16x16x32_bf16 v[112:115], v[40:43], v[128:131], 0
    v_cvt_pk_bf16_f32 v140, v140, v141
    v_cvt_pk_bf16_f32 v141, v142, v143
    ds_write_b64 v52, v[136:137] offset:4096
    ds_write_b64 v52, v[140:141] offset:4608
    v_mfma_f32_16x16x32_bf16 v[116:119], v[40:43], v[132:135], 0
    v_mfma_f32_16x16x32_bf16 v[120:123], v[44:47], v[128:131], 0
    v_mfma_f32_16x16x32_bf16 v[124:127], v[44:47], v[132:135], 0
    s_waitcnt vmcnt(7) lgkmcnt(0)
    s_barrier
    ds_read_b64 v[138:139], v53 offset:4096
    ds_read_b64 v[142:143], v53 offset:4608
    ds_read_b64_tr_b16 v[24:25], v6 offset:12288
    ds_read_b64_tr_b16 v[26:27], v10 offset:12288
    ds_read_b64_tr_b16 v[28:29], v7 offset:12288
    ds_read_b64_tr_b16 v[30:31], v11 offset:12288
    ds_read_b64_tr_b16 v[32:33], v8 offset:12288
    ds_read_b64_tr_b16 v[34:35], v12 offset:12288
    ds_read_b64_tr_b16 v[36:37], v9 offset:12288
    ds_read_b64_tr_b16 v[38:39], v13 offset:12288
    s_waitcnt lgkmcnt(6)
    v_mfma_f32_16x16x32_bf16 v[80:83], v[24:27], v[136:139], v[80:83]
    ds_read_b64_tr_b16 v[40:41], v6 offset:12416
    ds_read_b64_tr_b16 v[42:43], v10 offset:12416
    v_fma_f32 v144, v144, s54, -v14
    v_fma_f32 v145, v145, s54, -v14
    v_fma_f32 v146, v146, s54, -v14
    v_mfma_f32_16x16x32_bf16 v[84:87], v[24:27], v[140:143], v[84:87]
    v_fma_f32 v147, v147, s54, -v14
    v_fma_f32 v148, v148, s54, -v15
    v_fma_f32 v149, v149, s54, -v15
    s_waitcnt lgkmcnt(6)
    v_mfma_f32_16x16x32_bf16 v[88:91], v[28:31], v[136:139], v[88:91]
    ds_read_b64_tr_b16 v[44:45], v7 offset:12416
    ds_read_b64_tr_b16 v[46:47], v11 offset:12416
    v_fma_f32 v150, v150, s54, -v15
    v_fma_f32 v151, v151, s54, -v15
    v_exp_f32 v144, v144
    v_exp_f32 v145, v145
    v_mfma_f32_16x16x32_bf16 v[92:95], v[28:31], v[140:143], v[92:95]
    v_exp_f32 v146, v146
    v_exp_f32 v147, v147
    v_exp_f32 v148, v148
    s_waitcnt lgkmcnt(6)
    v_mfma_f32_16x16x32_bf16 v[96:99], v[32:35], v[136:139], v[96:99]
    v_exp_f32 v149, v149
    v_exp_f32 v150, v150
    v_exp_f32 v151, v151
    v_mfma_f32_16x16x32_bf16 v[100:103], v[32:35], v[140:143], v[100:103]
    v_add_f32 v16, v16, v144
    v_add_f32 v17, v17, v148
    v_add_f32 v16, v16, v145
    v_add_f32 v17, v17, v149
    s_waitcnt lgkmcnt(4)
    v_mfma_f32_16x16x32_bf16 v[104:107], v[36:39], v[136:139], v[104:107]
    v_add_f32 v16, v16, v146
    v_add_f32 v17, v17, v150
    v_add_f32 v16, v16, v147
    v_mfma_f32_16x16x32_bf16 v[108:111], v[36:39], v[140:143], v[108:111]
    v_add_f32 v17, v17, v151
    v_cvt_pk_bf16_f32 v144, v144, v145
    v_cvt_pk_bf16_f32 v145, v146, v147
    s_waitcnt lgkmcnt(2)
    v_mfma_f32_16x16x32_bf16 v[112:115], v[40:43], v[136:139], v[112:115]
    v_cvt_pk_bf16_f32 v148, v148, v149
    v_cvt_pk_bf16_f32 v149, v150, v151
    ds_write_b64 v52, v[144:145] offset:0
    ds_write_b64 v52, v[148:149] offset:512
    v_mfma_f32_16x16x32_bf16 v[116:119], v[40:43], v[140:143], v[116:119]
    s_waitcnt lgkmcnt(2)
    v_mfma_f32_16x16x32_bf16 v[120:123], v[44:47], v[136:139], v[120:123]
    v_mfma_f32_16x16x32_bf16 v[124:127], v[44:47], v[140:143], v[124:127]
    s_waitcnt vmcnt(4) lgkmcnt(0)
    s_barrier
    s_add_u32 m0, s51, 0
    s_nop 0
    buffer_load_dwordx4 v1, s[12:15], s53 offen offset:0 nt lds
    buffer_load_dwordx4 v2, s[12:15], s53 offen offset:1024 nt lds
    buffer_load_dwordx4 v3, s[12:15], s53 offen offset:2048 nt lds
    s_add_u32 m0, s51, 12288
    s_add_u32 s53, s53, 12288
    buffer_load_dwordx4 v1, s[12:15], s53 offen offset:0 nt lds
    buffer_load_dwordx4 v2, s[12:15], s53 offen offset:1024 nt lds
    buffer_load_dwordx4 v3, s[12:15], s53 offen offset:2048 nt lds
    s_add_u32 s53, s53, 12288
    s_lshl_b32 s57, s50, 4
    s_add_u32 s57, s57, 9
    s_bitcmp1_b64 s[100:101], s57
    s_cselect_b32 s57, s55, 1073741824
    s_mov_b32 exec_hi, 0
    buffer_load_dword v23, v22, s[60:63], s57 offen
    s_mov_b64 exec, -1
    ds_read_b64 v[146:147], v53 offset:0
    ds_read_b64 v[150:151], v53 offset:512
    ds_read_b64_tr_b16 v[24:25], v6 offset:24576
    ds_read_b64_tr_b16 v[26:27], v10 offset:24576
    ds_read_b64_tr_b16 v[28:29], v7 offset:24576
    ds_read_b64_tr_b16 v[30:31], v11 offset:24576
    ds_read_b64_tr_b16 v[32:33], v8 offset:24576
    ds_read_b64_tr_b16 v[34:35], v12 offset:24576
    ds_read_b64_tr_b16 v[36:37], v9 offset:24576
    ds_read_b64_tr_b16 v[38:39], v13 offset:24576
    s_waitcnt lgkmcnt(6)
    v_mfma_f32_16x16x32_bf16 v[80:83], v[24:27], v[144:147], v[80:83]
    ds_read_b64_tr_b16 v[40:41], v6 offset:24704
    ds_read_b64_tr_b16 v[42:43], v10 offset:24704
    v_fma_f32 v152, v152, s54, -v14
    v_fma_f32 v153, v153, s54, -v14
    v_fma_f32 v154, v154, s54, -v14
    v_mfma_f32_16x16x32_bf16 v[84:87], v[24:27], v[148:151], v[84:87]
    v_fma_f32 v155, v155, s54, -v14
    v_fma_f32 v156, v156, s54, -v15
    v_fma_f32 v157, v157, s54, -v15
    s_waitcnt lgkmcnt(6)
    v_mfma_f32_16x16x32_bf16 v[88:91], v[28:31], v[144:147], v[88:91]
    ds_read_b64_tr_b16 v[44:45], v7 offset:24704
    ds_read_b64_tr_b16 v[46:47], v11 offset:24704
    v_fma_f32 v158, v158, s54, -v15
    v_fma_f32 v159, v159, s54, -v15
    v_exp_f32 v152, v152
    v_exp_f32 v153, v153
    v_mfma_f32_16x16x32_bf16 v[92:95], v[28:31], v[148:151], v[92:95]
    v_exp_f32 v154, v154
    v_exp_f32 v155, v155
    v_exp_f32 v156, v156
    s_waitcnt lgkmcnt(6)
    v_mfma_f32_16x16x32_bf16 v[96:99], v[32:35], v[144:147], v[96:99]
    v_exp_f32 v157, v157
    v_exp_f32 v158, v158
    v_exp_f32 v159, v159
    v_mfma_f32_16x16x32_bf16 v[100:103], v[32:35], v[148:151], v[100:103]
    v_add_f32 v16, v16, v152
    v_add_f32 v17, v17, v156
    v_add_f32 v16, v16, v153
    v_add_f32 v17, v17, v157
    s_waitcnt lgkmcnt(4)
    v_mfma_f32_16x16x32_bf16 v[104:107], v[36:39], v[144:147], v[104:107]
    v_add_f32 v16, v16, v154
    v_add_f32 v17, v17, v158
    v_add_f32 v16, v16, v155
    v_mfma_f32_16x16x32_bf16 v[108:111], v[36:39], v[148:151], v[108:111]
    v_add_f32 v17, v17, v159
    v_cvt_pk_bf16_f32 v152, v152, v153
    v_cvt_pk_bf16_f32 v153, v154, v155
    s_waitcnt lgkmcnt(2)
    v_mfma_f32_16x16x32_bf16 v[112:115], v[40:43], v[144:147], v[112:115]
    v_cvt_pk_bf16_f32 v156, v156, v157
    v_cvt_pk_bf16_f32 v157, v158, v159
    ds_write_b64 v52, v[152:153] offset:4096
    ds_write_b64 v52, v[156:157] offset:4608
    v_mfma_f32_16x16x32_bf16 v[116:119], v[40:43], v[148:151], v[116:119]
    s_waitcnt lgkmcnt(2)
    v_mfma_f32_16x16x32_bf16 v[120:123], v[44:47], v[144:147], v[120:123]
    v_mfma_f32_16x16x32_bf16 v[124:127], v[44:47], v[148:151], v[124:127]
    s_waitcnt vmcnt(7) lgkmcnt(0)
    s_barrier
    ds_read_b64 v[154:155], v53 offset:4096
    ds_read_b64 v[158:159], v53 offset:4608
    ds_read_b64_tr_b16 v[24:25], v6 offset:36864
    ds_read_b64_tr_b16 v[26:27], v10 offset:36864
    ds_read_b64_tr_b16 v[28:29], v7 offset:36864
    ds_read_b64_tr_b16 v[30:31], v11 offset:36864
    ds_read_b64_tr_b16 v[32:33], v8 offset:36864
    ds_read_b64_tr_b16 v[34:35], v12 offset:36864
    ds_read_b64_tr_b16 v[36:37], v9 offset:36864
    ds_read_b64_tr_b16 v[38:39], v13 offset:36864
    s_waitcnt lgkmcnt(6)
    v_mfma_f32_16x16x32_bf16 v[80:83], v[24:27], v[152:155], v[80:83]
    ds_read_b64_tr_b16 v[40:41], v6 offset:36992
    ds_read_b64_tr_b16 v[42:43], v10 offset:36992
    v_fma_f32 v160, v160, s54, -v14
    v_fma_f32 v161, v161, s54, -v14
    v_fma_f32 v162, v162, s54, -v14
    v_mfma_f32_16x16x32_bf16 v[84:87], v[24:27], v[156:159], v[84:87]
    v_fma_f32 v163, v163, s54, -v14
    v_fma_f32 v164, v164, s54, -v15
    v_fma_f32 v165, v165, s54, -v15
    s_waitcnt lgkmcnt(6)
    v_mfma_f32_16x16x32_bf16 v[88:91], v[28:31], v[152:155], v[88:91]
    ds_read_b64_tr_b16 v[44:45], v7 offset:36992
    ds_read_b64_tr_b16 v[46:47], v11 offset:36992
    v_fma_f32 v166, v166, s54, -v15
    v_fma_f32 v167, v167, s54, -v15
    v_exp_f32 v160, v160
    v_exp_f32 v161, v161
    v_mfma_f32_16x16x32_bf16 v[92:95], v[28:31], v[156:159], v[92:95]
    v_exp_f32 v162, v162
    v_exp_f32 v163, v163
    v_exp_f32 v164, v164
    s_waitcnt lgkmcnt(6)
    v_mfma_f32_16x16x32_bf16 v[96:99], v[32:35], v[152:155], v[96:99]
    v_exp_f32 v165, v165
    v_exp_f32 v166, v166
    v_exp_f32 v167, v167
    v_mfma_f32_16x16x32_bf16 v[100:103], v[32:35], v[156:159], v[100:103]
    v_add_f32 v16, v16, v160
    v_add_f32 v17, v17, v164
    v_add_f32 v16, v16, v161
    v_add_f32 v17, v17, v165
    s_waitcnt lgkmcnt(4)
    v_mfma_f32_16x16x32_bf16 v[104:107], v[36:39], v[152:155], v[104:107]
    v_add_f32 v16, v16, v162
    v_add_f32 v17, v17, v166
    v_add_f32 v16, v16, v163
    v_mfma_f32_16x16x32_bf16 v[108:111], v[36:39], v[156:159], v[108:111]
    v_add_f32 v17, v17, v167
    v_cvt_pk_bf16_f32 v160, v160, v161
    v_cvt_pk_bf16_f32 v161, v162, v163
    s_waitcnt lgkmcnt(2)
    v_mfma_f32_16x16x32_bf16 v[112:115], v[40:43], v[152:155], v[112:115]
    v_cvt_pk_bf16_f32 v164, v164, v165
    v_cvt_pk_bf16_f32 v165, v166, v167
    ds_write_b64 v52, v[160:161] offset:0
    ds_write_b64 v52, v[164:165] offset:512
    v_mfma_f32_16x16x32_bf16 v[116:119], v[40:43], v[156:159], v[116:119]
    s_waitcnt lgkmcnt(2)
    v_mfma_f32_16x16x32_bf16 v[120:123], v[44:47], v[152:155], v[120:123]
    v_mfma_f32_16x16x32_bf16 v[124:127], v[44:47], v[156:159], v[124:127]
    s_waitcnt vmcnt(4) lgkmcnt(0)
    s_barrier
    s_add_u32 m0, s51, 24576
    s_nop 0
    buffer_load_dwordx4 v1, s[12:15], s53 offen offset:0 nt lds
    buffer_load_dwordx4 v2, s[12:15], s53 offen offset:1024 nt lds
    buffer_load_dwordx4 v3, s[12:15], s53 offen offset:2048 nt lds
    s_add_u32 m0, s51, 36864
    s_add_u32 s53, s53, 12288
    buffer_load_dwordx4 v1, s[12:15], s53 offen offset:0 nt lds
    buffer_load_dwordx4 v2, s[12:15], s53 offen offset:1024 nt lds
    buffer_load_dwordx4 v3, s[12:15], s53 offen offset:2048 nt lds
    s_add_u32 s53, s53, 12288
    s_lshl_b32 s57, s50, 4
    s_add_u32 s57, s57, 10
    s_bitcmp1_b64 s[100:101], s57
    s_cselect_b32 s57, s55, 1073741824
    s_cselect_b32 s59, s56, 0
    s_mov_b32 exec_lo, 0
    buffer_load_dword v23, v22, s[60:63], s57 offen
    s_mov_b64 exec, -1
    s_add_u32 s55, s55, s59
    ds_read_b64 v[162:163], v53 offset:0
    ds_read_b64 v[166:167], v53 offset:512
    ds_read_b64_tr_b16 v[24:25], v6 offset:0
    ds_read_b64_tr_b16 v[26:27], v10 offset:0
    ds_read_b64_tr_b16 v[28:29], v7 offset:0
    ds_read_b64_tr_b16 v[30:31], v11 offset:0
    ds_read_b64_tr_b16 v[32:33], v8 offset:0
    ds_read_b64_tr_b16 v[34:35], v12 offset:0
    ds_read_b64_tr_b16 v[36:37], v9 offset:0
    ds_read_b64_tr_b16 v[38:39], v13 offset:0
    s_waitcnt lgkmcnt(6)
    v_mfma_f32_16x16x32_bf16 v[80:83], v[24:27], v[160:163], v[80:83]
    ds_read_b64_tr_b16 v[40:41], v6 offset:128
    ds_read_b64_tr_b16 v[42:43], v10 offset:128
    v_fma_f32 v168, v168, s54, -v14
    v_fma_f32 v169, v169, s54, -v14
    v_fma_f32 v170, v170, s54, -v14
    v_mfma_f32_16x16x32_bf16 v[84:87], v[24:27], v[164:167], v[84:87]
    v_fma_f32 v171, v171, s54, -v14
    v_fma_f32 v172, v172, s54, -v15
    v_fma_f32 v173, v173, s54, -v15
    s_waitcnt lgkmcnt(6)
    v_mfma_f32_16x16x32_bf16 v[88:91], v[28:31], v[160:163], v[88:91]
    ds_read_b64_tr_b16 v[44:45], v7 offset:128
    ds_read_b64_tr_b16 v[46:47], v11 offset:128
    v_fma_f32 v174, v174, s54, -v15
    v_fma_f32 v175, v175, s54, -v15
    v_exp_f32 v168, v168
    v_exp_f32 v169, v169
    v_mfma_f32_16x16x32_bf16 v[92:95], v[28:31], v[164:167], v[92:95]
    v_exp_f32 v170, v170
    v_exp_f32 v171, v171
    v_exp_f32 v172, v172
    s_waitcnt lgkmcnt(6)
    v_mfma_f32_16x16x32_bf16 v[96:99], v[32:35], v[160:163], v[96:99]
    v_exp_f32 v173, v173
    v_exp_f32 v174, v174
    v_exp_f32 v175, v175
    v_mfma_f32_16x16x32_bf16 v[100:103], v[32:35], v[164:167], v[100:103]
    v_add_f32 v16, v16, v168
    v_add_f32 v17, v17, v172
    v_add_f32 v16, v16, v169
    v_add_f32 v17, v17, v173
    s_waitcnt lgkmcnt(4)
    v_mfma_f32_16x16x32_bf16 v[104:107], v[36:39], v[160:163], v[104:107]
    v_add_f32 v16, v16, v170
    v_add_f32 v17, v17, v174
    v_add_f32 v16, v16, v171
    v_mfma_f32_16x16x32_bf16 v[108:111], v[36:39], v[164:167], v[108:111]
    v_add_f32 v17, v17, v175
    v_cvt_pk_bf16_f32 v168, v168, v169
    v_cvt_pk_bf16_f32 v169, v170, v171
    s_waitcnt lgkmcnt(2)
    v_mfma_f32_16x16x32_bf16 v[112:115], v[40:43], v[160:163], v[112:115]
    v_cvt_pk_bf16_f32 v172, v172, v173
    v_cvt_pk_bf16_f32 v173, v174, v175
    ds_write_b64 v52, v[168:169] offset:4096
    ds_write_b64 v52, v[172:173] offset:4608
    v_mfma_f32_16x16x32_bf16 v[116:119], v[40:43], v[164:167], v[116:119]
    s_waitcnt lgkmcnt(2)
    v_mfma_f32_16x16x32_bf16 v[120:123], v[44:47], v[160:163], v[120:123]
    v_mfma_f32_16x16x32_bf16 v[124:127], v[44:47], v[164:167], v[124:127]
    s_waitcnt vmcnt(7) lgkmcnt(0)
    s_barrier
    ds_read_b64 v[170:171], v53 offset:4096
    ds_read_b64 v[174:175], v53 offset:4608
    ds_read_b64_tr_b16 v[24:25], v6 offset:12288
    ds_read_b64_tr_b16 v[26:27], v10 offset:12288
    ds_read_b64_tr_b16 v[28:29], v7 offset:12288
    ds_read_b64_tr_b16 v[30:31], v11 offset:12288
    ds_read_b64_tr_b16 v[32:33], v8 offset:12288
    ds_read_b64_tr_b16 v[34:35], v12 offset:12288
    ds_read_b64_tr_b16 v[36:37], v9 offset:12288
    ds_read_b64_tr_b16 v[38:39], v13 offset:12288
    s_waitcnt lgkmcnt(6)
    v_mfma_f32_16x16x32_bf16 v[80:83], v[24:27], v[168:171], v[80:83]
    ds_read_b64_tr_b16 v[40:41], v6 offset:12416
    ds_read_b64_tr_b16 v[42:43], v10 offset:12416
    v_fma_f32 v176, v176, s54, -v14
    v_fma_f32 v177, v177, s54, -v14
    v_fma_f32 v178, v178, s54, -v14
    v_mfma_f32_16x16x32_bf16 v[84:87], v[24:27], v[172:175], v[84:87]
    v_fma_f32 v179, v179, s54, -v14
    v_fma_f32 v180, v180, s54, -v15
    v_fma_f32 v181, v181, s54, -v15
    s_waitcnt lgkmcnt(6)
    v_mfma_f32_16x16x32_bf16 v[88:91], v[28:31], v[168:171], v[88:91]
    ds_read_b64_tr_b16 v[44:45], v7 offset:12416
    ds_read_b64_tr_b16 v[46:47], v11 offset:12416
    v_fma_f32 v182, v182, s54, -v15
    v_fma_f32 v183, v183, s54, -v15
    v_exp_f32 v176, v176
    v_exp_f32 v177, v177
    v_mfma_f32_16x16x32_bf16 v[92:95], v[28:31], v[172:175], v[92:95]
    v_exp_f32 v178, v178
    v_exp_f32 v179, v179
    v_exp_f32 v180, v180
    s_waitcnt lgkmcnt(6)
    v_mfma_f32_16x16x32_bf16 v[96:99], v[32:35], v[168:171], v[96:99]
    v_exp_f32 v181, v181
    v_exp_f32 v182, v182
    v_exp_f32 v183, v183
    v_mfma_f32_16x16x32_bf16 v[100:103], v[32:35], v[172:175], v[100:103]
    v_add_f32 v16, v16, v176
    v_add_f32 v17, v17, v180
    v_add_f32 v16, v16, v177
    v_add_f32 v17, v17, v181
    s_waitcnt lgkmcnt(4)
    v_mfma_f32_16x16x32_bf16 v[104:107], v[36:39], v[168:171], v[104:107]
    v_add_f32 v16, v16, v178
    v_add_f32 v17, v17, v182
    v_add_f32 v16, v16, v179
    v_mfma_f32_16x16x32_bf16 v[108:111], v[36:39], v[172:175], v[108:111]
    v_add_f32 v17, v17, v183
    v_cvt_pk_bf16_f32 v176, v176, v177
    v_cvt_pk_bf16_f32 v177, v178, v179
    s_waitcnt lgkmcnt(2)
    v_mfma_f32_16x16x32_bf16 v[112:115], v[40:43], v[168:171], v[112:115]
    v_cvt_pk_bf16_f32 v180, v180, v181
    v_cvt_pk_bf16_f32 v181, v182, v183
    ds_write_b64 v52, v[176:177] offset:0
    ds_write_b64 v52, v[180:181] offset:512
    v_mfma_f32_16x16x32_bf16 v[116:119], v[40:43], v[172:175], v[116:119]
    s_waitcnt lgkmcnt(2)
    v_mfma_f32_16x16x32_bf16 v[120:123], v[44:47], v[168:171], v[120:123]
    v_mfma_f32_16x16x32_bf16 v[124:127], v[44:47], v[172:175], v[124:127]
    s_waitcnt vmcnt(4) lgkmcnt(0)
    s_barrier
    s_add_u32 m0, s51, 0
    s_nop 0
    buffer_load_dwordx4 v1, s[12:15], s53 offen offset:0 nt lds
    buffer_load_dwordx4 v2, s[12:15], s53 offen offset:1024 nt lds
    buffer_load_dwordx4 v3, s[12:15], s53 offen offset:2048 nt lds
    s_add_u32 m0, s51, 12288
    s_add_u32 s53, s53, 12288
    buffer_load_dwordx4 v1, s[12:15], s53 offen offset:0 nt lds
    buffer_load_dwordx4 v2, s[12:15], s53 offen offset:1024 nt lds
    buffer_load_dwordx4 v3, s[12:15], s53 offen offset:2048 nt lds
    s_add_u32 s53, s53, 12288
    s_lshl_b32 s57, s50, 4
    s_add_u32 s57, s57, 11
    s_bitcmp1_b64 s[100:101], s57
    s_cselect_b32 s57, s55, 1073741824
    s_mov_b32 exec_hi, 0
    buffer_load_dword v23, v22, s[60:63], s57 offen
    s_mov_b64 exec, -1
    ds_read_b64 v[178:179], v53 offset:0
    ds_read_b64 v[182:183], v53 offset:512
    ds_read_b64_tr_b16 v[24:25], v6 offset:24576
    ds_read_b64_tr_b16 v[26:27], v10 offset:24576
    ds_read_b64_tr_b16 v[28:29], v7 offset:24576
    ds_read_b64_tr_b16 v[30:31], v11 offset:24576
    ds_read_b64_tr_b16 v[32:33], v8 offset:24576
    ds_read_b64_tr_b16 v[34:35], v12 offset:24576
    ds_read_b64_tr_b16 v[36:37], v9 offset:24576
    ds_read_b64_tr_b16 v[38:39], v13 offset:24576
    s_waitcnt lgkmcnt(6)
    v_mfma_f32_16x16x32_bf16 v[80:83], v[24:27], v[176:179], v[80:83]
    ds_read_b64_tr_b16 v[40:41], v6 offset:24704
    ds_read_b64_tr_b16 v[42:43], v10 offset:24704
    v_fma_f32 v184, v184, s54, -v14
    v_fma_f32 v185, v185, s54, -v14
    v_fma_f32 v186, v186, s54, -v14
    v_mfma_f32_16x16x32_bf16 v[84:87], v[24:27], v[180:183], v[84:87]
    v_fma_f32 v187, v187, s54, -v14
    v_fma_f32 v188, v188, s54, -v15
    v_fma_f32 v189, v189, s54, -v15
    s_waitcnt lgkmcnt(6)
    v_mfma_f32_16x16x32_bf16 v[88:91], v[28:31], v[176:179], v[88:91]
    ds_read_b64_tr_b16 v[44:45], v7 offset:24704
    ds_read_b64_tr_b16 v[46:47], v11 offset:24704
    v_fma_f32 v190, v190, s54, -v15
    v_fma_f32 v191, v191, s54, -v15
    v_exp_f32 v184, v184
    v_exp_f32 v185, v185
    v_mfma_f32_16x16x32_bf16 v[92:95], v[28:31], v[180:183], v[92:95]
    v_exp_f32 v186, v186
    v_exp_f32 v187, v187
    v_exp_f32 v188, v188
    s_waitcnt lgkmcnt(6)
    v_mfma_f32_16x16x32_bf16 v[96:99], v[32:35], v[176:179], v[96:99]
    v_exp_f32 v189, v189
    v_exp_f32 v190, v190
    v_exp_f32 v191, v191
    v_mfma_f32_16x16x32_bf16 v[100:103], v[32:35], v[180:183], v[100:103]
    v_add_f32 v16, v16, v184
    v_add_f32 v17, v17, v188
    v_add_f32 v16, v16, v185
    v_add_f32 v17, v17, v189
    s_waitcnt lgkmcnt(4)
    v_mfma_f32_16x16x32_bf16 v[104:107], v[36:39], v[176:179], v[104:107]
    v_add_f32 v16, v16, v186
    v_add_f32 v17, v17, v190
    v_add_f32 v16, v16, v187
    v_mfma_f32_16x16x32_bf16 v[108:111], v[36:39], v[180:183], v[108:111]
    v_add_f32 v17, v17, v191
    v_cvt_pk_bf16_f32 v184, v184, v185
    v_cvt_pk_bf16_f32 v185, v186, v187
    s_waitcnt lgkmcnt(2)
    v_mfma_f32_16x16x32_bf16 v[112:115], v[40:43], v[176:179], v[112:115]
    v_cvt_pk_bf16_f32 v188, v188, v189
    v_cvt_pk_bf16_f32 v189, v190, v191
    ds_write_b64 v52, v[184:185] offset:4096
    ds_write_b64 v52, v[188:189] offset:4608
    v_mfma_f32_16x16x32_bf16 v[116:119], v[40:43], v[180:183], v[116:119]
    s_waitcnt lgkmcnt(2)
    v_mfma_f32_16x16x32_bf16 v[120:123], v[44:47], v[176:179], v[120:123]
    v_mfma_f32_16x16x32_bf16 v[124:127], v[44:47], v[180:183], v[124:127]
    s_waitcnt vmcnt(7) lgkmcnt(0)
    s_barrier
    ds_read_b64 v[186:187], v53 offset:4096
    ds_read_b64 v[190:191], v53 offset:4608
    ds_read_b64_tr_b16 v[24:25], v6 offset:36864
    ds_read_b64_tr_b16 v[26:27], v10 offset:36864
    ds_read_b64_tr_b16 v[28:29], v7 offset:36864
    ds_read_b64_tr_b16 v[30:31], v11 offset:36864
    ds_read_b64_tr_b16 v[32:33], v8 offset:36864
    ds_read_b64_tr_b16 v[34:35], v12 offset:36864
    ds_read_b64_tr_b16 v[36:37], v9 offset:36864
    ds_read_b64_tr_b16 v[38:39], v13 offset:36864
    s_waitcnt lgkmcnt(6)
    v_mfma_f32_16x16x32_bf16 v[80:83], v[24:27], v[184:187], v[80:83]
    ds_read_b64_tr_b16 v[40:41], v6 offset:36992
    ds_read_b64_tr_b16 v[42:43], v10 offset:36992
    v_fma_f32 v192, v192, s54, -v14
    v_fma_f32 v193, v193, s54, -v14
    v_fma_f32 v194, v194, s54, -v14
    v_mfma_f32_16x16x32_bf16 v[84:87], v[24:27], v[188:191], v[84:87]
    v_fma_f32 v195, v195, s54, -v14
    v_fma_f32 v196, v196, s54, -v15
    v_fma_f32 v197, v197, s54, -v15
    s_waitcnt lgkmcnt(6)
    v_mfma_f32_16x16x32_bf16 v[88:91], v[28:31], v[184:187], v[88:91]
    ds_read_b64_tr_b16 v[44:45], v7 offset:36992
    ds_read_b64_tr_b16 v[46:47], v11 offset:36992
    v_fma_f32 v198, v198, s54, -v15
    v_fma_f32 v199, v199, s54, -v15
    v_exp_f32 v192, v192
    v_exp_f32 v193, v193
    v_mfma_f32_16x16x32_bf16 v[92:95], v[28:31], v[188:191], v[92:95]
    v_exp_f32 v194, v194
    v_exp_f32 v195, v195
    v_exp_f32 v196, v196
    s_waitcnt lgkmcnt(6)
    v_mfma_f32_16x16x32_bf16 v[96:99], v[32:35], v[184:187], v[96:99]
    v_exp_f32 v197, v197
    v_exp_f32 v198, v198
    v_exp_f32 v199, v199
    v_mfma_f32_16x16x32_bf16 v[100:103], v[32:35], v[188:191], v[100:103]
    v_add_f32 v16, v16, v192
    v_add_f32 v17, v17, v196
    v_add_f32 v16, v16, v193
    v_add_f32 v17, v17, v197
    s_waitcnt lgkmcnt(4)
    v_mfma_f32_16x16x32_bf16 v[104:107], v[36:39], v[184:187], v[104:107]
    v_add_f32 v16, v16, v194
    v_add_f32 v17, v17, v198
    v_add_f32 v16, v16, v195
    v_mfma_f32_16x16x32_bf16 v[108:111], v[36:39], v[188:191], v[108:111]
    v_add_f32 v17, v17, v199
    v_cvt_pk_bf16_f32 v192, v192, v193
    v_cvt_pk_bf16_f32 v193, v194, v195
    s_waitcnt lgkmcnt(2)
    v_mfma_f32_16x16x32_bf16 v[112:115], v[40:43], v[184:187], v[112:115]
    v_cvt_pk_bf16_f32 v196, v196, v197
    v_cvt_pk_bf16_f32 v197, v198, v199
    ds_write_b64 v52, v[192:193] offset:0
    ds_write_b64 v52, v[196:197] offset:512
    v_mfma_f32_16x16x32_bf16 v[116:119], v[40:43], v[188:191], v[116:119]
    s_waitcnt lgkmcnt(2)
    v_mfma_f32_16x16x32_bf16 v[120:123], v[44:47], v[184:187], v[120:123]
    v_mfma_f32_16x16x32_bf16 v[124:127], v[44:47], v[188:191], v[124:127]
    s_waitcnt vmcnt(4) lgkmcnt(0)
    s_barrier
    s_add_u32 m0, s51, 24576
    s_nop 0
    buffer_load_dwordx4 v1, s[12:15], s53 offen offset:0 nt lds
    buffer_load_dwordx4 v2, s[12:15], s53 offen offset:1024 nt lds
    buffer_load_dwordx4 v3, s[12:15], s53 offen offset:2048 nt lds
    s_add_u32 m0, s51, 36864
    s_add_u32 s53, s53, 12288
    buffer_load_dwordx4 v1, s[12:15], s53 offen offset:0 nt lds
    buffer_load_dwordx4 v2, s[12:15], s53 offen offset:1024 nt lds
    buffer_load_dwordx4 v3, s[12:15], s53 offen offset:2048 nt lds
    s_add_u32 s53, s53, 12288
    s_lshl_b32 s57, s50, 4
    s_add_u32 s57, s57, 12
    s_bitcmp1_b64 s[100:101], s57
    s_cselect_b32 s57, s55, 1073741824
    s_cselect_b32 s59, s56, 0
    s_mov_b32 exec_lo, 0
    buffer_load_dword v23, v22, s[60:63], s57 offen
    s_mov_b64 exec, -1
    s_add_u32 s55, s55, s59
    ds_read_b64 v[194:195], v53 offset:0
    ds_read_b64 v[198:199], v53 offset:512
    ds_read_b64_tr_b16 v[24:25], v6 offset:0
    ds_read_b64_tr_b16 v[26:27], v10 offset:0
    ds_read_b64_tr_b16 v[28:29], v7 offset:0
    ds_read_b64_tr_b16 v[30:31], v11 offset:0
    ds_read_b64_tr_b16 v[32:33], v8 offset:0
    ds_read_b64_tr_b16 v[34:35], v12 offset:0
    ds_read_b64_tr_b16 v[36:37], v9 offset:0
    ds_read_b64_tr_b16 v[38:39], v13 offset:0
    s_waitcnt lgkmcnt(6)
    v_mfma_f32_16x16x32_bf16 v[80:83], v[24:27], v[192:195], v[80:83]
    ds_read_b64_tr_b16 v[40:41], v6 offset:128
    ds_read_b64_tr_b16 v[42:43], v10 offset:128
    v_fma_f32 v200, v200, s54, -v14
    v_fma_f32 v201, v201, s54, -v14
    v_fma_f32 v202, v202, s54, -v14
    v_mfma_f32_16x16x32_bf16 v[84:87], v[24:27], v[196:199], v[84:87]
    v_fma_f32 v203, v203, s54, -v14
    v_fma_f32 v204, v204, s54, -v15
    v_fma_f32 v205, v205, s54, -v15
    s_waitcnt lgkmcnt(6)
    v_mfma_f32_16x16x32_bf16 v[88:91], v[28:31], v[192:195], v[88:91]
    ds_read_b64_tr_b16 v[44:45], v7 offset:128
    ds_read_b64_tr_b16 v[46:47], v11 offset:128
    v_fma_f32 v206, v206, s54, -v15
    v_fma_f32 v207, v207, s54, -v15
    v_exp_f32 v200, v200
    v_exp_f32 v201, v201
    v_mfma_f32_16x16x32_bf16 v[92:95], v[28:31], v[196:199], v[92:95]
    v_exp_f32 v202, v202
    v_exp_f32 v203, v203
    v_exp_f32 v204, v204
    s_waitcnt lgkmcnt(6)
    v_mfma_f32_16x16x32_bf16 v[96:99], v[32:35], v[192:195], v[96:99]
    v_exp_f32 v205, v205
    v_exp_f32 v206, v206
    v_exp_f32 v207, v207
    v_mfma_f32_16x16x32_bf16 v[100:103], v[32:35], v[196:199], v[100:103]
    v_add_f32 v16, v16, v200
    v_add_f32 v17, v17, v204
    v_add_f32 v16, v16, v201
    v_add_f32 v17, v17, v205
    s_waitcnt lgkmcnt(4)
    v_mfma_f32_16x16x32_bf16 v[104:107], v[36:39], v[192:195], v[104:107]
    v_add_f32 v16, v16, v202
    v_add_f32 v17, v17, v206
    v_add_f32 v16, v16, v203
    v_mfma_f32_16x16x32_bf16 v[108:111], v[36:39], v[196:199], v[108:111]
    v_add_f32 v17, v17, v207
    v_cvt_pk_bf16_f32 v200, v200, v201
    v_cvt_pk_bf16_f32 v201, v202, v203
    s_waitcnt lgkmcnt(2)
    v_mfma_f32_16x16x32_bf16 v[112:115], v[40:43], v[192:195], v[112:115]
    v_cvt_pk_bf16_f32 v204, v204, v205
    v_cvt_pk_bf16_f32 v205, v206, v207
    ds_write_b64 v52, v[200:201] offset:4096
    ds_write_b64 v52, v[204:205] offset:4608
    v_mfma_f32_16x16x32_bf16 v[116:119], v[40:43], v[196:199], v[116:119]
    s_waitcnt lgkmcnt(2)
    v_mfma_f32_16x16x32_bf16 v[120:123], v[44:47], v[192:195], v[120:123]
    v_mfma_f32_16x16x32_bf16 v[124:127], v[44:47], v[196:199], v[124:127]
    s_waitcnt vmcnt(7) lgkmcnt(0)
    s_barrier
    ds_read_b64 v[202:203], v53 offset:4096
    ds_read_b64 v[206:207], v53 offset:4608
    ds_read_b64_tr_b16 v[24:25], v6 offset:12288
    ds_read_b64_tr_b16 v[26:27], v10 offset:12288
    ds_read_b64_tr_b16 v[28:29], v7 offset:12288
    ds_read_b64_tr_b16 v[30:31], v11 offset:12288
    ds_read_b64_tr_b16 v[32:33], v8 offset:12288
    ds_read_b64_tr_b16 v[34:35], v12 offset:12288
    ds_read_b64_tr_b16 v[36:37], v9 offset:12288
    ds_read_b64_tr_b16 v[38:39], v13 offset:12288
    s_waitcnt lgkmcnt(6)
    v_mfma_f32_16x16x32_bf16 v[80:83], v[24:27], v[200:203], v[80:83]
    ds_read_b64_tr_b16 v[40:41], v6 offset:12416
    ds_read_b64_tr_b16 v[42:43], v10 offset:12416
    v_fma_f32 v208, v208, s54, -v14
    v_fma_f32 v209, v209, s54, -v14
    v_fma_f32 v210, v210, s54, -v14
    v_mfma_f32_16x16x32_bf16 v[84:87], v[24:27], v[204:207], v[84:87]
    v_fma_f32 v211, v211, s54, -v14
    v_fma_f32 v212, v212, s54, -v15
    v_fma_f32 v213, v213, s54, -v15
    s_waitcnt lgkmcnt(6)
    v_mfma_f32_16x16x32_bf16 v[88:91], v[28:31], v[200:203], v[88:91]
    ds_read_b64_tr_b16 v[44:45], v7 offset:12416
    ds_read_b64_tr_b16 v[46:47], v11 offset:12416
    v_fma_f32 v214, v214, s54, -v15
    v_fma_f32 v215, v215, s54, -v15
    v_exp_f32 v208, v208
    v_exp_f32 v209, v209
    v_mfma_f32_16x16x32_bf16 v[92:95], v[28:31], v[204:207], v[92:95]
    v_exp_f32 v210, v210
    v_exp_f32 v211, v211
    v_exp_f32 v212, v212
    s_waitcnt lgkmcnt(6)
    v_mfma_f32_16x16x32_bf16 v[96:99], v[32:35], v[200:203], v[96:99]
    v_exp_f32 v213, v213
    v_exp_f32 v214, v214
    v_exp_f32 v215, v215
    v_mfma_f32_16x16x32_bf16 v[100:103], v[32:35], v[204:207], v[100:103]
    v_add_f32 v16, v16, v208
    v_add_f32 v17, v17, v212
    v_add_f32 v16, v16, v209
    v_add_f32 v17, v17, v213
    s_waitcnt lgkmcnt(4)
    v_mfma_f32_16x16x32_bf16 v[104:107], v[36:39], v[200:203], v[104:107]
    v_add_f32 v16, v16, v210
    v_add_f32 v17, v17, v214
    v_add_f32 v16, v16, v211
    v_mfma_f32_16x16x32_bf16 v[108:111], v[36:39], v[204:207], v[108:111]
    v_add_f32 v17, v17, v215
    v_cvt_pk_bf16_f32 v208, v208, v209
    v_cvt_pk_bf16_f32 v209, v210, v211
    s_waitcnt lgkmcnt(2)
    v_mfma_f32_16x16x32_bf16 v[112:115], v[40:43], v[200:203], v[112:115]
    v_cvt_pk_bf16_f32 v212, v212, v213
    v_cvt_pk_bf16_f32 v213, v214, v215
    ds_write_b64 v52, v[208:209] offset:0
    ds_write_b64 v52, v[212:213] offset:512
    v_mfma_f32_16x16x32_bf16 v[116:119], v[40:43], v[204:207], v[116:119]
    s_waitcnt lgkmcnt(2)
    v_mfma_f32_16x16x32_bf16 v[120:123], v[44:47], v[200:203], v[120:123]
    v_mfma_f32_16x16x32_bf16 v[124:127], v[44:47], v[204:207], v[124:127]
    s_waitcnt vmcnt(4) lgkmcnt(0)
    s_barrier
    s_add_u32 m0, s51, 0
    s_nop 0
    buffer_load_dwordx4 v1, s[12:15], s53 offen offset:0 nt lds
    buffer_load_dwordx4 v2, s[12:15], s53 offen offset:1024 nt lds
    buffer_load_dwordx4 v3, s[12:15], s53 offen offset:2048 nt lds
    s_add_u32 m0, s51, 12288
    s_add_u32 s53, s53, 12288
    buffer_load_dwordx4 v1, s[12:15], s53 offen offset:0 nt lds
    buffer_load_dwordx4 v2, s[12:15], s53 offen offset:1024 nt lds
    buffer_load_dwordx4 v3, s[12:15], s53 offen offset:2048 nt lds
    s_add_u32 s53, s53, 12288
    ds_read_b64 v[210:211], v53 offset:0
    ds_read_b64 v[214:215], v53 offset:512
    ds_read_b64_tr_b16 v[24:25], v6 offset:24576
    ds_read_b64_tr_b16 v[26:27], v10 offset:24576
    ds_read_b64_tr_b16 v[28:29], v7 offset:24576
    ds_read_b64_tr_b16 v[30:31], v11 offset:24576
    ds_read_b64_tr_b16 v[32:33], v8 offset:24576
    ds_read_b64_tr_b16 v[34:35], v12 offset:24576
    ds_read_b64_tr_b16 v[36:37], v9 offset:24576
    ds_read_b64_tr_b16 v[38:39], v13 offset:24576
    s_waitcnt lgkmcnt(6)
    v_mfma_f32_16x16x32_bf16 v[80:83], v[24:27], v[208:211], v[80:83]
    ds_read_b64_tr_b16 v[40:41], v6 offset:24704
    ds_read_b64_tr_b16 v[42:43], v10 offset:24704
    v_fma_f32 v216, v216, s54, -v14
    v_fma_f32 v217, v217, s54, -v14
    v_fma_f32 v218, v218, s54, -v14
    v_mfma_f32_16x16x32_bf16 v[84:87], v[24:27], v[212:215], v[84:87]
    v_fma_f32 v219, v219, s54, -v14
    v_fma_f32 v220, v220, s54, -v15
    v_fma_f32 v221, v221, s54, -v15
    s_waitcnt lgkmcnt(6)
    v_mfma_f32_16x16x32_bf16 v[88:91], v[28:31], v[208:211], v[88:91]
    ds_read_b64_tr_b16 v[44:45], v7 offset:24704
    ds_read_b64_tr_b16 v[46:47], v11 offset:24704
    v_fma_f32 v222, v222, s54, -v15
    v_fma_f32 v223, v223, s54, -v15
    v_exp_f32 v216, v216
    v_exp_f32 v217, v217
    v_mfma_f32_16x16x32_bf16 v[92:95], v[28:31], v[212:215], v[92:95]
    v_exp_f32 v218, v218
    v_exp_f32 v219, v219
    v_exp_f32 v220, v220
    s_waitcnt lgkmcnt(6)
    v_mfma_f32_16x16x32_bf16 v[96:99], v[32:35], v[208:211], v[96:99]
    v_exp_f32 v221, v221
    v_exp_f32 v222, v222
    v_exp_f32 v223, v223
    v_mfma_f32_16x16x32_bf16 v[100:103], v[32:35], v[212:215], v[100:103]
    v_add_f32 v16, v16, v216
    v_add_f32 v17, v17, v220
    v_add_f32 v16, v16, v217
    v_add_f32 v17, v17, v221
    s_waitcnt lgkmcnt(4)
    v_mfma_f32_16x16x32_bf16 v[104:107], v[36:39], v[208:211], v[104:107]
    v_add_f32 v16, v16, v218
    v_add_f32 v17, v17, v222
    v_add_f32 v16, v16, v219
    v_mfma_f32_16x16x32_bf16 v[108:111], v[36:39], v[212:215], v[108:111]
    v_add_f32 v17, v17, v223
    v_cvt_pk_bf16_f32 v216, v216, v217
    v_cvt_pk_bf16_f32 v217, v218, v219
    s_waitcnt lgkmcnt(2)
    v_mfma_f32_16x16x32_bf16 v[112:115], v[40:43], v[208:211], v[112:115]
    v_cvt_pk_bf16_f32 v220, v220, v221
    v_cvt_pk_bf16_f32 v221, v222, v223
    ds_write_b64 v52, v[216:217] offset:4096
    ds_write_b64 v52, v[220:221] offset:4608
    v_mfma_f32_16x16x32_bf16 v[116:119], v[40:43], v[212:215], v[116:119]
    s_waitcnt lgkmcnt(2)
    v_mfma_f32_16x16x32_bf16 v[120:123], v[44:47], v[208:211], v[120:123]
    v_mfma_f32_16x16x32_bf16 v[124:127], v[44:47], v[212:215], v[124:127]
    s_waitcnt vmcnt(6) lgkmcnt(0)
    s_barrier
    ds_read_b64 v[218:219], v53 offset:4096
    ds_read_b64 v[222:223], v53 offset:4608
    ds_read_b64_tr_b16 v[24:25], v6 offset:36864
    ds_read_b64_tr_b16 v[26:27], v10 offset:36864
    ds_read_b64_tr_b16 v[28:29], v7 offset:36864
    ds_read_b64_tr_b16 v[30:31], v11 offset:36864
    ds_read_b64_tr_b16 v[32:33], v8 offset:36864
    ds_read_b64_tr_b16 v[34:35], v12 offset:36864
    ds_read_b64_tr_b16 v[36:37], v9 offset:36864
    ds_read_b64_tr_b16 v[38:39], v13 offset:36864
    s_waitcnt lgkmcnt(6)
    v_mfma_f32_16x16x32_bf16 v[80:83], v[24:27], v[216:219], v[80:83]
    ds_read_b64_tr_b16 v[40:41], v6 offset:36992
    ds_read_b64_tr_b16 v[42:43], v10 offset:36992
    v_fma_f32 v224, v224, s54, -v14
    v_fma_f32 v225, v225, s54, -v14
    v_fma_f32 v226, v226, s54, -v14
    v_mfma_f32_16x16x32_bf16 v[84:87], v[24:27], v[220:223], v[84:87]
    v_fma_f32 v227, v227, s54, -v14
    v_fma_f32 v228, v228, s54, -v15
    v_fma_f32 v229, v229, s54, -v15
    s_waitcnt lgkmcnt(6)
    v_mfma_f32_16x16x32_bf16 v[88:91], v[28:31], v[216:219], v[88:91]
    ds_read_b64_tr_b16 v[44:45], v7 offset:36992
    ds_read_b64_tr_b16 v[46:47], v11 offset:36992
    v_fma_f32 v230, v230, s54, -v15
    v_fma_f32 v231, v231, s54, -v15
    v_exp_f32 v224, v224
    v_exp_f32 v225, v225
    v_mfma_f32_16x16x32_bf16 v[92:95], v[28:31], v[220:223], v[92:95]
    v_exp_f32 v226, v226
    v_exp_f32 v227, v227
    v_exp_f32 v228, v228
    s_waitcnt lgkmcnt(6)
    v_mfma_f32_16x16x32_bf16 v[96:99], v[32:35], v[216:219], v[96:99]
    v_exp_f32 v229, v229
    v_exp_f32 v230, v230
    v_exp_f32 v231, v231
    v_mfma_f32_16x16x32_bf16 v[100:103], v[32:35], v[220:223], v[100:103]
    v_add_f32 v16, v16, v224
    v_add_f32 v17, v17, v228
    v_add_f32 v16, v16, v225
    v_add_f32 v17, v17, v229
    s_waitcnt lgkmcnt(4)
    v_mfma_f32_16x16x32_bf16 v[104:107], v[36:39], v[216:219], v[104:107]
    v_add_f32 v16, v16, v226
    v_add_f32 v17, v17, v230
    v_add_f32 v16, v16, v227
    v_mfma_f32_16x16x32_bf16 v[108:111], v[36:39], v[220:223], v[108:111]
    v_add_f32 v17, v17, v231
    v_cvt_pk_bf16_f32 v224, v224, v225
    v_cvt_pk_bf16_f32 v225, v226, v227
    s_waitcnt lgkmcnt(2)
    v_mfma_f32_16x16x32_bf16 v[112:115], v[40:43], v[216:219], v[112:115]
    v_cvt_pk_bf16_f32 v228, v228, v229
    v_cvt_pk_bf16_f32 v229, v230, v231
    ds_write_b64 v52, v[224:225] offset:0
    ds_write_b64 v52, v[228:229] offset:512
    v_mfma_f32_16x16x32_bf16 v[116:119], v[40:43], v[220:223], v[116:119]
    s_waitcnt lgkmcnt(2)
    v_mfma_f32_16x16x32_bf16 v[120:123], v[44:47], v[216:219], v[120:123]
    v_mfma_f32_16x16x32_bf16 v[124:127], v[44:47], v[220:223], v[124:127]
    s_waitcnt vmcnt(3) lgkmcnt(0)
    s_barrier
    s_add_u32 m0, s51, 24576
    s_nop 0
    buffer_load_dwordx4 v1, s[12:15], s53 offen offset:0 nt lds
    buffer_load_dwordx4 v2, s[12:15], s53 offen offset:1024 nt lds
    buffer_load_dwordx4 v3, s[12:15], s53 offen offset:2048 nt lds
    s_add_u32 m0, s51, 36864
    s_add_u32 s53, s53, 12288
    buffer_load_dwordx4 v1, s[12:15], s53 offen offset:0 nt lds
    buffer_load_dwordx4 v2, s[12:15], s53 offen offset:1024 nt lds
    buffer_load_dwordx4 v3, s[12:15], s53 offen offset:2048 nt lds
    s_add_u32 s53, s53, 12288
    ds_read_b64 v[226:227], v53 offset:0
    ds_read_b64 v[230:231], v53 offset:512
    ds_read_b64_tr_b16 v[24:25], v6 offset:0
    ds_read_b64_tr_b16 v[26:27], v10 offset:0
    ds_read_b64_tr_b16 v[28:29], v7 offset:0
    ds_read_b64_tr_b16 v[30:31], v11 offset:0
    ds_read_b64_tr_b16 v[32:33], v8 offset:0
    ds_read_b64_tr_b16 v[34:35], v12 offset:0
    ds_read_b64_tr_b16 v[36:37], v9 offset:0
    ds_read_b64_tr_b16 v[38:39], v13 offset:0
    s_waitcnt lgkmcnt(6)
    v_mfma_f32_16x16x32_bf16 v[80:83], v[24:27], v[224:227], v[80:83]
    ds_read_b64_tr_b16 v[40:41], v6 offset:128
    ds_read_b64_tr_b16 v[42:43], v10 offset:128
    v_fma_f32 v232, v232, s54, -v14
    v_fma_f32 v233, v233, s54, -v14
    v_fma_f32 v234, v234, s54, -v14
    v_mfma_f32_16x16x32_bf16 v[84:87], v[24:27], v[228:231], v[84:87]
    v_fma_f32 v235, v235, s54, -v14
    v_fma_f32 v236, v236, s54, -v15
    v_fma_f32 v237, v237, s54, -v15
    s_waitcnt lgkmcnt(6)
    v_mfma_f32_16x16x32_bf16 v[88:91], v[28:31], v[224:227], v[88:91]
    ds_read_b64_tr_b16 v[44:45], v7 offset:128
    ds_read_b64_tr_b16 v[46:47], v11 offset:128
    v_fma_f32 v238, v238, s54, -v15
    v_fma_f32 v239, v239, s54, -v15
    v_exp_f32 v232, v232
    v_exp_f32 v233, v233
    v_mfma_f32_16x16x32_bf16 v[92:95], v[28:31], v[228:231], v[92:95]
    v_exp_f32 v234, v234
    v_exp_f32 v235, v235
    v_exp_f32 v236, v236
    s_waitcnt lgkmcnt(6)
    v_mfma_f32_16x16x32_bf16 v[96:99], v[32:35], v[224:227], v[96:99]
    v_exp_f32 v237, v237
    v_exp_f32 v238, v238
    v_exp_f32 v239, v239
    v_mfma_f32_16x16x32_bf16 v[100:103], v[32:35], v[228:231], v[100:103]
    v_add_f32 v16, v16, v232
    v_add_f32 v17, v17, v236
    v_add_f32 v16, v16, v233
    v_add_f32 v17, v17, v237
    s_waitcnt lgkmcnt(4)
    v_mfma_f32_16x16x32_bf16 v[104:107], v[36:39], v[224:227], v[104:107]
    v_add_f32 v16, v16, v234
    v_add_f32 v17, v17, v238
    v_add_f32 v16, v16, v235
    v_mfma_f32_16x16x32_bf16 v[108:111], v[36:39], v[228:231], v[108:111]
    v_add_f32 v17, v17, v239
    v_cvt_pk_bf16_f32 v232, v232, v233
    v_cvt_pk_bf16_f32 v233, v234, v235
    s_waitcnt lgkmcnt(2)
    v_mfma_f32_16x16x32_bf16 v[112:115], v[40:43], v[224:227], v[112:115]
    v_cvt_pk_bf16_f32 v236, v236, v237
    v_cvt_pk_bf16_f32 v237, v238, v239
    ds_write_b64 v52, v[232:233] offset:4096
    ds_write_b64 v52, v[236:237] offset:4608
    v_mfma_f32_16x16x32_bf16 v[116:119], v[40:43], v[228:231], v[116:119]
    s_waitcnt lgkmcnt(2)
    v_mfma_f32_16x16x32_bf16 v[120:123], v[44:47], v[224:227], v[120:123]
    v_mfma_f32_16x16x32_bf16 v[124:127], v[44:47], v[228:231], v[124:127]
    s_waitcnt vmcnt(6) lgkmcnt(0)
    s_barrier
    ds_read_b64 v[234:235], v53 offset:4096
    ds_read_b64 v[238:239], v53 offset:4608
    ds_read_b64_tr_b16 v[24:25], v6 offset:12288
    ds_read_b64_tr_b16 v[26:27], v10 offset:12288
    ds_read_b64_tr_b16 v[28:29], v7 offset:12288
    ds_read_b64_tr_b16 v[30:31], v11 offset:12288
    ds_read_b64_tr_b16 v[32:33], v8 offset:12288
    ds_read_b64_tr_b16 v[34:35], v12 offset:12288
    ds_read_b64_tr_b16 v[36:37], v9 offset:12288
    ds_read_b64_tr_b16 v[38:39], v13 offset:12288
    s_waitcnt lgkmcnt(6)
    v_mfma_f32_16x16x32_bf16 v[80:83], v[24:27], v[232:235], v[80:83]
    ds_read_b64_tr_b16 v[40:41], v6 offset:12416
    ds_read_b64_tr_b16 v[42:43], v10 offset:12416
    v_fma_f32 v240, v240, s54, -v14
    v_fma_f32 v241, v241, s54, -v14
    v_fma_f32 v242, v242, s54, -v14
    v_mfma_f32_16x16x32_bf16 v[84:87], v[24:27], v[236:239], v[84:87]
    v_fma_f32 v243, v243, s54, -v14
    v_fma_f32 v244, v244, s54, -v15
    v_fma_f32 v245, v245, s54, -v15
    s_waitcnt lgkmcnt(6)
    v_mfma_f32_16x16x32_bf16 v[88:91], v[28:31], v[232:235], v[88:91]
    ds_read_b64_tr_b16 v[44:45], v7 offset:12416
    ds_read_b64_tr_b16 v[46:47], v11 offset:12416
    v_fma_f32 v246, v246, s54, -v15
    v_fma_f32 v247, v247, s54, -v15
    v_exp_f32 v240, v240
    v_exp_f32 v241, v241
    v_mfma_f32_16x16x32_bf16 v[92:95], v[28:31], v[236:239], v[92:95]
    v_exp_f32 v242, v242
    v_exp_f32 v243, v243
    v_exp_f32 v244, v244
    s_waitcnt lgkmcnt(6)
    v_mfma_f32_16x16x32_bf16 v[96:99], v[32:35], v[232:235], v[96:99]
    v_exp_f32 v245, v245
    v_exp_f32 v246, v246
    v_exp_f32 v247, v247
    v_mfma_f32_16x16x32_bf16 v[100:103], v[32:35], v[236:239], v[100:103]
    v_add_f32 v16, v16, v240
    v_add_f32 v17, v17, v244
    v_add_f32 v16, v16, v241
    v_add_f32 v17, v17, v245
    s_waitcnt lgkmcnt(4)
    v_mfma_f32_16x16x32_bf16 v[104:107], v[36:39], v[232:235], v[104:107]
    v_add_f32 v16, v16, v242
    v_add_f32 v17, v17, v246
    v_add_f32 v16, v16, v243
    v_mfma_f32_16x16x32_bf16 v[108:111], v[36:39], v[236:239], v[108:111]
    v_add_f32 v17, v17, v247
    v_cvt_pk_bf16_f32 v240, v240, v241
    v_cvt_pk_bf16_f32 v241, v242, v243
    s_waitcnt lgkmcnt(2)
    v_mfma_f32_16x16x32_bf16 v[112:115], v[40:43], v[232:235], v[112:115]
    v_cvt_pk_bf16_f32 v244, v244, v245
    v_cvt_pk_bf16_f32 v245, v246, v247
    ds_write_b64 v52, v[240:241] offset:0
    ds_write_b64 v52, v[244:245] offset:512
    v_mfma_f32_16x16x32_bf16 v[116:119], v[40:43], v[236:239], v[116:119]
    s_waitcnt lgkmcnt(2)
    v_mfma_f32_16x16x32_bf16 v[120:123], v[44:47], v[232:235], v[120:123]
    v_mfma_f32_16x16x32_bf16 v[124:127], v[44:47], v[236:239], v[124:127]
    s_waitcnt vmcnt(3) lgkmcnt(0)
    s_barrier
    s_cmp_eq_u32 s50, 3
    s_nop 4
    s_cbranch_scc1 L_A30
    s_add_u32 m0, s51, 0
    s_nop 0
    buffer_load_dwordx4 v1, s[8:11], s52 offen offset:0 nt lds
    buffer_load_dwordx4 v2, s[8:11], s52 offen offset:1024 nt lds
    buffer_load_dwordx4 v3, s[8:11], s52 offen offset:2048 nt lds
    s_add_u32 m0, s51, 12288
    s_add_u32 s52, s52, 12288
    buffer_load_dwordx4 v1, s[8:11], s52 offen offset:0 nt lds
    buffer_load_dwordx4 v2, s[8:11], s52 offen offset:1024 nt lds
    buffer_load_dwordx4 v3, s[8:11], s52 offen offset:2048 nt lds
    s_add_u32 s52, s52, 12288
L_A30:
    ds_read_b64 v[242:243], v53 offset:0
    ds_read_b64 v[246:247], v53 offset:512
    ds_read_b64_tr_b16 v[24:25], v6 offset:24576
    ds_read_b64_tr_b16 v[26:27], v10 offset:24576
    ds_read_b64_tr_b16 v[28:29], v7 offset:24576
    ds_read_b64_tr_b16 v[30:31], v11 offset:24576
    ds_read_b64_tr_b16 v[32:33], v8 offset:24576
    ds_read_b64_tr_b16 v[34:35], v12 offset:24576
    ds_read_b64_tr_b16 v[36:37], v9 offset:24576
    ds_read_b64_tr_b16 v[38:39], v13 offset:24576
    s_waitcnt lgkmcnt(6)
    v_mfma_f32_16x16x32_bf16 v[80:83], v[24:27], v[240:243], v[80:83]
    ds_read_b64_tr_b16 v[40:41], v6 offset:24704
    ds_read_b64_tr_b16 v[42:43], v10 offset:24704
    v_fma_f32 v248, v248, s54, -v14
    v_fma_f32 v249, v249, s54, -v14
    v_fma_f32 v250, v250, s54, -v14
    v_fma_f32 v251, v251, s54, -v14
    v_mfma_f32_16x16x32_bf16 v[84:87], v[24:27], v[244:247], v[84:87]
    v_fma_f32 v252, v252, s54, -v15
    v_fma_f32 v253, v253, s54, -v15
    v_fma_f32 v254, v254, s54, -v15
    v_fma_f32 v255, v255, s54, -v15
    s_waitcnt lgkmcnt(6)
    v_mfma_f32_16x16x32_bf16 v[88:91], v[28:31], v[240:243], v[88:91]
    ds_read_b64_tr_b16 v[44:45], v7 offset:24704
    ds_read_b64_tr_b16 v[46:47], v11 offset:24704
    v_exp_f32 v248, v248
    v_exp_f32 v249, v249
    v_exp_f32 v250, v250
    v_exp_f32 v251, v251
    v_mfma_f32_16x16x32_bf16 v[92:95], v[28:31], v[244:247], v[92:95]
    v_exp_f32 v252, v252
    v_exp_f32 v253, v253
    v_exp_f32 v254, v254
    v_exp_f32 v255, v255
    s_waitcnt lgkmcnt(6)
    v_mfma_f32_16x16x32_bf16 v[96:99], v[32:35], v[240:243], v[96:99]
    v_add_f32 v16, v16, v248
    v_add_f32 v17, v17, v252
    v_add_f32 v16, v16, v249
    v_add_f32 v17, v17, v253
    v_mfma_f32_16x16x32_bf16 v[100:103], v[32:35], v[244:247], v[100:103]
    v_add_f32 v16, v16, v250
    v_add_f32 v17, v17, v254
    v_add_f32 v16, v16, v251
    v_add_f32 v17, v17, v255
    v_cvt_pk_bf16_f32 v248, v248, v249
    s_waitcnt lgkmcnt(4)
    v_mfma_f32_16x16x32_bf16 v[104:107], v[36:39], v[240:243], v[104:107]
    v_cvt_pk_bf16_f32 v249, v250, v251
    v_cvt_pk_bf16_f32 v252, v252, v253
    v_cvt_pk_bf16_f32 v253, v254, v255
    ds_write_b64 v52, v[248:249] offset:4096
    v_mfma_f32_16x16x32_bf16 v[108:111], v[36:39], v[244:247], v[108:111]
    ds_write_b64 v52, v[252:253] offset:4608
    v_mov_b32 v20, v16
    v_mov_b32 v21, v17
    s_nop 0
    v_permlane32_swap_b32 v16, v20
    s_waitcnt lgkmcnt(4)
    v_mfma_f32_16x16x32_bf16 v[112:115], v[40:43], v[240:243], v[112:115]
    v_permlane32_swap_b32 v17, v21
    v_add_f32 v16, v16, v20
    v_add_f32 v17, v17, v21
    v_mov_b32 v20, v16
    v_mfma_f32_16x16x32_bf16 v[116:119], v[40:43], v[244:247], v[116:119]
    v_mov_b32 v21, v17
    v_permlane16_swap_b32 v16, v20
    s_nop 0
    v_permlane16_swap_b32 v17, v21
    v_add_f32 v16, v16, v20
    s_waitcnt lgkmcnt(2)
    v_mfma_f32_16x16x32_bf16 v[120:123], v[44:47], v[240:243], v[120:123]
    v_add_f32 v17, v17, v21
    s_mov_b32 s57, 4294914048
    s_cmp_eq_u32 s50, 3
    s_cselect_b32 s57, 4294934528, s57
    v_mfma_f32_16x16x32_bf16 v[124:127], v[44:47], v[244:247], v[124:127]
    s_lshl_b32 s59, s33, 9
    s_sub_u32 s57, s57, s59
    v_add_u32 v18, s57, v52
    v_xor_b32 v19, 512, v18
    ds_write_b64 v18, v[16:17]
    s_cmp_eq_u32 s50, 3
    s_waitcnt lgkmcnt(0)
    s_nop 0
    s_cbranch_scc0 L_A30j
    s_waitcnt vmcnt(0)
L_A30j:
    s_waitcnt vmcnt(6) lgkmcnt(0)
    s_barrier
    ds_read_b64 v[250:251], v53 offset:4096
    ds_read_b64 v[254:255], v53 offset:4608
    ds_read_b64 v[20:21], v19
    ds_read_b64_tr_b16 v[24:25], v6 offset:36864
    ds_read_b64_tr_b16 v[26:27], v10 offset:36864
    ds_read_b64_tr_b16 v[28:29], v7 offset:36864
    ds_read_b64_tr_b16 v[30:31], v11 offset:36864
    ds_read_b64_tr_b16 v[32:33], v8 offset:36864
    ds_read_b64_tr_b16 v[34:35], v12 offset:36864
    ds_read_b64_tr_b16 v[36:37], v9 offset:36864
    ds_read_b64_tr_b16 v[38:39], v13 offset:36864
    s_waitcnt lgkmcnt(6)
    v_mfma_f32_16x16x32_bf16 v[80:83], v[24:27], v[248:251], v[80:83]
    ds_read_b64_tr_b16 v[40:41], v6 offset:36992
    ds_read_b64_tr_b16 v[42:43], v10 offset:36992
    v_mfma_f32_16x16x32_bf16 v[84:87], v[24:27], v[252:255], v[84:87]
    v_add_f32 v16, v16, v20
    v_add_f32 v17, v17, v21
    s_waitcnt lgkmcnt(6)
    v_mfma_f32_16x16x32_bf16 v[88:91], v[28:31], v[248:251], v[88:91]
    v_rcp_f32 v18, v16
    v_rcp_f32 v19, v17
    ds_read_b64_tr_b16 v[44:45], v7 offset:36992
    ds_read_b64_tr_b16 v[46:47], v11 offset:36992
    v_mfma_f32_16x16x32_bf16 v[92:95], v[28:31], v[252:255], v[92:95]
    s_waitcnt lgkmcnt(6)
    v_mfma_f32_16x16x32_bf16 v[96:99], v[32:35], v[248:251], v[96:99]
    v_mfma_f32_16x16x32_bf16 v[100:103], v[32:35], v[252:255], v[100:103]
    v_mul_f32 v80, v80, v18
    v_mul_f32 v81, v81, v18
    v_mul_f32 v82, v82, v18
    v_mul_f32 v83, v83, v18
    v_mul_f32 v84, v84, v19
    v_mul_f32 v85, v85, v19
    v_mul_f32 v86, v86, v19
    v_mul_f32 v87, v87, v19
    v_cvt_pk_bf16_f32 v56, v80, v81
    v_cvt_pk_bf16_f32 v57, v82, v83
    v_cvt_pk_bf16_f32 v58, v84, v85
    v_cvt_pk_bf16_f32 v59, v86, v87
    s_waitcnt lgkmcnt(4)
    v_mfma_f32_16x16x32_bf16 v[104:107], v[36:39], v[248:251], v[104:107]
    v_mfma_f32_16x16x32_bf16 v[108:111], v[36:39], v[252:255], v[108:111]
    v_mul_f32 v88, v88, v18
    v_mul_f32 v89, v89, v18
    v_mul_f32 v90, v90, v18
    v_mul_f32 v91, v91, v18
    v_mul_f32 v92, v92, v19
    v_mul_f32 v93, v93, v19
    v_mul_f32 v94, v94, v19
    v_mul_f32 v95, v95, v19
    v_cvt_pk_bf16_f32 v60, v88, v89
    v_cvt_pk_bf16_f32 v61, v90, v91
    v_cvt_pk_bf16_f32 v62, v92, v93
    v_cvt_pk_bf16_f32 v63, v94, v95
    s_waitcnt lgkmcnt(2)
    v_mfma_f32_16x16x32_bf16 v[112:115], v[40:43], v[248:251], v[112:115]
    v_mfma_f32_16x16x32_bf16 v[116:119], v[40:43], v[252:255], v[116:119]
    v_mul_f32 v96, v96, v18
    v_mul_f32 v97, v97, v18
    v_mul_f32 v98, v98, v18
    v_mul_f32 v99, v99, v18
    v_mul_f32 v100, v100, v19
    v_mul_f32 v101, v101, v19
    v_mul_f32 v102, v102, v19
    v_mul_f32 v103, v103, v19
    v_cvt_pk_bf16_f32 v64, v96, v97
    v_cvt_pk_bf16_f32 v65, v98, v99
    v_cvt_pk_bf16_f32 v66, v100, v101
    v_cvt_pk_bf16_f32 v67, v102, v103
    s_waitcnt lgkmcnt(0)
    v_mfma_f32_16x16x32_bf16 v[120:123], v[44:47], v[248:251], v[120:123]
    v_mfma_f32_16x16x32_bf16 v[124:127], v[44:47], v[252:255], v[124:127]
    v_mul_f32 v104, v104, v18
    v_mul_f32 v105, v105, v18
    v_mul_f32 v106, v106, v18
    v_mul_f32 v107, v107, v18
    v_mul_f32 v108, v108, v19
    v_mul_f32 v109, v109, v19
    v_mul_f32 v110, v110, v19
    v_mul_f32 v111, v111, v19
    v_cvt_pk_bf16_f32 v68, v104, v105
    v_cvt_pk_bf16_f32 v69, v106, v107
    v_cvt_pk_bf16_f32 v70, v108, v109
    v_cvt_pk_bf16_f32 v71, v110, v111
    v_mul_f32 v112, v112, v18
    v_mul_f32 v113, v113, v18
    v_mul_f32 v114, v114, v18
    v_mul_f32 v115, v115, v18
    v_mul_f32 v116, v116, v19
    v_mul_f32 v117, v117, v19
    v_mul_f32 v118, v118, v19
    v_mul_f32 v119, v119, v19
    v_cvt_pk_bf16_f32 v72, v112, v113
    v_cvt_pk_bf16_f32 v73, v114, v115
    v_cvt_pk_bf16_f32 v74, v116, v117
    v_cvt_pk_bf16_f32 v75, v118, v119
    v_mul_f32 v120, v120, v18
    v_mul_f32 v121, v121, v18
    v_mul_f32 v122, v122, v18
    v_mul_f32 v123, v123, v18
    v_mul_f32 v124, v124, v19
    v_mul_f32 v125, v125, v19
    v_mul_f32 v126, v126, v19
    v_mul_f32 v127, v127, v19
    v_cvt_pk_bf16_f32 v76, v120, v121
    v_cvt_pk_bf16_f32 v77, v122, v123
    v_cvt_pk_bf16_f32 v78, v124, v125
    v_cvt_pk_bf16_f32 v79, v126, v127
    s_cmp_eq_u32 s50, 3
    s_nop 0
    s_cbranch_scc0 L_A31
    v_xor_b32 v20, 0, v50
    ds_write_b64 v20, v[56:57] offset:0
    ds_write_b64 v20, v[58:59] offset:6144
    v_xor_b32 v21, 32, v50
    ds_write_b64 v21, v[60:61] offset:0
    ds_write_b64 v21, v[62:63] offset:6144
    v_xor_b32 v20, 64, v51
    ds_write_b64 v20, v[64:65] offset:0
    ds_write_b64 v20, v[66:67] offset:6144
    v_xor_b32 v21, 96, v51
    ds_write_b64 v21, v[68:69] offset:0
    ds_write_b64 v21, v[70:71] offset:6144
    v_xor_b32 v20, 0, v50
    ds_write_b64 v20, v[72:73] offset:128
    ds_write_b64 v20, v[74:75] offset:6272
    v_xor_b32 v21, 32, v50
    ds_write_b64 v21, v[76:77] offset:128
    ds_write_b64 v21, v[78:79] offset:6272
    s_waitcnt lgkmcnt(0)
L_A31:
    s_waitcnt vmcnt(3) lgkmcnt(0)
    s_barrier
    s_add_u32 s50, s50, 1
    s_cmp_lt_u32 s50, 4
    s_cbranch_scc1 L_Aper
L_Aend:
    v_lshrrev_b32 v24, 3, v0
    v_and_b32 v24, 2, v24
    v_and_b32 v25, 7, v0
    v_xor_b32 v24, v24, v25
    v_lshrrev_b32 v25, 3, v0
    v_mul_u32_u24 v25, 1280, v25
    v_lshl_add_u32 v128, v24, 4, v25
    v_xor_b32 v129, 64, v128
    s_mul_i32 s51, s33, 6144
    s_mul_i32 s52, s6, 983040
    s_mul_i32 s59, s33, 61440
    s_add_u32 s52, s52, s59
    s_add_u32 s52, s52, 737280
    s_add_u32 m0, s51, 24576
    s_add_u32 s59, s52, 512
    buffer_load_dwordx4 v128, s[20:23], s59 offen lds
    s_add_u32 m0, s51, 25600
    s_add_u32 s59, s52, 10752
    buffer_load_dwordx4 v129, s[20:23], s59 offen lds
    s_add_u32 m0, s51, 26624
    s_add_u32 s59, s52, 20992
    buffer_load_dwordx4 v128, s[20:23], s59 offen lds
    s_add_u32 m0, s51, 27648
    s_add_u32 s59, s52, 31232
    buffer_load_dwordx4 v129, s[20:23], s59 offen lds
    s_add_u32 m0, s51, 28672
    s_add_u32 s59, s52, 41472
    buffer_load_dwordx4 v128, s[20:23], s59 offen lds
    s_add_u32 m0, s51, 29696
    s_add_u32 s59, s52, 51712
    buffer_load_dwordx4 v129, s[20:23], s59 offen lds
    s_waitcnt vmcnt(0)
    s_barrier
    s_add_u32 m0, s51, 49152
    s_add_u32 s59, s52, 640
    buffer_load_dwordx4 v128, s[20:23], s59 offen lds
    s_add_u32 m0, s51, 50176
    s_add_u32 s59, s52, 10880
    buffer_load_dwordx4 v129, s[20:23], s59 offen lds
    s_add_u32 m0, s51, 51200
    s_add_u32 s59, s52, 21120
    buffer_load_dwordx4 v128, s[20:23], s59 offen lds
    s_add_u32 m0, s51, 52224
    s_add_u32 s59, s52, 31360
    buffer_load_dwordx4 v129, s[20:23], s59 offen lds
    s_add_u32 m0, s51, 53248
    s_add_u32 s59, s52, 41600
    buffer_load_dwordx4 v128, s[20:23], s59 offen lds
    s_add_u32 m0, s51, 54272
    s_add_u32 s59, s52, 51840
    buffer_load_dwordx4 v129, s[20:23], s59 offen lds
    s_add_u32 m0, s51, 73728
    s_add_u32 s59, s52, 768
    buffer_load_dwordx4 v128, s[20:23], s59 offen lds
    s_add_u32 m0, s51, 74752
    s_add_u32 s59, s52, 11008
    buffer_load_dwordx4 v129, s[20:23], s59 offen lds
    s_add_u32 m0, s51, 75776
    s_add_u32 s59, s52, 21248
    buffer_load_dwordx4 v128, s[20:23], s59 offen lds
    s_add_u32 m0, s51, 76800
    s_add_u32 s59, s52, 31488
    buffer_load_dwordx4 v129, s[20:23], s59 offen lds
    s_add_u32 m0, s51, 77824
    s_add_u32 s59, s52, 41728
    buffer_load_dwordx4 v128, s[20:23], s59 offen lds
    s_add_u32 m0, s51, 78848
    s_add_u32 s59, s52, 51968
    buffer_load_dwordx4 v129, s[20:23], s59 offen lds
    s_waitcnt vmcnt(6)
    s_barrier
    s_add_u32 m0, s51, 98304
    s_add_u32 s59, s52, 896
    buffer_load_dwordx4 v128, s[20:23], s59 offen lds
    s_add_u32 m0, s51, 99328
    s_add_u32 s59, s52, 11136
    buffer_load_dwordx4 v129, s[20:23], s59 offen lds
    s_add_u32 m0, s51, 100352
    s_add_u32 s59, s52, 21376
    buffer_load_dwordx4 v128, s[20:23], s59 offen lds
    s_add_u32 m0, s51, 101376
    s_add_u32 s59, s52, 31616
    buffer_load_dwordx4 v129, s[20:23], s59 offen lds
    s_add_u32 m0, s51, 102400
    s_add_u32 s59, s52, 41856
    buffer_load_dwordx4 v128, s[20:23], s59 offen lds
    s_add_u32 m0, s51, 103424
    s_add_u32 s59, s52, 52096
    buffer_load_dwordx4 v129, s[20:23], s59 offen lds
    s_add_u32 m0, s51, 0
    s_add_u32 s59, s52, 1024
    buffer_load_dwordx4 v128, s[20:23], s59 offen lds
    s_add_u32 m0, s51, 1024
    s_add_u32 s59, s52, 11264
    buffer_load_dwordx4 v129, s[20:23], s59 offen lds
    s_add_u32 m0, s51, 2048
    s_add_u32 s59, s52, 21504
    buffer_load_dwordx4 v128, s[20:23], s59 offen lds
    s_add_u32 m0, s51, 3072
    s_add_u32 s59, s52, 31744
    buffer_load_dwordx4 v129, s[20:23], s59 offen lds
    s_add_u32 m0, s51, 4096
    s_add_u32 s59, s52, 41984
    buffer_load_dwordx4 v128, s[20:23], s59 offen lds
    s_add_u32 m0, s51, 5120
    s_add_u32 s59, s52, 52224
    buffer_load_dwordx4 v129, s[20:23], s59 offen lds
    s_waitcnt vmcnt(6)
    s_barrier
    s_add_u32 m0, s51, 24576
    s_add_u32 s59, s52, 1152
    buffer_load_dwordx4 v128, s[20:23], s59 offen lds
    s_add_u32 m0, s51, 25600
    s_add_u32 s59, s52, 11392
    buffer_load_dwordx4 v129, s[20:23], s59 offen lds
    s_add_u32 m0, s51, 26624
    s_add_u32 s59, s52, 21632
    buffer_load_dwordx4 v128, s[20:23], s59 offen lds
    s_add_u32 m0, s51, 27648
    s_add_u32 s59, s52, 31872
    buffer_load_dwordx4 v129, s[20:23], s59 offen lds
    s_add_u32 m0, s51, 28672
    s_add_u32 s59, s52, 42112
    buffer_load_dwordx4 v128, s[20:23], s59 offen lds
    s_add_u32 m0, s51, 29696
    s_add_u32 s59, s52, 52352
    buffer_load_dwordx4 v129, s[20:23], s59 offen lds
    s_waitcnt vmcnt(0)
    s_barrier
    s_cmp_lg_u32 s33, 0
    s_cbranch_scc1 L_red
    s_lshl_b32 s45, s44, 3
    v_mov_b32 v28, s45
    s_mov_b32 s40, 0
    s_nop 0
L_in:
    buffer_load_dword v29, v28, s[36:39], 0 offen sc1
    s_add_u32 s40, s40, 1
    s_waitcnt vmcnt(0) lgkmcnt(0)
    v_readfirstlane_b32 s41, v29
    s_nop 1
    s_cmp_ge_u32 s41, 8
    s_nop 1
    s_cbranch_scc1 L_in_ok
    s_cmp_lt_u32 s40, 131072
    s_cbranch_scc1 L_in
L_in_ok:
    v_lshlrev_b32 v28, 2, v0
    v_add_u32 v28, 155648, v28
    ds_write_b32 v28, v54
    v_mov_b32 v29, 0
    ds_write_b32 v28, v29 offset:256
    s_waitcnt lgkmcnt(0)
L_red:
    v_mbcnt_lo_u32_b32 v0, -1, 0
    v_mbcnt_hi_u32_b32 v0, -1, v0
    s_lshl_b32 s44, s5, 4
    s_add_u32 s44, s44, s7
    s_lshl_b32 s45, s44, 10
    s_add_u32 s45, s45, 25165824
    s_lshl_b32 s46, s6, 7
    s_add_u32 s46, s46, s45
    s_lshl_b32 s40, s32, 2
    s_add_u32 s40, s40, 155648
    v_mov_b32 v3, s40
    v_and_b32 v28, 7, v0
    v_lshlrev_b32 v29, 7, v28
    v_lshlrev_b32 v1, 4, v0
    v_lshlrev_b32 v28, 2, v28
    s_cmp_lg_u32 s32, 4
    s_barrier
    s_cbranch_scc1 L_go
    v_add_u32 v55, 1, v55
    s_mov_b64 exec, 0xff
    buffer_store_dword v55, v29, s[28:31], s47 offen sc1
    s_mov_b64 exec, -1
L_go:
    s_cmp_eq_u32 s32, s6
    s_cbranch_scc0 L_fetch
    v_add_u32 v5, 155648, v28
    ds_read_b32 v4, v5
    s_mov_b64 exec, 0xff
    s_mov_b32 s40, 0
    s_waitcnt lgkmcnt(0)
L_poll:
    buffer_load_dword v30, v28, s[28:31], s46 offen sc1
    s_add_u32 s40, s40, 1
    s_waitcnt vmcnt(0) lgkmcnt(0)
    v_cmp_ne_u32 vcc, v30, v4
    s_nop 1
    v_cndmask_b32 v6, 0, 1, vcc
    ds_write_b32 v5, v6 offset:256
    s_bitset1_b32 vcc_lo, s6
    s_cmp_eq_u32 vcc_lo, 0xff
    s_waitcnt lgkmcnt(0)
    s_cbranch_scc1 L_poll_ok
    s_sleep 4
    s_cmp_lt_u32 s40, 131072
    s_cbranch_scc1 L_poll
L_poll_ok:
    s_mov_b64 exec, -1
    v_and_b32 v62, 31, v0
    v_mul_u32_u24 v62, 2560, v62
    v_lshrrev_b32 v63, 5, v0
    v_lshl_add_u32 v62, v63, 4, v62
    s_and_b32 s41, s32, 3
    s_lshl_b32 s41, s41, 4
    v_lshrrev_b32 v64, 2, v0
    v_add_u32 v64, s41, v64
    v_and_b32 v65, 31, v64
    v_mul_u32_u24 v65, 2560, v65
    v_lshrrev_b32 v64, 5, v64
    v_lshl_add_u32 v65, v64, 4, v65
    v_and_b32 v64, 3, v0
    v_lshl_add_u32 v67, v64, 2, v65
    s_lshl_b32 s41, s32, 10
    s_add_u32 s41, s41, 49152
    v_add_u32 v63, s41, v1
    v_add_u32 v66, 40960, v63
    s_lshl_b32 s41, s32, 8
    s_add_u32 s41, s41, 57344
    v_lshlrev_b32 v64, 2, v0
    v_add_u32 v64, s41, v64
    v_add_u32 v65, 40960, v64
    s_mul_i32 s43, s6, 10
    s_add_u32 s43, s43, s32
    s_and_b32 s41, s43, 1
    s_lshl_b32 s41, s41, 5
    s_lshr_b32 s43, s43, 1
    s_lshl_b32 s52, s7, 6
    s_add_u32 s52, s52, s41
    s_mul_i32 s52, s52, 2560
    s_mul_i32 s41, s5, 1280
    s_add_u32 s52, s52, s41
    s_lshl_b32 s43, s43, 5
    s_add_u32 s52, s52, s43
    s_lshr_b32 s54, s32, 2
    s_add_u32 s54, s54, 8
    s_mul_i32 s43, s6, 10
    s_add_u32 s43, s43, s54
    s_and_b32 s41, s43, 1
    s_lshl_b32 s41, s41, 5
    s_lshr_b32 s43, s43, 1
    s_lshl_b32 s53, s7, 6
    s_add_u32 s53, s53, s41
    s_mul_i32 s53, s53, 2560
    s_mul_i32 s41, s5, 1280
    s_add_u32 s53, s53, s41
    s_lshl_b32 s43, s43, 5
    s_add_u32 s53, s53, s43
    s_mov_b32 s50, 0x3f80
    s_mov_b32 s51, 0x3f800000
    s_branch L_staged
L_fetch:
    s_lshl_b32 s45, s44, 3
    s_add_u32 s45, s45, s32
    s_mul_i32 s45, s45, 81920
    s_mul_i32 s43, s6, 10240
    s_add_u32 s45, s45, s43
    s_mul_i32 s43, s32, 10240
    s_add_u32 s43, s43, 49152
    s_mov_b32 s40, 0
L_seen:
    ds_read_b32 v4, v3 offset:256
    s_add_u32 s40, s40, 1
    s_waitcnt vmcnt(0) lgkmcnt(0)
    v_readfirstlane_b32 s41, v4
    s_nop 1
    s_cmp_lg_u32 s41, 0
    s_nop 1
    s_cbranch_scc1 L_seen_ok
    s_sleep 1
    s_cmp_lt_u32 s40, 4194304
    s_cbranch_scc1 L_seen
L_seen_ok:
    v_add_u32 v3, s43, v1
    buffer_load_dwordx4 v[8:11], v1, s[28:31], s45 offen offset:0 sc1
    buffer_load_dwordx4 v[12:15], v1, s[28:31], s45 offen offset:1024 sc1
    buffer_load_dwordx4 v[16:19], v1, s[28:31], s45 offen offset:2048 sc1
    buffer_load_dwordx4 v[20:23], v1, s[28:31], s45 offen offset:3072 sc1
    s_add_u32 s45, s45, 4096
    buffer_load_dwordx4 v[24:27], v1, s[28:31], s45 offen offset:0 sc1
    buffer_load_dwordx4 v[28:31], v1, s[28:31], s45 offen offset:1024 sc1
    buffer_load_dwordx4 v[32:35], v1, s[28:31], s45 offen offset:2048 sc1
    buffer_load_dwordx4 v[36:39], v1, s[28:31], s45 offen offset:3072 sc1
    s_add_u32 s45, s45, 4096
    buffer_load_dwordx4 v[40:43], v1, s[28:31], s45 offen offset:0 sc1
    buffer_load_dwordx4 v[44:47], v1, s[28:31], s45 offen offset:1024 sc1
    v_and_b32 v62, 31, v0
    v_mul_u32_u24 v62, 2560, v62
    v_lshrrev_b32 v63, 5, v0
    v_lshl_add_u32 v62, v63, 4, v62
    s_and_b32 s41, s32, 3
    s_lshl_b32 s41, s41, 4
    v_lshrrev_b32 v64, 2, v0
    v_add_u32 v64, s41, v64
    v_and_b32 v65, 31, v64
    v_mul_u32_u24 v65, 2560, v65
    v_lshrrev_b32 v64, 5, v64
    v_lshl_add_u32 v65, v64, 4, v65
    v_and_b32 v64, 3, v0
    v_lshl_add_u32 v67, v64, 2, v65
    s_lshl_b32 s41, s32, 10
    s_add_u32 s41, s41, 49152
    v_add_u32 v63, s41, v1
    v_add_u32 v66, 40960, v63
    s_lshl_b32 s41, s32, 8
    s_add_u32 s41, s41, 57344
    v_lshlrev_b32 v64, 2, v0
    v_add_u32 v64, s41, v64
    v_add_u32 v65, 40960, v64
    s_mul_i32 s43, s6, 10
    s_add_u32 s43, s43, s32
    s_and_b32 s41, s43, 1
    s_lshl_b32 s41, s41, 5
    s_lshr_b32 s43, s43, 1
    s_lshl_b32 s52, s7, 6
    s_add_u32 s52, s52, s41
    s_mul_i32 s52, s52, 2560
    s_mul_i32 s41, s5, 1280
    s_add_u32 s52, s52, s41
    s_lshl_b32 s43, s43, 5
    s_add_u32 s52, s52, s43
    s_lshr_b32 s54, s32, 2
    s_add_u32 s54, s54, 8
    s_mul_i32 s43, s6, 10
    s_add_u32 s43, s43, s54
    s_and_b32 s41, s43, 1
    s_lshl_b32 s41, s41, 5
    s_lshr_b32 s43, s43, 1
    s_lshl_b32 s53, s7, 6
    s_add_u32 s53, s53, s41
    s_mul_i32 s53, s53, 2560
    s_mul_i32 s41, s5, 1280
    s_add_u32 s53, s53, s41
    s_lshl_b32 s43, s43, 5
    s_add_u32 s53, s53, s43
    s_mov_b32 s50, 0x3f80
    s_mov_b32 s51, 0x3f800000
    s_waitcnt vmcnt(9)
    ds_write_b128 v3, v[8:11] offset:0
    s_waitcnt vmcnt(8)
    ds_write_b128 v3, v[12:15] offset:1024
    s_waitcnt vmcnt(7)
    ds_write_b128 v3, v[16:19] offset:2048
    s_waitcnt vmcnt(6)
    ds_write_b128 v3, v[20:23] offset:3072
    s_waitcnt vmcnt(5)
    ds_write_b128 v3, v[24:27] offset:4096
    s_waitcnt vmcnt(4)
    ds_write_b128 v3, v[28:31] offset:5120
    s_waitcnt vmcnt(3)
    ds_write_b128 v3, v[32:35] offset:6144
    s_waitcnt vmcnt(2)
    ds_write_b128 v3, v[36:39] offset:7168
    s_waitcnt vmcnt(1)
    ds_write_b128 v3, v[40:43] offset:8192
    s_waitcnt vmcnt(0)
    ds_write_b128 v3, v[44:47] offset:9216
    s_waitcnt lgkmcnt(0)
L_staged:
    s_barrier
    ds_read_b128 v[8:11], v63 offset:0
    ds_read_b32 v40, v64 offset:0
    ds_read_b128 v[12:15], v63 offset:10240
    ds_read_b32 v41, v64 offset:10240
    ds_read_b128 v[16:19], v63 offset:20480
    ds_read_b32 v42, v64 offset:20480
    ds_read_b128 v[20:23], v63 offset:30720
    ds_read_b32 v43, v64 offset:30720
    ds_read_b128 v[24:27], v66 offset:0
    ds_read_b32 v44, v65 offset:0
    ds_read_b128 v[28:31], v66 offset:10240
    ds_read_b32 v45, v65 offset:10240
    ds_read_b128 v[32:35], v66 offset:20480
    ds_read_b32 v46, v65 offset:20480
    ds_read_b128 v[36:39], v66 offset:30720
    ds_read_b32 v47, v65 offset:30720
    s_waitcnt lgkmcnt(15)
    v_lshlrev_b32 v48, 16, v8
    v_and_b32 v49, 0xffff0000, v8
    v_lshlrev_b32 v50, 16, v9
    v_and_b32 v51, 0xffff0000, v9
    v_lshlrev_b32 v52, 16, v10
    v_and_b32 v53, 0xffff0000, v10
    v_lshlrev_b32 v54, 16, v11
    v_and_b32 v55, 0xffff0000, v11
    s_waitcnt lgkmcnt(14)
    v_lshlrev_b32 v56, 16, v40
    v_and_b32 v57, 0xffff0000, v40
    s_waitcnt lgkmcnt(13)
    v_dot2_f32_bf16 v48, v12, s50, v48
    v_dot2_f32_bf16 v49, v12, s51, v49
    v_dot2_f32_bf16 v50, v13, s50, v50
    v_dot2_f32_bf16 v51, v13, s51, v51
    v_dot2_f32_bf16 v52, v14, s50, v52
    v_dot2_f32_bf16 v53, v14, s51, v53
    v_dot2_f32_bf16 v54, v15, s50, v54
    v_dot2_f32_bf16 v55, v15, s51, v55
    s_waitcnt lgkmcnt(12)
    v_dot2_f32_bf16 v56, v41, s50, v56
    v_dot2_f32_bf16 v57, v41, s51, v57
    s_waitcnt lgkmcnt(11)
    v_dot2_f32_bf16 v48, v16, s50, v48
    v_dot2_f32_bf16 v49, v16, s51, v49
    v_dot2_f32_bf16 v50, v17, s50, v50
    v_dot2_f32_bf16 v51, v17, s51, v51
    v_dot2_f32_bf16 v52, v18, s50, v52
    v_dot2_f32_bf16 v53, v18, s51, v53
    v_dot2_f32_bf16 v54, v19, s50, v54
    v_dot2_f32_bf16 v55, v19, s51, v55
    s_waitcnt lgkmcnt(10)
    v_dot2_f32_bf16 v56, v42, s50, v56
    v_dot2_f32_bf16 v57, v42, s51, v57
    s_waitcnt lgkmcnt(9)
    v_dot2_f32_bf16 v48, v20, s50, v48
    v_dot2_f32_bf16 v49, v20, s51, v49
    v_dot2_f32_bf16 v50, v21, s50, v50
    v_dot2_f32_bf16 v51, v21, s51, v51
    v_dot2_f32_bf16 v52, v22, s50, v52
    v_dot2_f32_bf16 v53, v22, s51, v53
    v_dot2_f32_bf16 v54, v23, s50, v54
    v_dot2_f32_bf16 v55, v23, s51, v55
    s_waitcnt lgkmcnt(8)
    v_dot2_f32_bf16 v56, v43, s50, v56
    v_dot2_f32_bf16 v57, v43, s51, v57
    s_waitcnt lgkmcnt(7)
    v_dot2_f32_bf16 v48, v24, s50, v48
    v_dot2_f32_bf16 v49, v24, s51, v49
    v_dot2_f32_bf16 v50, v25, s50, v50
    v_dot2_f32_bf16 v51, v25, s51, v51
    v_dot2_f32_bf16 v52, v26, s50, v52
    v_dot2_f32_bf16 v53, v26, s51, v53
    v_dot2_f32_bf16 v54, v27, s50, v54
    v_dot2_f32_bf16 v55, v27, s51, v55
    s_waitcnt lgkmcnt(6)
    v_dot2_f32_bf16 v56, v44, s50, v56
    v_dot2_f32_bf16 v57, v44, s51, v57
    s_waitcnt lgkmcnt(5)
    v_dot2_f32_bf16 v48, v28, s50, v48
    v_dot2_f32_bf16 v49, v28, s51, v49
    v_dot2_f32_bf16 v50, v29, s50, v50
    v_dot2_f32_bf16 v51, v29, s51, v51
    v_dot2_f32_bf16 v52, v30, s50, v52
    v_dot2_f32_bf16 v53, v30, s51, v53
    v_dot2_f32_bf16 v54, v31, s50, v54
    v_dot2_f32_bf16 v55, v31, s51, v55
    s_waitcnt lgkmcnt(4)
    v_dot2_f32_bf16 v56, v45, s50, v56
    v_dot2_f32_bf16 v57, v45, s51, v57
    s_waitcnt lgkmcnt(3)
    v_dot2_f32_bf16 v48, v32, s50, v48
    v_dot2_f32_bf16 v49, v32, s51, v49
    v_dot2_f32_bf16 v50, v33, s50, v50
    v_dot2_f32_bf16 v51, v33, s51, v51
    v_dot2_f32_bf16 v52, v34, s50, v52
    v_dot2_f32_bf16 v53, v34, s51, v53
    v_dot2_f32_bf16 v54, v35, s50, v54
    v_dot2_f32_bf16 v55, v35, s51, v55
    s_waitcnt lgkmcnt(2)
    v_dot2_f32_bf16 v56, v46, s50, v56
    v_dot2_f32_bf16 v57, v46, s51, v57
    s_waitcnt lgkmcnt(1)
    v_dot2_f32_bf16 v48, v36, s50, v48
    v_dot2_f32_bf16 v49, v36, s51, v49
    v_dot2_f32_bf16 v50, v37, s50, v50
    v_dot2_f32_bf16 v51, v37, s51, v51
    v_dot2_f32_bf16 v52, v38, s50, v52
    v_dot2_f32_bf16 v53, v38, s51, v53
    v_dot2_f32_bf16 v54, v39, s50, v54
    v_dot2_f32_bf16 v55, v39, s51, v55
    s_waitcnt lgkmcnt(0)
    v_dot2_f32_bf16 v56, v47, s50, v56
    v_dot2_f32_bf16 v57, v47, s51, v57
    s_nop 2
    v_cvt_pk_bf16_f32 v8, v48, v49
    v_cvt_pk_bf16_f32 v9, v50, v51
    v_cvt_pk_bf16_f32 v10, v52, v53
    v_cvt_pk_bf16_f32 v11, v54, v55
    v_cvt_pk_bf16_f32 v12, v56, v57
    buffer_store_dwordx4 v[8:11], v62, s[64:67], s52 offen
    buffer_store_dword v12, v67, s[64:67], s53 offen
    s_nop 0
L_fin:
    s_endpgm
L_P:
    v_lshrrev_b32 v22, 4, v0
    v_and_b32 v20, 1, v22
    v_bfe_u32 v21, v0, 2, 2
    v_lshl_add_u32 v22, v22, 3, v21
    v_bfe_u32 v23, v0, 1, 1
    v_and_b32 v24, 1, v0
    v_lshlrev_b32 v24, 3, v24
    v_and_b32 v25, 2, v21
    v_lshl_or_b32 v25, v20, 2, v25
    v_mul_u32_u24 v27, 384, v22
    v_add_u32 v27, v27, v24
    s_mul_i32 s57, s33, 6
    s_add_u32 s57, s57, 0
    v_add_u32 v26, s57, v23
    v_xor_b32 v26, v26, v25
    v_lshl_add_u32 v26, v26, 4, v27
    v_add_u32 v10, 49152, v26
    v_add_u32 v168, 24576, v26
    v_add_u32 v171, 73728, v26
    s_mul_i32 s57, s33, 6
    s_add_u32 s57, s57, 2
    v_add_u32 v26, s57, v23
    v_xor_b32 v26, v26, v25
    v_lshl_add_u32 v26, v26, 4, v27
    v_add_u32 v11, 49152, v26
    v_add_u32 v169, 24576, v26
    v_add_u32 v172, 73728, v26
    s_mul_i32 s57, s33, 6
    s_add_u32 s57, s57, 4
    v_add_u32 v26, s57, v23
    v_xor_b32 v26, v26, v25
    v_lshl_add_u32 v26, v26, 4, v27
    v_add_u32 v12, 49152, v26
    v_add_u32 v170, 24576, v26
    v_add_u32 v173, 73728, v26
    v_lshl_or_b32 v25, v20, 2, v21
    v_lshlrev_b32 v25, 1, v25
    v_mul_u32_u24 v27, 1280, v22
    v_add_u32 v27, v27, v24
    s_lshl_b32 s57, s33, 1
    v_add_u32 v26, s57, v23
    v_xor_b32 v26, v26, v25
    v_lshl_add_u32 v26, v26, 4, v27
    v_add_u32 v13, 49152, v26
    v_xor_b32 v14, 128, v13
    v_and_b32 v20, 15, v0
    v_lshrrev_b32 v21, 4, v0
    v_and_b32 v22, 6, v20
    v_xor_b32 v23, v22, v21
    v_lshlrev_b32 v23, 4, v23
    v_lshl_add_u32 v24, v20, 7, v23
    v_add_u32 v15, 81920, v24
    v_add_u32 v174, 122880, v24
    v_xor_b32 v175, 64, v174
    v_mul_u32_u24 v20, 384, v20
    v_add_u32 v20, 131072, v20
    v_bfe_u32 v22, v0, 1, 3
    v_xor_b32 v23, v22, v21
    v_lshl_add_u32 v16, v23, 4, v20
    v_lshrrev_b32 v23, 1, v21
    v_xor_b32 v23, v23, v22
    v_lshl_add_u32 v23, v23, 4, v20
    v_and_b32 v21, 1, v21
    v_lshl_add_u32 v18, v21, 3, v23
    s_and_b32 s57, s33, 1
    s_lshl_b32 s57, s57, 2
    v_add_u32 v28, 0, v0
    v_add_u32 v32, 64, v0
    v_add_u32 v36, 128, v0
    v_lshrrev_b32 v40, 3, v0
    v_mul_u32_u24 v31, 2731, v28
    v_mul_u32_u24 v35, 2731, v32
    v_mul_u32_u24 v39, 2731, v36
    v_and_b32 v40, 6, v40
    v_lshrrev_b32 v29, 16, v31
    v_lshrrev_b32 v33, 16, v35
    v_lshrrev_b32 v37, 16, v39
    v_and_b32 v41, 7, v0
    v_mul_u32_u24 v31, 24, v29
    v_mul_u32_u24 v35, 24, v33
    v_mul_u32_u24 v39, 24, v37
    v_xor_b32 v40, v40, v41
    v_sub_u32 v30, v28, v31
    v_sub_u32 v34, v32, v35
    v_sub_u32 v38, v36, v39
    v_lshrrev_b32 v41, 3, v0
    v_and_or_b32 v31, v29, 2, s57
    v_and_or_b32 v35, v33, 2, s57
    v_and_or_b32 v39, v37, 2, s57
    v_mul_u32_u24 v41, 1280, v41
    v_xor_b32 v30, v30, v31
    v_xor_b32 v34, v34, v35
    v_xor_b32 v38, v38, v39
    v_lshl_add_u32 v4, v40, 4, v41
    v_mul_u32_u24 v29, 12288, v29
    v_mul_u32_u24 v33, 12288, v33
    v_mul_u32_u24 v37, 12288, v37
    v_lshl_add_u32 v29, v30, 4, v29
    v_lshl_add_u32 v33, v34, 4, v33
    v_lshl_add_u32 v37, v38, 4, v37
    v_subrev_u32 v1, 0, v29
    v_subrev_u32 v2, 1024, v33
    v_subrev_u32 v3, 2048, v37
    s_lshr_b32 s57, s33, 1
    s_lshl_b32 s57, s57, 2
    v_add_u32 v20, 0, v0
    v_mul_u32_u24 v20, 820, v20
    v_lshrrev_b32 v20, 16, v20
    v_or_b32 v20, s57, v20
    v_lshlrev_b32 v20, 1, v20
    v_xor_b32 v20, v20, v0
    v_lshlrev_b32 v5, 4, v20
    v_add_u32 v20, 64, v0
    v_mul_u32_u24 v20, 820, v20
    v_lshrrev_b32 v20, 16, v20
    v_or_b32 v20, s57, v20
    v_lshlrev_b32 v20, 1, v20
    v_xor_b32 v20, v20, v0
    v_lshlrev_b32 v6, 4, v20
    v_add_u32 v20, 128, v0
    v_mul_u32_u24 v20, 820, v20
    v_lshrrev_b32 v20, 16, v20
    v_or_b32 v20, s57, v20
    v_lshlrev_b32 v20, 1, v20
    v_xor_b32 v20, v20, v0
    v_lshlrev_b32 v7, 4, v20
    v_add_u32 v20, 192, v0
    v_mul_u32_u24 v20, 820, v20
    v_lshrrev_b32 v20, 16, v20
    v_or_b32 v20, s57, v20
    v_lshlrev_b32 v20, 1, v20
    v_xor_b32 v20, v20, v0
    v_lshlrev_b32 v8, 4, v20
    v_add_u32 v20, 256, v0
    v_mul_u32_u24 v20, 820, v20
    v_lshrrev_b32 v20, 16, v20
    v_or_b32 v20, s57, v20
    v_lshlrev_b32 v20, 1, v20
    v_xor_b32 v20, v20, v0
    v_lshlrev_b32 v9, 4, v20
    s_mul_i32 s51, s33, 3072
    s_lshl_b32 s52, s33, 10
    s_mul_i32 s54, s6, 1536
    s_mul_i32 s57, s33, 98304
    s_add_u32 s54, s54, s57
    s_add_u32 s54, s54, 384
    s_mul_i32 s55, s7, 81920
    s_mul_i32 s57, s33, 10240
    s_add_u32 s55, s55, s57
    s_mul_i32 s53, s33, 5120
    s_mul_i32 s56, s6, 983040
    s_add_u32 s56, s56, s53
    s_mov_b32 s50, 1
    s_barrier
L_Ppro:
    ds_read_b128 v[96:99], v174 offset:0
    ds_read_b64_tr_b16 v[144:145], v171 offset:0
    ds_read_b64_tr_b16 v[146:147], v171 offset:1536
    ds_read_b128 v[100:103], v174 offset:2048
    ds_read_b128 v[104:107], v174 offset:4096
    ds_read_b128 v[108:111], v174 offset:6144
    ds_read_b64_tr_b16 v[148:149], v172 offset:0
    ds_read_b64_tr_b16 v[150:151], v172 offset:1536
    ds_read_b64_tr_b16 v[152:153], v173 offset:0
    ds_read_b64_tr_b16 v[154:155], v173 offset:1536
    s_waitcnt lgkmcnt(7)
    v_mfma_f32_16x16x32_bf16 v[48:51], v[144:147], v[96:99], 0
    ds_read_b128 v[112:115], v175 offset:0
    ds_read_b64_tr_b16 v[156:157], v171 offset:12288
    ds_read_b64_tr_b16 v[158:159], v171 offset:13824
    ds_read_b128 v[116:119], v175 offset:2048
    ds_read_b128 v[120:123], v175 offset:4096
    ds_read_b128 v[124:127], v175 offset:6144
    s_waitcnt lgkmcnt(12)
    v_mfma_f32_16x16x32_bf16 v[52:55], v[144:147], v[100:103], 0
    s_waitcnt lgkmcnt(11)
    v_mfma_f32_16x16x32_bf16 v[56:59], v[144:147], v[104:107], 0
    s_waitcnt lgkmcnt(10)
    v_mfma_f32_16x16x32_bf16 v[60:63], v[144:147], v[108:111], 0
    s_waitcnt lgkmcnt(8)
    v_mfma_f32_16x16x32_bf16 v[64:67], v[148:151], v[96:99], 0
    ds_read_b64_tr_b16 v[160:161], v172 offset:12288
    ds_read_b64_tr_b16 v[162:163], v172 offset:13824
    v_mfma_f32_16x16x32_bf16 v[68:71], v[148:151], v[100:103], 0
    v_mfma_f32_16x16x32_bf16 v[72:75], v[148:151], v[104:107], 0
    v_mfma_f32_16x16x32_bf16 v[76:79], v[148:151], v[108:111], 0
    s_waitcnt lgkmcnt(8)
    v_mfma_f32_16x16x32_bf16 v[80:83], v[152:155], v[96:99], 0
    ds_read_b64_tr_b16 v[164:165], v173 offset:12288
    ds_read_b64_tr_b16 v[166:167], v173 offset:13824
    v_mfma_f32_16x16x32_bf16 v[84:87], v[152:155], v[100:103], 0
    v_mfma_f32_16x16x32_bf16 v[88:91], v[152:155], v[104:107], 0
    v_mfma_f32_16x16x32_bf16 v[92:95], v[152:155], v[108:111], 0
    s_waitcnt lgkmcnt(7)
    v_mfma_f32_16x16x32_bf16 v[48:51], v[156:159], v[112:115], v[48:51]
    s_barrier
    ds_read_b128 v[128:131], v174 offset:32768
    ds_read_b64_tr_b16 v[144:145], v171 offset:24576
    ds_read_b64_tr_b16 v[146:147], v171 offset:26112
    ds_read_b128 v[132:135], v174 offset:34816
    ds_read_b128 v[136:139], v174 offset:36864
    ds_read_b128 v[140:143], v174 offset:38912
    s_waitcnt lgkmcnt(12)
    v_mfma_f32_16x16x32_bf16 v[52:55], v[156:159], v[116:119], v[52:55]
    s_waitcnt lgkmcnt(11)
    v_mfma_f32_16x16x32_bf16 v[56:59], v[156:159], v[120:123], v[56:59]
    s_waitcnt lgkmcnt(10)
    v_mfma_f32_16x16x32_bf16 v[60:63], v[156:159], v[124:127], v[60:63]
    s_waitcnt lgkmcnt(8)
    v_mfma_f32_16x16x32_bf16 v[64:67], v[160:163], v[112:115], v[64:67]
    ds_read_b64_tr_b16 v[148:149], v172 offset:24576
    ds_read_b64_tr_b16 v[150:151], v172 offset:26112
    v_mfma_f32_16x16x32_bf16 v[68:71], v[160:163], v[116:119], v[68:71]
    v_mfma_f32_16x16x32_bf16 v[72:75], v[160:163], v[120:123], v[72:75]
    v_mfma_f32_16x16x32_bf16 v[76:79], v[160:163], v[124:127], v[76:79]
    s_waitcnt lgkmcnt(8)
    v_mfma_f32_16x16x32_bf16 v[80:83], v[164:167], v[112:115], v[80:83]
    ds_read_b64_tr_b16 v[152:153], v173 offset:24576
    ds_read_b64_tr_b16 v[154:155], v173 offset:26112
    v_mfma_f32_16x16x32_bf16 v[84:87], v[164:167], v[116:119], v[84:87]
    v_mfma_f32_16x16x32_bf16 v[88:91], v[164:167], v[120:123], v[88:91]
    v_mfma_f32_16x16x32_bf16 v[92:95], v[164:167], v[124:127], v[92:95]
    s_waitcnt lgkmcnt(7)
    v_mfma_f32_16x16x32_bf16 v[48:51], v[144:147], v[128:131], v[48:51]
    ds_read_b128 v[96:99], v175 offset:32768
    ds_read_b64_tr_b16 v[156:157], v171 offset:36864
    ds_read_b64_tr_b16 v[158:159], v171 offset:38400
    ds_read_b128 v[100:103], v175 offset:34816
    ds_read_b128 v[104:107], v175 offset:36864
    ds_read_b128 v[108:111], v175 offset:38912
    s_waitcnt lgkmcnt(12)
    v_mfma_f32_16x16x32_bf16 v[52:55], v[144:147], v[132:135], v[52:55]
    s_waitcnt lgkmcnt(11)
    v_mfma_f32_16x16x32_bf16 v[56:59], v[144:147], v[136:139], v[56:59]
    s_waitcnt lgkmcnt(10)
    v_mfma_f32_16x16x32_bf16 v[60:63], v[144:147], v[140:143], v[60:63]
    s_waitcnt lgkmcnt(8)
    v_mfma_f32_16x16x32_bf16 v[64:67], v[148:151], v[128:131], v[64:67]
    ds_read_b64_tr_b16 v[160:161], v172 offset:36864
    ds_read_b64_tr_b16 v[162:163], v172 offset:38400
    v_mfma_f32_16x16x32_bf16 v[68:71], v[148:151], v[132:135], v[68:71]
    v_mfma_f32_16x16x32_bf16 v[72:75], v[148:151], v[136:139], v[72:75]
    v_mfma_f32_16x16x32_bf16 v[76:79], v[148:151], v[140:143], v[76:79]
    s_waitcnt lgkmcnt(8)
    v_mfma_f32_16x16x32_bf16 v[80:83], v[152:155], v[128:131], v[80:83]
    ds_read_b64_tr_b16 v[164:165], v173 offset:36864
    ds_read_b64_tr_b16 v[166:167], v173 offset:38400
    v_mfma_f32_16x16x32_bf16 v[84:87], v[152:155], v[132:135], v[84:87]
    v_mfma_f32_16x16x32_bf16 v[88:91], v[152:155], v[136:139], v[88:91]
    v_mfma_f32_16x16x32_bf16 v[92:95], v[152:155], v[140:143], v[92:95]
    s_waitcnt lgkmcnt(7)
    v_mfma_f32_16x16x32_bf16 v[48:51], v[156:159], v[96:99], v[48:51]
    s_barrier
    ds_read_b128 v[112:115], v174 offset:8192
    ds_read_b64_tr_b16 v[144:145], v168 offset:0
    ds_read_b64_tr_b16 v[146:147], v168 offset:1536
    ds_read_b128 v[116:119], v174 offset:10240
    ds_read_b128 v[120:123], v174 offset:12288
    ds_read_b128 v[124:127], v174 offset:14336
    s_waitcnt lgkmcnt(12)
    v_mfma_f32_16x16x32_bf16 v[52:55], v[156:159], v[100:103], v[52:55]
    s_waitcnt lgkmcnt(11)
    v_mfma_f32_16x16x32_bf16 v[56:59], v[156:159], v[104:107], v[56:59]
    s_waitcnt lgkmcnt(10)
    v_mfma_f32_16x16x32_bf16 v[60:63], v[156:159], v[108:111], v[60:63]
    s_waitcnt lgkmcnt(8)
    v_mfma_f32_16x16x32_bf16 v[64:67], v[160:163], v[96:99], v[64:67]
    ds_read_b64_tr_b16 v[148:149], v169 offset:0
    ds_read_b64_tr_b16 v[150:151], v169 offset:1536
    v_mfma_f32_16x16x32_bf16 v[68:71], v[160:163], v[100:103], v[68:71]
    v_mfma_f32_16x16x32_bf16 v[72:75], v[160:163], v[104:107], v[72:75]
    v_mfma_f32_16x16x32_bf16 v[76:79], v[160:163], v[108:111], v[76:79]
    s_waitcnt lgkmcnt(8)
    v_mfma_f32_16x16x32_bf16 v[80:83], v[164:167], v[96:99], v[80:83]
    ds_read_b64_tr_b16 v[152:153], v170 offset:0
    ds_read_b64_tr_b16 v[154:155], v170 offset:1536
    v_mfma_f32_16x16x32_bf16 v[84:87], v[164:167], v[100:103], v[84:87]
    v_mfma_f32_16x16x32_bf16 v[88:91], v[164:167], v[104:107], v[88:91]
    v_mfma_f32_16x16x32_bf16 v[92:95], v[164:167], v[108:111], v[92:95]
    s_waitcnt lgkmcnt(7)
    v_mfma_f32_16x16x32_bf16 v[48:51], v[144:147], v[112:115], v[48:51]
    ds_read_b128 v[128:131], v175 offset:8192
    ds_read_b64_tr_b16 v[156:157], v168 offset:12288
    ds_read_b64_tr_b16 v[158:159], v168 offset:13824
    ds_read_b128 v[132:135], v175 offset:10240
    ds_read_b128 v[136:139], v175 offset:12288
    ds_read_b128 v[140:143], v175 offset:14336
    s_waitcnt lgkmcnt(12)
    v_mfma_f32_16x16x32_bf16 v[52:55], v[144:147], v[116:119], v[52:55]
    s_waitcnt lgkmcnt(11)
    v_mfma_f32_16x16x32_bf16 v[56:59], v[144:147], v[120:123], v[56:59]
    s_waitcnt lgkmcnt(10)
    v_mfma_f32_16x16x32_bf16 v[60:63], v[144:147], v[124:127], v[60:63]
    s_waitcnt lgkmcnt(8)
    v_mfma_f32_16x16x32_bf16 v[64:67], v[148:151], v[112:115], v[64:67]
    ds_read_b64_tr_b16 v[160:161], v169 offset:12288
    ds_read_b64_tr_b16 v[162:163], v169 offset:13824
    v_mfma_f32_16x16x32_bf16 v[68:71], v[148:151], v[116:119], v[68:71]
    v_mfma_f32_16x16x32_bf16 v[72:75], v[148:151], v[120:123], v[72:75]
    v_mfma_f32_16x16x32_bf16 v[76:79], v[148:151], v[124:127], v[76:79]
    s_waitcnt lgkmcnt(8)
    v_mfma_f32_16x16x32_bf16 v[80:83], v[152:155], v[112:115], v[80:83]
    ds_read_b64_tr_b16 v[164:165], v170 offset:12288
    ds_read_b64_tr_b16 v[166:167], v170 offset:13824
    v_mfma_f32_16x16x32_bf16 v[84:87], v[152:155], v[116:119], v[84:87]
    v_mfma_f32_16x16x32_bf16 v[88:91], v[152:155], v[120:123], v[88:91]
    v_mfma_f32_16x16x32_bf16 v[92:95], v[152:155], v[124:127], v[92:95]
    s_waitcnt lgkmcnt(7)
    v_mfma_f32_16x16x32_bf16 v[48:51], v[156:159], v[128:131], v[48:51]
    s_barrier
    ds_read_b128 v[96:99], v174 offset:16384
    ds_read_b64_tr_b16 v[144:145], v168 offset:24576
    ds_read_b64_tr_b16 v[146:147], v168 offset:26112
    ds_read_b128 v[100:103], v174 offset:18432
    ds_read_b128 v[104:107], v174 offset:20480
    ds_read_b128 v[108:111], v174 offset:22528
    s_waitcnt lgkmcnt(12)
    v_mfma_f32_16x16x32_bf16 v[52:55], v[156:159], v[132:135], v[52:55]
    s_waitcnt lgkmcnt(11)
    v_mfma_f32_16x16x32_bf16 v[56:59], v[156:159], v[136:139], v[56:59]
    s_waitcnt lgkmcnt(10)
    v_mfma_f32_16x16x32_bf16 v[60:63], v[156:159], v[140:143], v[60:63]
    s_waitcnt lgkmcnt(8)
    v_mfma_f32_16x16x32_bf16 v[64:67], v[160:163], v[128:131], v[64:67]
    ds_read_b64_tr_b16 v[148:149], v169 offset:24576
    ds_read_b64_tr_b16 v[150:151], v169 offset:26112
    v_mfma_f32_16x16x32_bf16 v[68:71], v[160:163], v[132:135], v[68:71]
    v_mfma_f32_16x16x32_bf16 v[72:75], v[160:163], v[136:139], v[72:75]
    v_mfma_f32_16x16x32_bf16 v[76:79], v[160:163], v[140:143], v[76:79]
    s_waitcnt lgkmcnt(8)
    v_mfma_f32_16x16x32_bf16 v[80:83], v[164:167], v[128:131], v[80:83]
    ds_read_b64_tr_b16 v[152:153], v170 offset:24576
    ds_read_b64_tr_b16 v[154:155], v170 offset:26112
    v_mfma_f32_16x16x32_bf16 v[84:87], v[164:167], v[132:135], v[84:87]
    v_mfma_f32_16x16x32_bf16 v[88:91], v[164:167], v[136:139], v[88:91]
    v_mfma_f32_16x16x32_bf16 v[92:95], v[164:167], v[140:143], v[92:95]
    s_waitcnt lgkmcnt(7)
    v_mfma_f32_16x16x32_bf16 v[48:51], v[144:147], v[96:99], v[48:51]
    ds_read_b128 v[112:115], v175 offset:16384
    ds_read_b64_tr_b16 v[156:157], v168 offset:36864
    ds_read_b64_tr_b16 v[158:159], v168 offset:38400
    ds_read_b128 v[116:119], v175 offset:18432
    ds_read_b128 v[120:123], v175 offset:20480
    ds_read_b128 v[124:127], v175 offset:22528
    s_waitcnt lgkmcnt(12)
    v_mfma_f32_16x16x32_bf16 v[52:55], v[144:147], v[100:103], v[52:55]
    s_waitcnt lgkmcnt(11)
    v_mfma_f32_16x16x32_bf16 v[56:59], v[144:147], v[104:107], v[56:59]
    s_waitcnt lgkmcnt(10)
    v_mfma_f32_16x16x32_bf16 v[60:63], v[144:147], v[108:111], v[60:63]
    s_waitcnt lgkmcnt(8)
    v_mfma_f32_16x16x32_bf16 v[64:67], v[148:151], v[96:99], v[64:67]
    ds_read_b64_tr_b16 v[160:161], v169 offset:36864
    ds_read_b64_tr_b16 v[162:163], v169 offset:38400
    v_mfma_f32_16x16x32_bf16 v[68:71], v[148:151], v[100:103], v[68:71]
    v_mfma_f32_16x16x32_bf16 v[72:75], v[148:151], v[104:107], v[72:75]
    v_mfma_f32_16x16x32_bf16 v[76:79], v[148:151], v[108:111], v[76:79]
    s_waitcnt lgkmcnt(8)
    v_mfma_f32_16x16x32_bf16 v[80:83], v[152:155], v[96:99], v[80:83]
    ds_read_b64_tr_b16 v[164:165], v170 offset:36864
    ds_read_b64_tr_b16 v[166:167], v170 offset:38400
    v_mfma_f32_16x16x32_bf16 v[84:87], v[152:155], v[100:103], v[84:87]
    v_mfma_f32_16x16x32_bf16 v[88:91], v[152:155], v[104:107], v[88:91]
    v_mfma_f32_16x16x32_bf16 v[92:95], v[152:155], v[108:111], v[92:95]
    s_waitcnt lgkmcnt(7)
    v_mfma_f32_16x16x32_bf16 v[48:51], v[156:159], v[112:115], v[48:51]
    s_barrier
    ds_read_b128 v[128:131], v174 offset:0
    ds_read_b64_tr_b16 v[144:145], v171 offset:0
    ds_read_b64_tr_b16 v[146:147], v171 offset:1536
    ds_read_b128 v[132:135], v174 offset:2048
    ds_read_b128 v[136:139], v174 offset:4096
    ds_read_b128 v[140:143], v174 offset:6144
    s_waitcnt lgkmcnt(12)
    v_mfma_f32_16x16x32_bf16 v[52:55], v[156:159], v[116:119], v[52:55]
    s_waitcnt lgkmcnt(11)
    v_mfma_f32_16x16x32_bf16 v[56:59], v[156:159], v[120:123], v[56:59]
    s_waitcnt lgkmcnt(10)
    v_mfma_f32_16x16x32_bf16 v[60:63], v[156:159], v[124:127], v[60:63]
    s_waitcnt lgkmcnt(8)
    v_mfma_f32_16x16x32_bf16 v[64:67], v[160:163], v[112:115], v[64:67]
    ds_read_b64_tr_b16 v[148:149], v172 offset:0
    ds_read_b64_tr_b16 v[150:151], v172 offset:1536
    v_mfma_f32_16x16x32_bf16 v[68:71], v[160:163], v[116:119], v[68:71]
    v_mfma_f32_16x16x32_bf16 v[72:75], v[160:163], v[120:123], v[72:75]
    v_mfma_f32_16x16x32_bf16 v[76:79], v[160:163], v[124:127], v[76:79]
    s_waitcnt lgkmcnt(8)
    v_mfma_f32_16x16x32_bf16 v[80:83], v[164:167], v[112:115], v[80:83]
    ds_read_b64_tr_b16 v[152:153], v173 offset:0
    ds_read_b64_tr_b16 v[154:155], v173 offset:1536
    v_mfma_f32_16x16x32_bf16 v[84:87], v[164:167], v[116:119], v[84:87]
    v_mfma_f32_16x16x32_bf16 v[88:91], v[164:167], v[120:123], v[88:91]
    v_mfma_f32_16x16x32_bf16 v[92:95], v[164:167], v[124:127], v[92:95]
    s_waitcnt lgkmcnt(7)
    v_mfma_f32_16x16x32_bf16 v[48:51], v[144:147], v[128:131], v[48:51]
    ds_read_b128 v[96:99], v175 offset:0
    ds_read_b64_tr_b16 v[156:157], v171 offset:12288
    ds_read_b64_tr_b16 v[158:159], v171 offset:13824
    ds_read_b128 v[100:103], v175 offset:2048
    ds_read_b128 v[104:107], v175 offset:4096
    ds_read_b128 v[108:111], v175 offset:6144
    s_waitcnt lgkmcnt(12)
    v_mfma_f32_16x16x32_bf16 v[52:55], v[144:147], v[132:135], v[52:55]
    s_waitcnt lgkmcnt(11)
    v_mfma_f32_16x16x32_bf16 v[56:59], v[144:147], v[136:139], v[56:59]
    s_waitcnt lgkmcnt(10)
    v_mfma_f32_16x16x32_bf16 v[60:63], v[144:147], v[140:143], v[60:63]
    s_waitcnt lgkmcnt(8)
    v_mfma_f32_16x16x32_bf16 v[64:67], v[148:151], v[128:131], v[64:67]
    ds_read_b64_tr_b16 v[160:161], v172 offset:12288
    ds_read_b64_tr_b16 v[162:163], v172 offset:13824
    v_mfma_f32_16x16x32_bf16 v[68:71], v[148:151], v[132:135], v[68:71]
    v_mfma_f32_16x16x32_bf16 v[72:75], v[148:151], v[136:139], v[72:75]
    v_mfma_f32_16x16x32_bf16 v[76:79], v[148:151], v[140:143], v[76:79]
    s_waitcnt lgkmcnt(8)
    v_mfma_f32_16x16x32_bf16 v[80:83], v[152:155], v[128:131], v[80:83]
    ds_read_b64_tr_b16 v[164:165], v173 offset:12288
    ds_read_b64_tr_b16 v[166:167], v173 offset:13824
    v_mfma_f32_16x16x32_bf16 v[84:87], v[152:155], v[132:135], v[84:87]
    v_mfma_f32_16x16x32_bf16 v[88:91], v[152:155], v[136:139], v[88:91]
    v_mfma_f32_16x16x32_bf16 v[92:95], v[152:155], v[140:143], v[92:95]
    s_waitcnt lgkmcnt(7)
    v_mfma_f32_16x16x32_bf16 v[48:51], v[156:159], v[96:99], v[48:51]
    s_barrier
    ds_read_b128 v[112:115], v174 offset:32768
    ds_read_b64_tr_b16 v[144:145], v171 offset:24576
    ds_read_b64_tr_b16 v[146:147], v171 offset:26112
    ds_read_b128 v[116:119], v174 offset:34816
    ds_read_b128 v[120:123], v174 offset:36864
    ds_read_b128 v[124:127], v174 offset:38912
    s_waitcnt lgkmcnt(12)
    v_mfma_f32_16x16x32_bf16 v[52:55], v[156:159], v[100:103], v[52:55]
    s_waitcnt lgkmcnt(11)
    v_mfma_f32_16x16x32_bf16 v[56:59], v[156:159], v[104:107], v[56:59]
    s_waitcnt lgkmcnt(10)
    v_mfma_f32_16x16x32_bf16 v[60:63], v[156:159], v[108:111], v[60:63]
    s_waitcnt lgkmcnt(8)
    v_mfma_f32_16x16x32_bf16 v[64:67], v[160:163], v[96:99], v[64:67]
    ds_read_b64_tr_b16 v[148:149], v172 offset:24576
    ds_read_b64_tr_b16 v[150:151], v172 offset:26112
    v_mfma_f32_16x16x32_bf16 v[68:71], v[160:163], v[100:103], v[68:71]
    v_mfma_f32_16x16x32_bf16 v[72:75], v[160:163], v[104:107], v[72:75]
    v_mfma_f32_16x16x32_bf16 v[76:79], v[160:163], v[108:111], v[76:79]
    s_waitcnt lgkmcnt(8)
    v_mfma_f32_16x16x32_bf16 v[80:83], v[164:167], v[96:99], v[80:83]
    ds_read_b64_tr_b16 v[152:153], v173 offset:24576
    ds_read_b64_tr_b16 v[154:155], v173 offset:26112
    v_mfma_f32_16x16x32_bf16 v[84:87], v[164:167], v[100:103], v[84:87]
    v_mfma_f32_16x16x32_bf16 v[88:91], v[164:167], v[104:107], v[88:91]
    v_mfma_f32_16x16x32_bf16 v[92:95], v[164:167], v[108:111], v[92:95]
    s_waitcnt lgkmcnt(7)
    v_mfma_f32_16x16x32_bf16 v[48:51], v[144:147], v[112:115], v[48:51]
    ds_read_b128 v[128:131], v175 offset:32768
    ds_read_b64_tr_b16 v[156:157], v171 offset:36864
    ds_read_b64_tr_b16 v[158:159], v171 offset:38400
    ds_read_b128 v[132:135], v175 offset:34816
    ds_read_b128 v[136:139], v175 offset:36864
    ds_read_b128 v[140:143], v175 offset:38912
    s_waitcnt lgkmcnt(12)
    v_mfma_f32_16x16x32_bf16 v[52:55], v[144:147], v[116:119], v[52:55]
    s_waitcnt lgkmcnt(11)
    v_mfma_f32_16x16x32_bf16 v[56:59], v[144:147], v[120:123], v[56:59]
    s_waitcnt lgkmcnt(10)
    v_mfma_f32_16x16x32_bf16 v[60:63], v[144:147], v[124:127], v[60:63]
    s_waitcnt lgkmcnt(8)
    v_mfma_f32_16x16x32_bf16 v[64:67], v[148:151], v[112:115], v[64:67]
    ds_read_b64_tr_b16 v[160:161], v172 offset:36864
    ds_read_b64_tr_b16 v[162:163], v172 offset:38400
    v_mfma_f32_16x16x32_bf16 v[68:71], v[148:151], v[116:119], v[68:71]
    v_mfma_f32_16x16x32_bf16 v[72:75], v[148:151], v[120:123], v[72:75]
    v_mfma_f32_16x16x32_bf16 v[76:79], v[148:151], v[124:127], v[76:79]
    s_waitcnt lgkmcnt(8)
    v_mfma_f32_16x16x32_bf16 v[80:83], v[152:155], v[112:115], v[80:83]
    ds_read_b64_tr_b16 v[164:165], v173 offset:36864
    ds_read_b64_tr_b16 v[166:167], v173 offset:38400
    v_mfma_f32_16x16x32_bf16 v[84:87], v[152:155], v[116:119], v[84:87]
    v_mfma_f32_16x16x32_bf16 v[88:91], v[152:155], v[120:123], v[88:91]
    v_mfma_f32_16x16x32_bf16 v[92:95], v[152:155], v[124:127], v[92:95]
    s_waitcnt lgkmcnt(7)
    v_mfma_f32_16x16x32_bf16 v[48:51], v[156:159], v[128:131], v[48:51]
    s_barrier
    ds_read_b128 v[96:99], v174 offset:8192
    ds_read_b64_tr_b16 v[144:145], v168 offset:0
    ds_read_b64_tr_b16 v[146:147], v168 offset:1536
    ds_read_b128 v[100:103], v174 offset:10240
    ds_read_b128 v[104:107], v174 offset:12288
    ds_read_b128 v[108:111], v174 offset:14336
    s_waitcnt lgkmcnt(12)
    v_mfma_f32_16x16x32_bf16 v[52:55], v[156:159], v[132:135], v[52:55]
    s_waitcnt lgkmcnt(11)
    v_mfma_f32_16x16x32_bf16 v[56:59], v[156:159], v[136:139], v[56:59]
    s_waitcnt lgkmcnt(10)
    v_mfma_f32_16x16x32_bf16 v[60:63], v[156:159], v[140:143], v[60:63]
    s_waitcnt lgkmcnt(8)
    v_mfma_f32_16x16x32_bf16 v[64:67], v[160:163], v[128:131], v[64:67]
    ds_read_b64_tr_b16 v[148:149], v169 offset:0
    ds_read_b64_tr_b16 v[150:151], v169 offset:1536
    v_mfma_f32_16x16x32_bf16 v[68:71], v[160:163], v[132:135], v[68:71]
    v_mfma_f32_16x16x32_bf16 v[72:75], v[160:163], v[136:139], v[72:75]
    v_mfma_f32_16x16x32_bf16 v[76:79], v[160:163], v[140:143], v[76:79]
    s_waitcnt lgkmcnt(8)
    v_mfma_f32_16x16x32_bf16 v[80:83], v[164:167], v[128:131], v[80:83]
    ds_read_b64_tr_b16 v[152:153], v170 offset:0
    ds_read_b64_tr_b16 v[154:155], v170 offset:1536
    v_mfma_f32_16x16x32_bf16 v[84:87], v[164:167], v[132:135], v[84:87]
    v_mfma_f32_16x16x32_bf16 v[88:91], v[164:167], v[136:139], v[88:91]
    v_mfma_f32_16x16x32_bf16 v[92:95], v[164:167], v[140:143], v[92:95]
    s_waitcnt lgkmcnt(7)
    v_mfma_f32_16x16x32_bf16 v[48:51], v[144:147], v[96:99], v[48:51]
    ds_read_b128 v[112:115], v175 offset:8192
    ds_read_b64_tr_b16 v[156:157], v168 offset:12288
    ds_read_b64_tr_b16 v[158:159], v168 offset:13824
    ds_read_b128 v[116:119], v175 offset:10240
    ds_read_b128 v[120:123], v175 offset:12288
    ds_read_b128 v[124:127], v175 offset:14336
    s_waitcnt lgkmcnt(12)
    v_mfma_f32_16x16x32_bf16 v[52:55], v[144:147], v[100:103], v[52:55]
    s_waitcnt lgkmcnt(11)
    v_mfma_f32_16x16x32_bf16 v[56:59], v[144:147], v[104:107], v[56:59]
    s_waitcnt lgkmcnt(10)
    v_mfma_f32_16x16x32_bf16 v[60:63], v[144:147], v[108:111], v[60:63]
    s_waitcnt lgkmcnt(8)
    v_mfma_f32_16x16x32_bf16 v[64:67], v[148:151], v[96:99], v[64:67]
    ds_read_b64_tr_b16 v[160:161], v169 offset:12288
    ds_read_b64_tr_b16 v[162:163], v169 offset:13824
    v_mfma_f32_16x16x32_bf16 v[68:71], v[148:151], v[100:103], v[68:71]
    v_mfma_f32_16x16x32_bf16 v[72:75], v[148:151], v[104:107], v[72:75]
    v_mfma_f32_16x16x32_bf16 v[76:79], v[148:151], v[108:111], v[76:79]
    s_waitcnt lgkmcnt(8)
    v_mfma_f32_16x16x32_bf16 v[80:83], v[152:155], v[96:99], v[80:83]
    ds_read_b64_tr_b16 v[164:165], v170 offset:12288
    ds_read_b64_tr_b16 v[166:167], v170 offset:13824
    v_mfma_f32_16x16x32_bf16 v[84:87], v[152:155], v[100:103], v[84:87]
    v_mfma_f32_16x16x32_bf16 v[88:91], v[152:155], v[104:107], v[88:91]
    v_mfma_f32_16x16x32_bf16 v[92:95], v[152:155], v[108:111], v[92:95]
    s_waitcnt lgkmcnt(7)
    v_mfma_f32_16x16x32_bf16 v[48:51], v[156:159], v[112:115], v[48:51]
    s_barrier
    ds_read_b128 v[128:131], v174 offset:16384
    ds_read_b64_tr_b16 v[144:145], v168 offset:24576
    ds_read_b64_tr_b16 v[146:147], v168 offset:26112
    ds_read_b128 v[132:135], v174 offset:18432
    ds_read_b128 v[136:139], v174 offset:20480
    ds_read_b128 v[140:143], v174 offset:22528
    s_waitcnt lgkmcnt(12)
    v_mfma_f32_16x16x32_bf16 v[52:55], v[156:159], v[116:119], v[52:55]
    s_waitcnt lgkmcnt(11)
    v_mfma_f32_16x16x32_bf16 v[56:59], v[156:159], v[120:123], v[56:59]
    s_waitcnt lgkmcnt(10)
    v_mfma_f32_16x16x32_bf16 v[60:63], v[156:159], v[124:127], v[60:63]
    s_waitcnt lgkmcnt(8)
    v_mfma_f32_16x16x32_bf16 v[64:67], v[160:163], v[112:115], v[64:67]
    ds_read_b64_tr_b16 v[148:149], v169 offset:24576
    ds_read_b64_tr_b16 v[150:151], v169 offset:26112
    v_mfma_f32_16x16x32_bf16 v[68:71], v[160:163], v[116:119], v[68:71]
    v_mfma_f32_16x16x32_bf16 v[72:75], v[160:163], v[120:123], v[72:75]
    v_mfma_f32_16x16x32_bf16 v[76:79], v[160:163], v[124:127], v[76:79]
    s_waitcnt lgkmcnt(8)
    v_mfma_f32_16x16x32_bf16 v[80:83], v[164:167], v[112:115], v[80:83]
    ds_read_b64_tr_b16 v[152:153], v170 offset:24576
    ds_read_b64_tr_b16 v[154:155], v170 offset:26112
    v_mfma_f32_16x16x32_bf16 v[84:87], v[164:167], v[116:119], v[84:87]
    v_mfma_f32_16x16x32_bf16 v[88:91], v[164:167], v[120:123], v[88:91]
    v_mfma_f32_16x16x32_bf16 v[92:95], v[164:167], v[124:127], v[92:95]
    s_waitcnt lgkmcnt(7)
    v_mfma_f32_16x16x32_bf16 v[48:51], v[144:147], v[128:131], v[48:51]
    ds_read_b128 v[96:99], v175 offset:16384
    ds_read_b64_tr_b16 v[156:157], v168 offset:36864
    ds_read_b64_tr_b16 v[158:159], v168 offset:38400
    ds_read_b128 v[100:103], v175 offset:18432
    ds_read_b128 v[104:107], v175 offset:20480
    ds_read_b128 v[108:111], v175 offset:22528
    s_waitcnt lgkmcnt(12)
    v_mfma_f32_16x16x32_bf16 v[52:55], v[144:147], v[132:135], v[52:55]
    s_waitcnt lgkmcnt(11)
    v_mfma_f32_16x16x32_bf16 v[56:59], v[144:147], v[136:139], v[56:59]
    s_waitcnt lgkmcnt(10)
    v_mfma_f32_16x16x32_bf16 v[60:63], v[144:147], v[140:143], v[60:63]
    s_waitcnt lgkmcnt(8)
    v_mfma_f32_16x16x32_bf16 v[64:67], v[148:151], v[128:131], v[64:67]
    ds_read_b64_tr_b16 v[160:161], v169 offset:36864
    ds_read_b64_tr_b16 v[162:163], v169 offset:38400
    v_mfma_f32_16x16x32_bf16 v[68:71], v[148:151], v[132:135], v[68:71]
    v_mfma_f32_16x16x32_bf16 v[72:75], v[148:151], v[136:139], v[72:75]
    v_mfma_f32_16x16x32_bf16 v[76:79], v[148:151], v[140:143], v[76:79]
    s_waitcnt lgkmcnt(8)
    v_mfma_f32_16x16x32_bf16 v[80:83], v[152:155], v[128:131], v[80:83]
    ds_read_b64_tr_b16 v[164:165], v170 offset:36864
    ds_read_b64_tr_b16 v[166:167], v170 offset:38400
    v_mfma_f32_16x16x32_bf16 v[84:87], v[152:155], v[132:135], v[84:87]
    v_mfma_f32_16x16x32_bf16 v[88:91], v[152:155], v[136:139], v[88:91]
    v_mfma_f32_16x16x32_bf16 v[92:95], v[152:155], v[140:143], v[92:95]
    s_waitcnt lgkmcnt(7)
    v_mfma_f32_16x16x32_bf16 v[48:51], v[156:159], v[96:99], v[48:51]
    s_barrier
    ds_read_b128 v[112:115], v174 offset:0
    ds_read_b64_tr_b16 v[144:145], v171 offset:0
    ds_read_b64_tr_b16 v[146:147], v171 offset:1536
    ds_read_b128 v[116:119], v174 offset:2048
    ds_read_b128 v[120:123], v174 offset:4096
    ds_read_b128 v[124:127], v174 offset:6144
    s_waitcnt lgkmcnt(12)
    v_mfma_f32_16x16x32_bf16 v[52:55], v[156:159], v[100:103], v[52:55]
    s_waitcnt lgkmcnt(11)
    v_mfma_f32_16x16x32_bf16 v[56:59], v[156:159], v[104:107], v[56:59]
    s_waitcnt lgkmcnt(10)
    v_mfma_f32_16x16x32_bf16 v[60:63], v[156:159], v[108:111], v[60:63]
    s_waitcnt lgkmcnt(8)
    v_mfma_f32_16x16x32_bf16 v[64:67], v[160:163], v[96:99], v[64:67]
    ds_read_b64_tr_b16 v[148:149], v172 offset:0
    ds_read_b64_tr_b16 v[150:151], v172 offset:1536
    v_mfma_f32_16x16x32_bf16 v[68:71], v[160:163], v[100:103], v[68:71]
    v_mfma_f32_16x16x32_bf16 v[72:75], v[160:163], v[104:107], v[72:75]
    v_mfma_f32_16x16x32_bf16 v[76:79], v[160:163], v[108:111], v[76:79]
    s_waitcnt lgkmcnt(8)
    v_mfma_f32_16x16x32_bf16 v[80:83], v[164:167], v[96:99], v[80:83]
    ds_read_b64_tr_b16 v[152:153], v173 offset:0
    ds_read_b64_tr_b16 v[154:155], v173 offset:1536
    v_mfma_f32_16x16x32_bf16 v[84:87], v[164:167], v[100:103], v[84:87]
    v_mfma_f32_16x16x32_bf16 v[88:91], v[164:167], v[104:107], v[88:91]
    v_mfma_f32_16x16x32_bf16 v[92:95], v[164:167], v[108:111], v[92:95]
    s_waitcnt lgkmcnt(7)
    v_mfma_f32_16x16x32_bf16 v[48:51], v[144:147], v[112:115], v[48:51]
    ds_read_b128 v[128:131], v175 offset:0
    ds_read_b64_tr_b16 v[156:157], v171 offset:12288
    ds_read_b64_tr_b16 v[158:159], v171 offset:13824
    ds_read_b128 v[132:135], v175 offset:2048
    ds_read_b128 v[136:139], v175 offset:4096
    ds_read_b128 v[140:143], v175 offset:6144
    s_waitcnt lgkmcnt(12)
    v_mfma_f32_16x16x32_bf16 v[52:55], v[144:147], v[116:119], v[52:55]
    s_waitcnt lgkmcnt(11)
    v_mfma_f32_16x16x32_bf16 v[56:59], v[144:147], v[120:123], v[56:59]
    s_waitcnt lgkmcnt(10)
    v_mfma_f32_16x16x32_bf16 v[60:63], v[144:147], v[124:127], v[60:63]
    s_waitcnt lgkmcnt(8)
    v_mfma_f32_16x16x32_bf16 v[64:67], v[148:151], v[112:115], v[64:67]
    ds_read_b64_tr_b16 v[160:161], v172 offset:12288
    ds_read_b64_tr_b16 v[162:163], v172 offset:13824
    v_mfma_f32_16x16x32_bf16 v[68:71], v[148:151], v[116:119], v[68:71]
    v_mfma_f32_16x16x32_bf16 v[72:75], v[148:151], v[120:123], v[72:75]
    v_mfma_f32_16x16x32_bf16 v[76:79], v[148:151], v[124:127], v[76:79]
    s_waitcnt lgkmcnt(8)
    v_mfma_f32_16x16x32_bf16 v[80:83], v[152:155], v[112:115], v[80:83]
    ds_read_b64_tr_b16 v[164:165], v173 offset:12288
    ds_read_b64_tr_b16 v[166:167], v173 offset:13824
    v_mfma_f32_16x16x32_bf16 v[84:87], v[152:155], v[116:119], v[84:87]
    v_mfma_f32_16x16x32_bf16 v[88:91], v[152:155], v[120:123], v[88:91]
    v_mfma_f32_16x16x32_bf16 v[92:95], v[152:155], v[124:127], v[92:95]
    s_waitcnt lgkmcnt(7)
    v_mfma_f32_16x16x32_bf16 v[48:51], v[156:159], v[128:131], v[48:51]
    s_barrier
    ds_read_b128 v[96:99], v174 offset:32768
    ds_read_b64_tr_b16 v[144:145], v171 offset:24576
    ds_read_b64_tr_b16 v[146:147], v171 offset:26112
    ds_read_b128 v[100:103], v174 offset:34816
    ds_read_b128 v[104:107], v174 offset:36864
    ds_read_b128 v[108:111], v174 offset:38912
    s_waitcnt lgkmcnt(12)
    v_mfma_f32_16x16x32_bf16 v[52:55], v[156:159], v[132:135], v[52:55]
    s_waitcnt lgkmcnt(11)
    v_mfma_f32_16x16x32_bf16 v[56:59], v[156:159], v[136:139], v[56:59]
    s_waitcnt lgkmcnt(10)
    v_mfma_f32_16x16x32_bf16 v[60:63], v[156:159], v[140:143], v[60:63]
    s_waitcnt lgkmcnt(8)
    v_mfma_f32_16x16x32_bf16 v[64:67], v[160:163], v[128:131], v[64:67]
    ds_read_b64_tr_b16 v[148:149], v172 offset:24576
    ds_read_b64_tr_b16 v[150:151], v172 offset:26112
    v_mfma_f32_16x16x32_bf16 v[68:71], v[160:163], v[132:135], v[68:71]
    v_mfma_f32_16x16x32_bf16 v[72:75], v[160:163], v[136:139], v[72:75]
    v_mfma_f32_16x16x32_bf16 v[76:79], v[160:163], v[140:143], v[76:79]
    s_waitcnt lgkmcnt(8)
    v_mfma_f32_16x16x32_bf16 v[80:83], v[164:167], v[128:131], v[80:83]
    ds_read_b64_tr_b16 v[152:153], v173 offset:24576
    ds_read_b64_tr_b16 v[154:155], v173 offset:26112
    v_mfma_f32_16x16x32_bf16 v[84:87], v[164:167], v[132:135], v[84:87]
    v_mfma_f32_16x16x32_bf16 v[88:91], v[164:167], v[136:139], v[88:91]
    v_mfma_f32_16x16x32_bf16 v[92:95], v[164:167], v[140:143], v[92:95]
    s_waitcnt lgkmcnt(7)
    v_mfma_f32_16x16x32_bf16 v[48:51], v[144:147], v[96:99], v[48:51]
    ds_read_b128 v[112:115], v175 offset:32768
    ds_read_b64_tr_b16 v[156:157], v171 offset:36864
    ds_read_b64_tr_b16 v[158:159], v171 offset:38400
    ds_read_b128 v[116:119], v175 offset:34816
    ds_read_b128 v[120:123], v175 offset:36864
    ds_read_b128 v[124:127], v175 offset:38912
    s_waitcnt lgkmcnt(12)
    v_mfma_f32_16x16x32_bf16 v[52:55], v[144:147], v[100:103], v[52:55]
    s_waitcnt lgkmcnt(11)
    v_mfma_f32_16x16x32_bf16 v[56:59], v[144:147], v[104:107], v[56:59]
    s_waitcnt lgkmcnt(10)
    v_mfma_f32_16x16x32_bf16 v[60:63], v[144:147], v[108:111], v[60:63]
    s_waitcnt lgkmcnt(8)
    v_mfma_f32_16x16x32_bf16 v[64:67], v[148:151], v[96:99], v[64:67]
    ds_read_b64_tr_b16 v[160:161], v172 offset:36864
    ds_read_b64_tr_b16 v[162:163], v172 offset:38400
    v_mfma_f32_16x16x32_bf16 v[68:71], v[148:151], v[100:103], v[68:71]
    v_mfma_f32_16x16x32_bf16 v[72:75], v[148:151], v[104:107], v[72:75]
    v_mfma_f32_16x16x32_bf16 v[76:79], v[148:151], v[108:111], v[76:79]
    s_waitcnt lgkmcnt(8)
    v_mfma_f32_16x16x32_bf16 v[80:83], v[152:155], v[96:99], v[80:83]
    ds_read_b64_tr_b16 v[164:165], v173 offset:36864
    ds_read_b64_tr_b16 v[166:167], v173 offset:38400
    v_mfma_f32_16x16x32_bf16 v[84:87], v[152:155], v[100:103], v[84:87]
    v_mfma_f32_16x16x32_bf16 v[88:91], v[152:155], v[104:107], v[88:91]
    v_mfma_f32_16x16x32_bf16 v[92:95], v[152:155], v[108:111], v[92:95]
    s_waitcnt lgkmcnt(7)
    v_mfma_f32_16x16x32_bf16 v[48:51], v[156:159], v[112:115], v[48:51]
    s_waitcnt lgkmcnt(6)
    v_mfma_f32_16x16x32_bf16 v[52:55], v[156:159], v[116:119], v[52:55]
    s_waitcnt lgkmcnt(5)
    v_mfma_f32_16x16x32_bf16 v[56:59], v[156:159], v[120:123], v[56:59]
    s_waitcnt lgkmcnt(4)
    v_mfma_f32_16x16x32_bf16 v[60:63], v[156:159], v[124:127], v[60:63]
    s_waitcnt lgkmcnt(2)
    v_mfma_f32_16x16x32_bf16 v[64:67], v[160:163], v[112:115], v[64:67]
    v_mfma_f32_16x16x32_bf16 v[68:71], v[160:163], v[116:119], v[68:71]
    v_mfma_f32_16x16x32_bf16 v[72:75], v[160:163], v[120:123], v[72:75]
    v_mfma_f32_16x16x32_bf16 v[76:79], v[160:163], v[124:127], v[76:79]
    s_waitcnt lgkmcnt(0)
    v_mfma_f32_16x16x32_bf16 v[80:83], v[164:167], v[112:115], v[80:83]
    v_mfma_f32_16x16x32_bf16 v[84:87], v[164:167], v[116:119], v[84:87]
    v_mfma_f32_16x16x32_bf16 v[88:91], v[164:167], v[120:123], v[88:91]
    v_mfma_f32_16x16x32_bf16 v[92:95], v[164:167], v[124:127], v[92:95]
    s_nop 7
L_Pcyc:
    v_cvt_pk_bf16_f32 v48, v48, v49
    v_cvt_pk_bf16_f32 v49, v50, v51
    v_cvt_pk_bf16_f32 v50, v52, v53
    v_cvt_pk_bf16_f32 v51, v54, v55
    v_cvt_pk_bf16_f32 v52, v56, v57
    v_cvt_pk_bf16_f32 v53, v58, v59
    v_cvt_pk_bf16_f32 v54, v60, v61
    v_cvt_pk_bf16_f32 v55, v62, v63
    v_cvt_pk_bf16_f32 v56, v64, v65
    v_cvt_pk_bf16_f32 v57, v66, v67
    v_cvt_pk_bf16_f32 v58, v68, v69
    v_cvt_pk_bf16_f32 v59, v70, v71
    v_cvt_pk_bf16_f32 v60, v72, v73
    v_cvt_pk_bf16_f32 v61, v74, v75
    v_cvt_pk_bf16_f32 v62, v76, v77
    v_cvt_pk_bf16_f32 v63, v78, v79
    v_cvt_pk_bf16_f32 v64, v80, v81
    v_cvt_pk_bf16_f32 v65, v82, v83
    v_cvt_pk_bf16_f32 v66, v84, v85
    v_cvt_pk_bf16_f32 v67, v86, v87
    v_cvt_pk_bf16_f32 v68, v88, v89
    v_cvt_pk_bf16_f32 v69, v90, v91
    v_cvt_pk_bf16_f32 v70, v92, v93
    v_cvt_pk_bf16_f32 v71, v94, v95
    s_mul_i32 s57, s33, 3
    s_add_u32 s57, s57, 0
    s_and_b32 s59, s57, 3
    s_lshl_b32 s59, s59, 5
    s_lshr_b32 s57, s57, 2
    s_lshl_b32 s57, s57, 7
    v_xor_b32 v0, s59, v18
    v_add_u32 v0, s57, v0
    ds_write_b64 v0, v[48:49] offset:0
    ds_write_b64 v0, v[50:51] offset:6144
    ds_write_b64 v0, v[52:53] offset:12288
    ds_write_b64 v0, v[54:55] offset:18432
    s_mul_i32 s57, s33, 3
    s_add_u32 s57, s57, 1
    s_and_b32 s59, s57, 3
    s_lshl_b32 s59, s59, 5
    s_lshr_b32 s57, s57, 2
    s_lshl_b32 s57, s57, 7
    v_xor_b32 v17, s59, v18
    v_add_u32 v17, s57, v17
    ds_write_b64 v17, v[56:57] offset:0
    ds_write_b64 v17, v[58:59] offset:6144
    ds_write_b64 v17, v[60:61] offset:12288
    ds_write_b64 v17, v[62:63] offset:18432
    s_mul_i32 s57, s33, 3
    s_add_u32 s57, s57, 2
    s_and_b32 s59, s57, 3
    s_lshl_b32 s59, s59, 5
    s_lshr_b32 s57, s57, 2
    s_lshl_b32 s57, s57, 7
    v_xor_b32 v0, s59, v18
    v_add_u32 v0, s57, v0
    ds_write_b64 v0, v[64:65] offset:0
    ds_write_b64 v0, v[66:67] offset:6144
    ds_write_b64 v0, v[68:69] offset:12288
    ds_write_b64 v0, v[70:71] offset:18432
    s_waitcnt lgkmcnt(0)
    s_cmp_eq_u32 s50, 4
    s_cbranch_scc0 L_Pc3
    s_mov_b32 s57, 4
L_Pi4:
    s_barrier
    s_sub_u32 s57, s57, 1
    s_cmp_lg_u32 s57, 0
    s_cbranch_scc1 L_Pi4
    s_branch L_PO
L_Pc3:
    s_cmp_eq_u32 s50, 1
    s_cbranch_scc0 L_PQa
    s_barrier
    s_add_u32 m0, s51, 49152
    s_add_u32 s57, s55, 40960
    buffer_load_dwordx4 v1, s[16:19], s54 offen offset:0 lds
    buffer_load_dwordx4 v2, s[16:19], s54 offen offset:1024 lds
    buffer_load_dwordx4 v3, s[16:19], s54 offen offset:2048 lds
    s_add_u32 m0, s52, 81920
    s_add_u32 s54, s54, 393216
    buffer_load_dwordx4 v4, s[24:27], s55 offen lds
    s_add_u32 m0, s52, 86016
    s_add_u32 s55, s55, 128
    buffer_load_dwordx4 v4, s[24:27], s57 offen lds
    s_add_u32 m0, s51, 69632
    s_nop 0
    buffer_load_dwordx4 v1, s[16:19], s54 offen offset:0 lds
    buffer_load_dwordx4 v2, s[16:19], s54 offen offset:1024 lds
    buffer_load_dwordx4 v3, s[16:19], s54 offen offset:2048 lds
    s_add_u32 s54, s54, 393216
    s_barrier
    s_barrier
    s_waitcnt vmcnt(3) lgkmcnt(0)
    s_barrier
L_PQa:
    ds_read_b128 v[20:23], v15 offset:0
    ds_read_b64_tr_b16 v[36:37], v10 offset:0
    ds_read_b64_tr_b16 v[38:39], v10 offset:1536
    ds_read_b128 v[24:27], v15 offset:2048
    ds_read_b128 v[28:31], v15 offset:4096
    ds_read_b128 v[32:35], v15 offset:6144
    ds_read_b64_tr_b16 v[40:41], v11 offset:0
    ds_read_b64_tr_b16 v[42:43], v11 offset:1536
    ds_read_b64_tr_b16 v[44:45], v12 offset:0
    ds_read_b64_tr_b16 v[46:47], v12 offset:1536
    s_add_u32 m0, s51, 90112
    s_add_u32 s57, s55, 40960
    buffer_load_dwordx4 v1, s[16:19], s54 offen offset:0 lds
    buffer_load_dwordx4 v2, s[16:19], s54 offen offset:1024 lds
    buffer_load_dwordx4 v3, s[16:19], s54 offen offset:2048 lds
    s_add_u32 m0, s52, 122880
    s_add_u32 s54, s54, 393216
    buffer_load_dwordx4 v4, s[24:27], s55 offen lds
    s_waitcnt lgkmcnt(7)
    v_mfma_f32_16x16x32_bf16 v[48:51], v[36:39], v[20:23], 0
    s_waitcnt lgkmcnt(6)
    v_mfma_f32_16x16x32_bf16 v[52:55], v[36:39], v[24:27], 0
    s_add_u32 m0, s52, 126976
    s_waitcnt lgkmcnt(5)
    v_mfma_f32_16x16x32_bf16 v[56:59], v[36:39], v[28:31], 0
    s_add_u32 s55, s55, 128
    s_waitcnt lgkmcnt(4)
    v_mfma_f32_16x16x32_bf16 v[60:63], v[36:39], v[32:35], 0
    buffer_load_dwordx4 v4, s[24:27], s57 offen lds
    s_waitcnt lgkmcnt(2)
    v_mfma_f32_16x16x32_bf16 v[64:67], v[40:43], v[20:23], 0
    v_mfma_f32_16x16x32_bf16 v[68:71], v[40:43], v[24:27], 0
    s_add_u32 m0, s51, 110592
    v_mfma_f32_16x16x32_bf16 v[72:75], v[40:43], v[28:31], 0
    s_nop 0
    v_mfma_f32_16x16x32_bf16 v[76:79], v[40:43], v[32:35], 0
    buffer_load_dwordx4 v1, s[16:19], s54 offen offset:0 lds
    s_waitcnt lgkmcnt(0)
    v_mfma_f32_16x16x32_bf16 v[80:83], v[44:47], v[20:23], 0
    v_mfma_f32_16x16x32_bf16 v[84:87], v[44:47], v[24:27], 0
    buffer_load_dwordx4 v2, s[16:19], s54 offen offset:1024 lds
    v_mfma_f32_16x16x32_bf16 v[88:91], v[44:47], v[28:31], 0
    buffer_load_dwordx4 v3, s[16:19], s54 offen offset:2048 lds
    v_mfma_f32_16x16x32_bf16 v[92:95], v[44:47], v[32:35], 0
    s_add_u32 s54, s54, 393216
    s_waitcnt vmcnt(8) lgkmcnt(0)
    s_barrier
    v_xor_b32 v0, 64, v15
    ds_read_b128 v[20:23], v0 offset:0
    ds_read_b64_tr_b16 v[36:37], v10 offset:20480
    ds_read_b64_tr_b16 v[38:39], v10 offset:22016
    ds_read_b128 v[24:27], v0 offset:2048
    ds_read_b128 v[28:31], v0 offset:4096
    ds_read_b128 v[32:35], v0 offset:6144
    ds_read_b64_tr_b16 v[40:41], v11 offset:20480
    ds_read_b64_tr_b16 v[42:43], v11 offset:22016
    ds_read_b64_tr_b16 v[44:45], v12 offset:20480
    ds_read_b64_tr_b16 v[46:47], v12 offset:22016
    s_waitcnt lgkmcnt(7)
    v_mfma_f32_16x16x32_bf16 v[48:51], v[36:39], v[20:23], v[48:51]
    s_waitcnt lgkmcnt(6)
    v_mfma_f32_16x16x32_bf16 v[52:55], v[36:39], v[24:27], v[52:55]
    s_waitcnt lgkmcnt(5)
    v_mfma_f32_16x16x32_bf16 v[56:59], v[36:39], v[28:31], v[56:59]
    s_waitcnt lgkmcnt(4)
    v_mfma_f32_16x16x32_bf16 v[60:63], v[36:39], v[32:35], v[60:63]
    s_waitcnt lgkmcnt(2)
    v_mfma_f32_16x16x32_bf16 v[64:67], v[40:43], v[20:23], v[64:67]
    v_mfma_f32_16x16x32_bf16 v[68:71], v[40:43], v[24:27], v[68:71]
    v_mfma_f32_16x16x32_bf16 v[72:75], v[40:43], v[28:31], v[72:75]
    v_mfma_f32_16x16x32_bf16 v[76:79], v[40:43], v[32:35], v[76:79]
    s_waitcnt lgkmcnt(0)
    v_mfma_f32_16x16x32_bf16 v[80:83], v[44:47], v[20:23], v[80:83]
    v_mfma_f32_16x16x32_bf16 v[84:87], v[44:47], v[24:27], v[84:87]
    v_mfma_f32_16x16x32_bf16 v[88:91], v[44:47], v[28:31], v[88:91]
    v_mfma_f32_16x16x32_bf16 v[92:95], v[44:47], v[32:35], v[92:95]
    v_add_u32 v10, 40960, v10
    v_add_u32 v11, 40960, v11
    v_add_u32 v12, 40960, v12
    v_add_u32 v15, 40960, v15
    s_waitcnt vmcnt(3) lgkmcnt(0)
    s_barrier
    ds_read_b128 v[20:23], v15 offset:0
    ds_read_b64_tr_b16 v[36:37], v10 offset:0
    ds_read_b64_tr_b16 v[38:39], v10 offset:1536
    ds_read_b128 v[24:27], v15 offset:2048
    ds_read_b128 v[28:31], v15 offset:4096
    ds_read_b128 v[32:35], v15 offset:6144
    ds_read_b64_tr_b16 v[40:41], v11 offset:0
    ds_read_b64_tr_b16 v[42:43], v11 offset:1536
    ds_read_b64_tr_b16 v[44:45], v12 offset:0
    ds_read_b64_tr_b16 v[46:47], v12 offset:1536
    s_waitcnt lgkmcnt(7)
    v_mfma_f32_16x16x32_bf16 v[48:51], v[36:39], v[20:23], v[48:51]
    s_waitcnt lgkmcnt(6)
    v_mfma_f32_16x16x32_bf16 v[52:55], v[36:39], v[24:27], v[52:55]
    s_waitcnt lgkmcnt(5)
    v_mfma_f32_16x16x32_bf16 v[56:59], v[36:39], v[28:31], v[56:59]
    s_waitcnt lgkmcnt(4)
    v_mfma_f32_16x16x32_bf16 v[60:63], v[36:39], v[32:35], v[60:63]
    s_waitcnt lgkmcnt(2)
    v_mfma_f32_16x16x32_bf16 v[64:67], v[40:43], v[20:23], v[64:67]
    v_mfma_f32_16x16x32_bf16 v[68:71], v[40:43], v[24:27], v[68:71]
    v_mfma_f32_16x16x32_bf16 v[72:75], v[40:43], v[28:31], v[72:75]
    v_mfma_f32_16x16x32_bf16 v[76:79], v[40:43], v[32:35], v[76:79]
    s_waitcnt lgkmcnt(0)
    v_mfma_f32_16x16x32_bf16 v[80:83], v[44:47], v[20:23], v[80:83]
    v_mfma_f32_16x16x32_bf16 v[84:87], v[44:47], v[24:27], v[84:87]
    v_mfma_f32_16x16x32_bf16 v[88:91], v[44:47], v[28:31], v[88:91]
    v_mfma_f32_16x16x32_bf16 v[92:95], v[44:47], v[32:35], v[92:95]
    s_cmp_ge_u32 s50, 2
    s_nop 6
    s_cbranch_scc1 L_Pa_b
    s_add_u32 m0, s51, 49152
    s_add_u32 s57, s55, 40960
    buffer_load_dwordx4 v1, s[16:19], s54 offen offset:0 lds
    buffer_load_dwordx4 v2, s[16:19], s54 offen offset:1024 lds
    buffer_load_dwordx4 v3, s[16:19], s54 offen offset:2048 lds
    s_add_u32 m0, s52, 81920
    s_add_u32 s54, s54, 393216
    buffer_load_dwordx4 v4, s[24:27], s55 offen lds
    s_add_u32 m0, s52, 86016
    s_add_u32 s55, s55, 128
    buffer_load_dwordx4 v4, s[24:27], s57 offen lds
    s_add_u32 m0, s51, 69632
    s_nop 0
    buffer_load_dwordx4 v1, s[16:19], s54 offen offset:0 lds
    buffer_load_dwordx4 v2, s[16:19], s54 offen offset:1024 lds
    buffer_load_dwordx4 v3, s[16:19], s54 offen offset:2048 lds
    s_add_u32 s54, s54, 393216
    s_waitcnt vmcnt(8)
    s_branch L_Pa_j
L_Pa_b:
    s_add_u32 m0, s53, 49152
    s_add_u32 s57, s56, 4096
    buffer_load_dwordx4 v5, s[20:23], s56 offen offset:0 lds
    buffer_load_dwordx4 v6, s[20:23], s56 offen offset:1024 lds
    buffer_load_dwordx4 v7, s[20:23], s56 offen offset:2048 lds
    buffer_load_dwordx4 v8, s[20:23], s56 offen offset:3072 lds
    s_add_u32 m0, s53, 53248
    s_add_u32 s56, s56, 20480
    buffer_load_dwordx4 v9, s[20:23], s57 offen lds
    s_add_u32 m0, s53, 69632
    s_add_u32 s57, s56, 4096
    buffer_load_dwordx4 v5, s[20:23], s56 offen offset:0 lds
    buffer_load_dwordx4 v6, s[20:23], s56 offen offset:1024 lds
    buffer_load_dwordx4 v7, s[20:23], s56 offen offset:2048 lds
    buffer_load_dwordx4 v8, s[20:23], s56 offen offset:3072 lds
    s_add_u32 m0, s53, 73728
    s_add_u32 s56, s56, 20480
    buffer_load_dwordx4 v9, s[20:23], s57 offen lds
    s_waitcnt vmcnt(10)
L_Pa_j:
    s_waitcnt lgkmcnt(0)
    s_barrier
    v_xor_b32 v0, 64, v15
    ds_read_b128 v[20:23], v0 offset:0
    ds_read_b64_tr_b16 v[36:37], v10 offset:20480
    ds_read_b64_tr_b16 v[38:39], v10 offset:22016
    ds_read_b128 v[24:27], v0 offset:2048
    ds_read_b128 v[28:31], v0 offset:4096
    ds_read_b128 v[32:35], v0 offset:6144
    ds_read_b64_tr_b16 v[40:41], v11 offset:20480
    ds_read_b64_tr_b16 v[42:43], v11 offset:22016
    ds_read_b64_tr_b16 v[44:45], v12 offset:20480
    ds_read_b64_tr_b16 v[46:47], v12 offset:22016
    s_waitcnt lgkmcnt(7)
    v_mfma_f32_16x16x32_bf16 v[48:51], v[36:39], v[20:23], v[48:51]
    s_waitcnt lgkmcnt(6)
    v_mfma_f32_16x16x32_bf16 v[52:55], v[36:39], v[24:27], v[52:55]
    s_waitcnt lgkmcnt(5)
    v_mfma_f32_16x16x32_bf16 v[56:59], v[36:39], v[28:31], v[56:59]
    s_waitcnt lgkmcnt(4)
    v_mfma_f32_16x16x32_bf16 v[60:63], v[36:39], v[32:35], v[60:63]
    s_waitcnt lgkmcnt(2)
    v_mfma_f32_16x16x32_bf16 v[64:67], v[40:43], v[20:23], v[64:67]
    v_mfma_f32_16x16x32_bf16 v[68:71], v[40:43], v[24:27], v[68:71]
    v_mfma_f32_16x16x32_bf16 v[72:75], v[40:43], v[28:31], v[72:75]
    v_mfma_f32_16x16x32_bf16 v[76:79], v[40:43], v[32:35], v[76:79]
    s_waitcnt lgkmcnt(0)
    v_mfma_f32_16x16x32_bf16 v[80:83], v[44:47], v[20:23], v[80:83]
    v_mfma_f32_16x16x32_bf16 v[84:87], v[44:47], v[24:27], v[84:87]
    v_mfma_f32_16x16x32_bf16 v[88:91], v[44:47], v[28:31], v[88:91]
    v_mfma_f32_16x16x32_bf16 v[92:95], v[44:47], v[32:35], v[92:95]
    v_subrev_u32 v10, 40960, v10
    v_subrev_u32 v11, 40960, v11
    v_subrev_u32 v12, 40960, v12
    v_subrev_u32 v15, 40960, v15
    s_waitcnt vmcnt(0) lgkmcnt(0)
    s_barrier
    s_cmp_ge_u32 s50, 2
    s_nop 0
    s_cbranch_scc1 L_PO
    v_mov_b32 v96, 0
    v_mov_b32 v97, 0
    v_mov_b32 v98, 0
    v_mov_b32 v99, 0
    v_mov_b32 v100, 0
    v_mov_b32 v101, 0
    v_mov_b32 v102, 0
    v_mov_b32 v103, 0
    v_mov_b32 v104, 0
    v_mov_b32 v105, 0
    v_mov_b32 v106, 0
    v_mov_b32 v107, 0
    v_mov_b32 v108, 0
    v_mov_b32 v109, 0
    v_mov_b32 v110, 0
    v_mov_b32 v111, 0
    v_mov_b32 v112, 0
    v_mov_b32 v113, 0
    v_mov_b32 v114, 0
    v_mov_b32 v115, 0
    v_mov_b32 v116, 0
    v_mov_b32 v117, 0
    v_mov_b32 v118, 0
    v_mov_b32 v119, 0
    v_mov_b32 v120, 0
    v_mov_b32 v121, 0
    v_mov_b32 v122, 0
    v_mov_b32 v123, 0
    v_mov_b32 v124, 0
    v_mov_b32 v125, 0
    v_mov_b32 v126, 0
    v_mov_b32 v127, 0
    v_mov_b32 v128, 0
    v_mov_b32 v129, 0
    v_mov_b32 v130, 0
    v_mov_b32 v131, 0
    v_mov_b32 v132, 0
    v_mov_b32 v133, 0
    v_mov_b32 v134, 0
    v_mov_b32 v135, 0
    v_mov_b32 v136, 0
    v_mov_b32 v137, 0
    v_mov_b32 v138, 0
    v_mov_b32 v139, 0
    v_mov_b32 v140, 0
    v_mov_b32 v141, 0
    v_mov_b32 v142, 0
    v_mov_b32 v143, 0
    v_mov_b32 v144, 0
    v_mov_b32 v145, 0
    v_mov_b32 v146, 0
    v_mov_b32 v147, 0
    v_mov_b32 v148, 0
    v_mov_b32 v149, 0
    v_mov_b32 v150, 0
    v_mov_b32 v151, 0
    v_mov_b32 v152, 0
    v_mov_b32 v153, 0
    v_mov_b32 v154, 0
    v_mov_b32 v155, 0
    v_mov_b32 v156, 0
    v_mov_b32 v157, 0
    v_mov_b32 v158, 0
    v_mov_b32 v159, 0
    v_mov_b32 v160, 0
    v_mov_b32 v161, 0
    v_mov_b32 v162, 0
    v_mov_b32 v163, 0
    v_mov_b32 v164, 0
    v_mov_b32 v165, 0
    v_mov_b32 v166, 0
    v_mov_b32 v167, 0
    v_mov_b32 v168, 0
    v_mov_b32 v169, 0
    v_mov_b32 v170, 0
    v_mov_b32 v171, 0
    v_mov_b32 v172, 0
    v_mov_b32 v173, 0
    v_mov_b32 v174, 0
    v_mov_b32 v175, 0
    v_mov_b32 v176, 0
    v_mov_b32 v177, 0
    v_mov_b32 v178, 0
    v_mov_b32 v179, 0
    v_mov_b32 v180, 0
    v_mov_b32 v181, 0
    v_mov_b32 v182, 0
    v_mov_b32 v183, 0
    v_mov_b32 v184, 0
    v_mov_b32 v185, 0
    v_mov_b32 v186, 0
    v_mov_b32 v187, 0
    v_mov_b32 v188, 0
    v_mov_b32 v189, 0
    v_mov_b32 v190, 0
    v_mov_b32 v191, 0
    v_mov_b32 v192, 0
    v_mov_b32 v193, 0
    v_mov_b32 v194, 0
    v_mov_b32 v195, 0
    v_mov_b32 v196, 0
    v_mov_b32 v197, 0
    v_mov_b32 v198, 0
    v_mov_b32 v199, 0
    v_mov_b32 v200, 0
    v_mov_b32 v201, 0
    v_mov_b32 v202, 0
    v_mov_b32 v203, 0
    v_mov_b32 v204, 0
    v_mov_b32 v205, 0
    v_mov_b32 v206, 0
    v_mov_b32 v207, 0
    v_mov_b32 v208, 0
    v_mov_b32 v209, 0
    v_mov_b32 v210, 0
    v_mov_b32 v211, 0
    v_mov_b32 v212, 0
    v_mov_b32 v213, 0
    v_mov_b32 v214, 0
    v_mov_b32 v215, 0
    v_mov_b32 v216, 0
    v_mov_b32 v217, 0
    v_mov_b32 v218, 0
    v_mov_b32 v219, 0
    v_mov_b32 v220, 0
    v_mov_b32 v221, 0
    v_mov_b32 v222, 0
    v_mov_b32 v223, 0
    v_mov_b32 v224, 0
    v_mov_b32 v225, 0
    v_mov_b32 v226, 0
    v_mov_b32 v227, 0
    v_mov_b32 v228, 0
    v_mov_b32 v229, 0
    v_mov_b32 v230, 0
    v_mov_b32 v231, 0
    v_mov_b32 v232, 0
    v_mov_b32 v233, 0
    v_mov_b32 v234, 0
    v_mov_b32 v235, 0
    v_mov_b32 v236, 0
    v_mov_b32 v237, 0
    v_mov_b32 v238, 0
    v_mov_b32 v239, 0
    v_mov_b32 v240, 0
    v_mov_b32 v241, 0
    v_mov_b32 v242, 0
    v_mov_b32 v243, 0
    v_mov_b32 v244, 0
    v_mov_b32 v245, 0
    v_mov_b32 v246, 0
    v_mov_b32 v247, 0
    v_mov_b32 v248, 0
    v_mov_b32 v249, 0
    v_mov_b32 v250, 0
    v_mov_b32 v251, 0
    v_mov_b32 v252, 0
    v_mov_b32 v253, 0
    v_mov_b32 v254, 0
    v_mov_b32 v255, 0
    s_mov_b32 s57, 8
    s_nop 0
L_Pi10:
    s_barrier
    s_sub_u32 s57, s57, 1
    s_cmp_lg_u32 s57, 0
    s_cbranch_scc1 L_Pi10
    s_branch L_PQb
L_PO:
    ds_read_b128 v[20:23], v16 offset:0
    ds_read_b64_tr_b16 v[36:37], v13 offset:0
    ds_read_b64_tr_b16 v[38:39], v13 offset:5120
    ds_read_b128 v[24:27], v16 offset:6144
    ds_read_b128 v[28:31], v16 offset:12288
    ds_read_b128 v[32:35], v16 offset:18432
    ds_read_b64_tr_b16 v[40:41], v14 offset:0
    ds_read_b64_tr_b16 v[42:43], v14 offset:5120
    ds_read_b64_tr_b16 v[44:45], v13 offset:256
    ds_read_b64_tr_b16 v[46:47], v13 offset:5376
    s_add_u32 m0, s53, 90112
    s_add_u32 s57, s56, 4096
    buffer_load_dwordx4 v5, s[20:23], s56 offen offset:0 lds
    buffer_load_dwordx4 v6, s[20:23], s56 offen offset:1024 lds
    buffer_load_dwordx4 v7, s[20:23], s56 offen offset:2048 lds
    buffer_load_dwordx4 v8, s[20:23], s56 offen offset:3072 lds
    s_add_u32 m0, s53, 94208
    s_add_u32 s56, s56, 20480
    buffer_load_dwordx4 v9, s[20:23], s57 offen lds
    s_waitcnt lgkmcnt(7)
    v_mfma_f32_16x16x32_bf16 v[96:99], v[36:39], v[20:23], v[96:99]
    s_waitcnt lgkmcnt(6)
    v_mfma_f32_16x16x32_bf16 v[100:103], v[36:39], v[24:27], v[100:103]
    s_waitcnt lgkmcnt(5)
    v_mfma_f32_16x16x32_bf16 v[104:107], v[36:39], v[28:31], v[104:107]
    s_add_u32 m0, s53, 110592
    s_waitcnt lgkmcnt(4)
    v_mfma_f32_16x16x32_bf16 v[108:111], v[36:39], v[32:35], v[108:111]
    ds_read_b64_tr_b16 v[36:37], v14 offset:256
    ds_read_b64_tr_b16 v[38:39], v14 offset:5376
    s_waitcnt lgkmcnt(4)
    v_mfma_f32_16x16x32_bf16 v[112:115], v[40:43], v[20:23], v[112:115]
    s_add_u32 s57, s56, 4096
    v_mfma_f32_16x16x32_bf16 v[116:119], v[40:43], v[24:27], v[116:119]
    v_mfma_f32_16x16x32_bf16 v[120:123], v[40:43], v[28:31], v[120:123]
    buffer_load_dwordx4 v5, s[20:23], s56 offen offset:0 lds
    v_mfma_f32_16x16x32_bf16 v[124:127], v[40:43], v[32:35], v[124:127]
    ds_read_b64_tr_b16 v[40:41], v13 offset:512
    ds_read_b64_tr_b16 v[42:43], v13 offset:5632
    s_waitcnt lgkmcnt(4)
    v_mfma_f32_16x16x32_bf16 v[128:131], v[44:47], v[20:23], v[128:131]
    buffer_load_dwordx4 v6, s[20:23], s56 offen offset:1024 lds
    v_mfma_f32_16x16x32_bf16 v[132:135], v[44:47], v[24:27], v[132:135]
    v_mfma_f32_16x16x32_bf16 v[136:139], v[44:47], v[28:31], v[136:139]
    v_mfma_f32_16x16x32_bf16 v[140:143], v[44:47], v[32:35], v[140:143]
    buffer_load_dwordx4 v7, s[20:23], s56 offen offset:2048 lds
    s_waitcnt lgkmcnt(2)
    v_mfma_f32_16x16x32_bf16 v[144:147], v[36:39], v[20:23], v[144:147]
    v_mfma_f32_16x16x32_bf16 v[148:151], v[36:39], v[24:27], v[148:151]
    buffer_load_dwordx4 v8, s[20:23], s56 offen offset:3072 lds
    v_mfma_f32_16x16x32_bf16 v[152:155], v[36:39], v[28:31], v[152:155]
    v_mfma_f32_16x16x32_bf16 v[156:159], v[36:39], v[32:35], v[156:159]
    s_add_u32 m0, s53, 114688
    s_waitcnt lgkmcnt(0)
    v_mfma_f32_16x16x32_bf16 v[160:163], v[40:43], v[20:23], v[160:163]
    v_mfma_f32_16x16x32_bf16 v[164:167], v[40:43], v[24:27], v[164:167]
    s_add_u32 s56, s56, 20480
    v_mfma_f32_16x16x32_bf16 v[168:171], v[40:43], v[28:31], v[168:171]
    v_mfma_f32_16x16x32_bf16 v[172:175], v[40:43], v[32:35], v[172:175]
    buffer_load_dwordx4 v9, s[20:23], s57 offen lds
    s_waitcnt vmcnt(10) lgkmcnt(0)
    s_barrier
    ds_read_b64_tr_b16 v[36:37], v14 offset:512
    ds_read_b64_tr_b16 v[38:39], v14 offset:5632
    ds_read_b64_tr_b16 v[40:41], v13 offset:768
    ds_read_b64_tr_b16 v[42:43], v13 offset:5888
    ds_read_b64_tr_b16 v[44:45], v14 offset:768
    ds_read_b64_tr_b16 v[46:47], v14 offset:5888
    s_waitcnt lgkmcnt(4)
    v_mfma_f32_16x16x32_bf16 v[176:179], v[36:39], v[20:23], v[176:179]
    v_mfma_f32_16x16x32_bf16 v[180:183], v[36:39], v[24:27], v[180:183]
    v_mfma_f32_16x16x32_bf16 v[184:187], v[36:39], v[28:31], v[184:187]
    v_mfma_f32_16x16x32_bf16 v[188:191], v[36:39], v[32:35], v[188:191]
    ds_read_b64_tr_b16 v[36:37], v13 offset:1024
    ds_read_b64_tr_b16 v[38:39], v13 offset:6144
    s_waitcnt lgkmcnt(4)
    v_mfma_f32_16x16x32_bf16 v[192:195], v[40:43], v[20:23], v[192:195]
    v_mfma_f32_16x16x32_bf16 v[196:199], v[40:43], v[24:27], v[196:199]
    v_mfma_f32_16x16x32_bf16 v[200:203], v[40:43], v[28:31], v[200:203]
    v_mfma_f32_16x16x32_bf16 v[204:207], v[40:43], v[32:35], v[204:207]
    ds_read_b64_tr_b16 v[40:41], v14 offset:1024
    ds_read_b64_tr_b16 v[42:43], v14 offset:6144
    s_waitcnt lgkmcnt(4)
    v_mfma_f32_16x16x32_bf16 v[208:211], v[44:47], v[20:23], v[208:211]
    v_mfma_f32_16x16x32_bf16 v[212:215], v[44:47], v[24:27], v[212:215]
    v_mfma_f32_16x16x32_bf16 v[216:219], v[44:47], v[28:31], v[216:219]
    v_mfma_f32_16x16x32_bf16 v[220:223], v[44:47], v[32:35], v[220:223]
    s_waitcnt lgkmcnt(2)
    v_mfma_f32_16x16x32_bf16 v[224:227], v[36:39], v[20:23], v[224:227]
    v_mfma_f32_16x16x32_bf16 v[228:231], v[36:39], v[24:27], v[228:231]
    v_mfma_f32_16x16x32_bf16 v[232:235], v[36:39], v[28:31], v[232:235]
    v_mfma_f32_16x16x32_bf16 v[236:239], v[36:39], v[32:35], v[236:239]
    s_waitcnt lgkmcnt(0)
    v_mfma_f32_16x16x32_bf16 v[240:243], v[40:43], v[20:23], v[240:243]
    v_mfma_f32_16x16x32_bf16 v[244:247], v[40:43], v[24:27], v[244:247]
    v_mfma_f32_16x16x32_bf16 v[248:251], v[40:43], v[28:31], v[248:251]
    v_mfma_f32_16x16x32_bf16 v[252:255], v[40:43], v[32:35], v[252:255]
    v_add_u32 v13, 40960, v13
    v_add_u32 v14, 40960, v14
    s_waitcnt vmcnt(0) lgkmcnt(0)
    s_barrier
    v_xor_b32 v0, 64, v16
    ds_read_b128 v[20:23], v0 offset:0
    ds_read_b64_tr_b16 v[36:37], v13 offset:0
    ds_read_b64_tr_b16 v[38:39], v13 offset:5120
    ds_read_b128 v[24:27], v0 offset:6144
    ds_read_b128 v[28:31], v0 offset:12288
    ds_read_b128 v[32:35], v0 offset:18432
    ds_read_b64_tr_b16 v[40:41], v14 offset:0
    ds_read_b64_tr_b16 v[42:43], v14 offset:5120
    ds_read_b64_tr_b16 v[44:45], v13 offset:256
    ds_read_b64_tr_b16 v[46:47], v13 offset:5376
    s_add_u32 m0, s53, 49152
    s_add_u32 s57, s56, 4096
    buffer_load_dwordx4 v5, s[20:23], s56 offen offset:0 lds
    buffer_load_dwordx4 v6, s[20:23], s56 offen offset:1024 lds
    buffer_load_dwordx4 v7, s[20:23], s56 offen offset:2048 lds
    buffer_load_dwordx4 v8, s[20:23], s56 offen offset:3072 lds
    s_add_u32 m0, s53, 53248
    s_add_u32 s56, s56, 20480
    buffer_load_dwordx4 v9, s[20:23], s57 offen lds
    s_waitcnt lgkmcnt(7)
    v_mfma_f32_16x16x32_bf16 v[96:99], v[36:39], v[20:23], v[96:99]
    s_waitcnt lgkmcnt(6)
    v_mfma_f32_16x16x32_bf16 v[100:103], v[36:39], v[24:27], v[100:103]
    s_waitcnt lgkmcnt(5)
    v_mfma_f32_16x16x32_bf16 v[104:107], v[36:39], v[28:31], v[104:107]
    s_add_u32 m0, s53, 69632
    s_waitcnt lgkmcnt(4)
    v_mfma_f32_16x16x32_bf16 v[108:111], v[36:39], v[32:35], v[108:111]
    ds_read_b64_tr_b16 v[36:37], v14 offset:256
    ds_read_b64_tr_b16 v[38:39], v14 offset:5376
    s_waitcnt lgkmcnt(4)
    v_mfma_f32_16x16x32_bf16 v[112:115], v[40:43], v[20:23], v[112:115]
    s_add_u32 s57, s56, 4096
    v_mfma_f32_16x16x32_bf16 v[116:119], v[40:43], v[24:27], v[116:119]
    v_mfma_f32_16x16x32_bf16 v[120:123], v[40:43], v[28:31], v[120:123]
    buffer_load_dwordx4 v5, s[20:23], s56 offen offset:0 lds
    v_mfma_f32_16x16x32_bf16 v[124:127], v[40:43], v[32:35], v[124:127]
    ds_read_b64_tr_b16 v[40:41], v13 offset:512
    ds_read_b64_tr_b16 v[42:43], v13 offset:5632
    s_waitcnt lgkmcnt(4)
    v_mfma_f32_16x16x32_bf16 v[128:131], v[44:47], v[20:23], v[128:131]
    buffer_load_dwordx4 v6, s[20:23], s56 offen offset:1024 lds
    v_mfma_f32_16x16x32_bf16 v[132:135], v[44:47], v[24:27], v[132:135]
    v_mfma_f32_16x16x32_bf16 v[136:139], v[44:47], v[28:31], v[136:139]
    v_mfma_f32_16x16x32_bf16 v[140:143], v[44:47], v[32:35], v[140:143]
    buffer_load_dwordx4 v7, s[20:23], s56 offen offset:2048 lds
    s_waitcnt lgkmcnt(2)
    v_mfma_f32_16x16x32_bf16 v[144:147], v[36:39], v[20:23], v[144:147]
    v_mfma_f32_16x16x32_bf16 v[148:151], v[36:39], v[24:27], v[148:151]
    buffer_load_dwordx4 v8, s[20:23], s56 offen offset:3072 lds
    v_mfma_f32_16x16x32_bf16 v[152:155], v[36:39], v[28:31], v[152:155]
    v_mfma_f32_16x16x32_bf16 v[156:159], v[36:39], v[32:35], v[156:159]
    s_add_u32 m0, s53, 73728
    s_waitcnt lgkmcnt(0)
    v_mfma_f32_16x16x32_bf16 v[160:163], v[40:43], v[20:23], v[160:163]
    v_mfma_f32_16x16x32_bf16 v[164:167], v[40:43], v[24:27], v[164:167]
    s_add_u32 s56, s56, 20480
    v_mfma_f32_16x16x32_bf16 v[168:171], v[40:43], v[28:31], v[168:171]
    v_mfma_f32_16x16x32_bf16 v[172:175], v[40:43], v[32:35], v[172:175]
    buffer_load_dwordx4 v9, s[20:23], s57 offen lds
    s_waitcnt vmcnt(10) lgkmcnt(0)
    s_barrier
    ds_read_b64_tr_b16 v[36:37], v14 offset:512
    ds_read_b64_tr_b16 v[38:39], v14 offset:5632
    ds_read_b64_tr_b16 v[40:41], v13 offset:768
    ds_read_b64_tr_b16 v[42:43], v13 offset:5888
    ds_read_b64_tr_b16 v[44:45], v14 offset:768
    ds_read_b64_tr_b16 v[46:47], v14 offset:5888
    s_waitcnt lgkmcnt(4)
    v_mfma_f32_16x16x32_bf16 v[176:179], v[36:39], v[20:23], v[176:179]
    v_mfma_f32_16x16x32_bf16 v[180:183], v[36:39], v[24:27], v[180:183]
    v_mfma_f32_16x16x32_bf16 v[184:187], v[36:39], v[28:31], v[184:187]
    v_mfma_f32_16x16x32_bf16 v[188:191], v[36:39], v[32:35], v[188:191]
    ds_read_b64_tr_b16 v[36:37], v13 offset:1024
    ds_read_b64_tr_b16 v[38:39], v13 offset:6144
    s_waitcnt lgkmcnt(4)
    v_mfma_f32_16x16x32_bf16 v[192:195], v[40:43], v[20:23], v[192:195]
    v_mfma_f32_16x16x32_bf16 v[196:199], v[40:43], v[24:27], v[196:199]
    v_mfma_f32_16x16x32_bf16 v[200:203], v[40:43], v[28:31], v[200:203]
    v_mfma_f32_16x16x32_bf16 v[204:207], v[40:43], v[32:35], v[204:207]
    ds_read_b64_tr_b16 v[40:41], v14 offset:1024
    ds_read_b64_tr_b16 v[42:43], v14 offset:6144
    s_waitcnt lgkmcnt(4)
    v_mfma_f32_16x16x32_bf16 v[208:211], v[44:47], v[20:23], v[208:211]
    v_mfma_f32_16x16x32_bf16 v[212:215], v[44:47], v[24:27], v[212:215]
    v_mfma_f32_16x16x32_bf16 v[216:219], v[44:47], v[28:31], v[216:219]
    v_mfma_f32_16x16x32_bf16 v[220:223], v[44:47], v[32:35], v[220:223]
    s_waitcnt lgkmcnt(2)
    v_mfma_f32_16x16x32_bf16 v[224:227], v[36:39], v[20:23], v[224:227]
    v_mfma_f32_16x16x32_bf16 v[228:231], v[36:39], v[24:27], v[228:231]
    v_mfma_f32_16x16x32_bf16 v[232:235], v[36:39], v[28:31], v[232:235]
    v_mfma_f32_16x16x32_bf16 v[236:239], v[36:39], v[32:35], v[236:239]
    s_waitcnt lgkmcnt(0)
    v_mfma_f32_16x16x32_bf16 v[240:243], v[40:43], v[20:23], v[240:243]
    v_mfma_f32_16x16x32_bf16 v[244:247], v[40:43], v[24:27], v[244:247]
    v_mfma_f32_16x16x32_bf16 v[248:251], v[40:43], v[28:31], v[248:251]
    v_mfma_f32_16x16x32_bf16 v[252:255], v[40:43], v[32:35], v[252:255]
    v_subrev_u32 v13, 40960, v13
    v_subrev_u32 v14, 40960, v14
    s_waitcnt vmcnt(0) lgkmcnt(0)
    s_barrier
    ds_read_b128 v[20:23], v16 offset:128
    ds_read_b64_tr_b16 v[36:37], v13 offset:0
    ds_read_b64_tr_b16 v[38:39], v13 offset:5120
    ds_read_b128 v[24:27], v16 offset:6272
    ds_read_b128 v[28:31], v16 offset:12416
    ds_read_b128 v[32:35], v16 offset:18560
    ds_read_b64_tr_b16 v[40:41], v14 offset:0
    ds_read_b64_tr_b16 v[42:43], v14 offset:5120
    ds_read_b64_tr_b16 v[44:45], v13 offset:256
    ds_read_b64_tr_b16 v[46:47], v13 offset:5376
    s_add_u32 m0, s53, 90112
    s_add_u32 s57, s56, 4096
    buffer_load_dwordx4 v5, s[20:23], s56 offen offset:0 lds
    buffer_load_dwordx4 v6, s[20:23], s56 offen offset:1024 lds
    buffer_load_dwordx4 v7, s[20:23], s56 offen offset:2048 lds
    buffer_load_dwordx4 v8, s[20:23], s56 offen offset:3072 lds
    s_add_u32 m0, s53, 94208
    s_add_u32 s56, s56, 20480
    buffer_load_dwordx4 v9, s[20:23], s57 offen lds
    s_waitcnt lgkmcnt(7)
    v_mfma_f32_16x16x32_bf16 v[96:99], v[36:39], v[20:23], v[96:99]
    s_waitcnt lgkmcnt(6)
    v_mfma_f32_16x16x32_bf16 v[100:103], v[36:39], v[24:27], v[100:103]
    s_waitcnt lgkmcnt(5)
    v_mfma_f32_16x16x32_bf16 v[104:107], v[36:39], v[28:31], v[104:107]
    s_add_u32 m0, s53, 110592
    s_waitcnt lgkmcnt(4)
    v_mfma_f32_16x16x32_bf16 v[108:111], v[36:39], v[32:35], v[108:111]
    ds_read_b64_tr_b16 v[36:37], v14 offset:256
    ds_read_b64_tr_b16 v[38:39], v14 offset:5376
    s_waitcnt lgkmcnt(4)
    v_mfma_f32_16x16x32_bf16 v[112:115], v[40:43], v[20:23], v[112:115]
    s_add_u32 s57, s56, 4096
    v_mfma_f32_16x16x32_bf16 v[116:119], v[40:43], v[24:27], v[116:119]
    v_mfma_f32_16x16x32_bf16 v[120:123], v[40:43], v[28:31], v[120:123]
    buffer_load_dwordx4 v5, s[20:23], s56 offen offset:0 lds
    v_mfma_f32_16x16x32_bf16 v[124:127], v[40:43], v[32:35], v[124:127]
    ds_read_b64_tr_b16 v[40:41], v13 offset:512
    ds_read_b64_tr_b16 v[42:43], v13 offset:5632
    s_waitcnt lgkmcnt(4)
    v_mfma_f32_16x16x32_bf16 v[128:131], v[44:47], v[20:23], v[128:131]
    buffer_load_dwordx4 v6, s[20:23], s56 offen offset:1024 lds
    v_mfma_f32_16x16x32_bf16 v[132:135], v[44:47], v[24:27], v[132:135]
    v_mfma_f32_16x16x32_bf16 v[136:139], v[44:47], v[28:31], v[136:139]
    v_mfma_f32_16x16x32_bf16 v[140:143], v[44:47], v[32:35], v[140:143]
    buffer_load_dwordx4 v7, s[20:23], s56 offen offset:2048 lds
    s_waitcnt lgkmcnt(2)
    v_mfma_f32_16x16x32_bf16 v[144:147], v[36:39], v[20:23], v[144:147]
    v_mfma_f32_16x16x32_bf16 v[148:151], v[36:39], v[24:27], v[148:151]
    buffer_load_dwordx4 v8, s[20:23], s56 offen offset:3072 lds
    v_mfma_f32_16x16x32_bf16 v[152:155], v[36:39], v[28:31], v[152:155]
    v_mfma_f32_16x16x32_bf16 v[156:159], v[36:39], v[32:35], v[156:159]
    s_add_u32 m0, s53, 114688
    s_waitcnt lgkmcnt(0)
    v_mfma_f32_16x16x32_bf16 v[160:163], v[40:43], v[20:23], v[160:163]
    v_mfma_f32_16x16x32_bf16 v[164:167], v[40:43], v[24:27], v[164:167]
    s_add_u32 s56, s56, 20480
    v_mfma_f32_16x16x32_bf16 v[168:171], v[40:43], v[28:31], v[168:171]
    v_mfma_f32_16x16x32_bf16 v[172:175], v[40:43], v[32:35], v[172:175]
    buffer_load_dwordx4 v9, s[20:23], s57 offen lds
    s_waitcnt vmcnt(10) lgkmcnt(0)
    s_barrier
    ds_read_b64_tr_b16 v[36:37], v14 offset:512
    ds_read_b64_tr_b16 v[38:39], v14 offset:5632
    ds_read_b64_tr_b16 v[40:41], v13 offset:768
    ds_read_b64_tr_b16 v[42:43], v13 offset:5888
    ds_read_b64_tr_b16 v[44:45], v14 offset:768
    ds_read_b64_tr_b16 v[46:47], v14 offset:5888
    s_waitcnt lgkmcnt(4)
    v_mfma_f32_16x16x32_bf16 v[176:179], v[36:39], v[20:23], v[176:179]
    v_mfma_f32_16x16x32_bf16 v[180:183], v[36:39], v[24:27], v[180:183]
    v_mfma_f32_16x16x32_bf16 v[184:187], v[36:39], v[28:31], v[184:187]
    v_mfma_f32_16x16x32_bf16 v[188:191], v[36:39], v[32:35], v[188:191]
    ds_read_b64_tr_b16 v[36:37], v13 offset:1024
    ds_read_b64_tr_b16 v[38:39], v13 offset:6144
    s_waitcnt lgkmcnt(4)
    v_mfma_f32_16x16x32_bf16 v[192:195], v[40:43], v[20:23], v[192:195]
    v_mfma_f32_16x16x32_bf16 v[196:199], v[40:43], v[24:27], v[196:199]
    v_mfma_f32_16x16x32_bf16 v[200:203], v[40:43], v[28:31], v[200:203]
    v_mfma_f32_16x16x32_bf16 v[204:207], v[40:43], v[32:35], v[204:207]
    ds_read_b64_tr_b16 v[40:41], v14 offset:1024
    ds_read_b64_tr_b16 v[42:43], v14 offset:6144
    s_waitcnt lgkmcnt(4)
    v_mfma_f32_16x16x32_bf16 v[208:211], v[44:47], v[20:23], v[208:211]
    v_mfma_f32_16x16x32_bf16 v[212:215], v[44:47], v[24:27], v[212:215]
    v_mfma_f32_16x16x32_bf16 v[216:219], v[44:47], v[28:31], v[216:219]
    v_mfma_f32_16x16x32_bf16 v[220:223], v[44:47], v[32:35], v[220:223]
    s_waitcnt lgkmcnt(2)
    v_mfma_f32_16x16x32_bf16 v[224:227], v[36:39], v[20:23], v[224:227]
    v_mfma_f32_16x16x32_bf16 v[228:231], v[36:39], v[24:27], v[228:231]
    v_mfma_f32_16x16x32_bf16 v[232:235], v[36:39], v[28:31], v[232:235]
    v_mfma_f32_16x16x32_bf16 v[236:239], v[36:39], v[32:35], v[236:239]
    s_waitcnt lgkmcnt(0)
    v_mfma_f32_16x16x32_bf16 v[240:243], v[40:43], v[20:23], v[240:243]
    v_mfma_f32_16x16x32_bf16 v[244:247], v[40:43], v[24:27], v[244:247]
    v_mfma_f32_16x16x32_bf16 v[248:251], v[40:43], v[28:31], v[248:251]
    v_mfma_f32_16x16x32_bf16 v[252:255], v[40:43], v[32:35], v[252:255]
    v_add_u32 v13, 40960, v13
    v_add_u32 v14, 40960, v14
    s_waitcnt vmcnt(0) lgkmcnt(0)
    s_barrier
    v_xor_b32 v0, 64, v16
    ds_read_b128 v[20:23], v0 offset:128
    ds_read_b64_tr_b16 v[36:37], v13 offset:0
    ds_read_b64_tr_b16 v[38:39], v13 offset:5120
    ds_read_b128 v[24:27], v0 offset:6272
    ds_read_b128 v[28:31], v0 offset:12416
    ds_read_b128 v[32:35], v0 offset:18560
    ds_read_b64_tr_b16 v[40:41], v14 offset:0
    ds_read_b64_tr_b16 v[42:43], v14 offset:5120
    ds_read_b64_tr_b16 v[44:45], v13 offset:256
    ds_read_b64_tr_b16 v[46:47], v13 offset:5376
    s_add_u32 m0, s53, 49152
    s_add_u32 s57, s56, 4096
    buffer_load_dwordx4 v5, s[20:23], s56 offen offset:0 lds
    buffer_load_dwordx4 v6, s[20:23], s56 offen offset:1024 lds
    buffer_load_dwordx4 v7, s[20:23], s56 offen offset:2048 lds
    buffer_load_dwordx4 v8, s[20:23], s56 offen offset:3072 lds
    s_add_u32 m0, s53, 53248
    s_add_u32 s56, s56, 20480
    buffer_load_dwordx4 v9, s[20:23], s57 offen lds
    s_waitcnt lgkmcnt(7)
    v_mfma_f32_16x16x32_bf16 v[96:99], v[36:39], v[20:23], v[96:99]
    s_waitcnt lgkmcnt(6)
    v_mfma_f32_16x16x32_bf16 v[100:103], v[36:39], v[24:27], v[100:103]
    s_waitcnt lgkmcnt(5)
    v_mfma_f32_16x16x32_bf16 v[104:107], v[36:39], v[28:31], v[104:107]
    s_add_u32 m0, s53, 69632
    s_waitcnt lgkmcnt(4)
    v_mfma_f32_16x16x32_bf16 v[108:111], v[36:39], v[32:35], v[108:111]
    ds_read_b64_tr_b16 v[36:37], v14 offset:256
    ds_read_b64_tr_b16 v[38:39], v14 offset:5376
    s_waitcnt lgkmcnt(4)
    v_mfma_f32_16x16x32_bf16 v[112:115], v[40:43], v[20:23], v[112:115]
    s_add_u32 s57, s56, 4096
    v_mfma_f32_16x16x32_bf16 v[116:119], v[40:43], v[24:27], v[116:119]
    v_mfma_f32_16x16x32_bf16 v[120:123], v[40:43], v[28:31], v[120:123]
    buffer_load_dwordx4 v5, s[20:23], s56 offen offset:0 lds
    v_mfma_f32_16x16x32_bf16 v[124:127], v[40:43], v[32:35], v[124:127]
    ds_read_b64_tr_b16 v[40:41], v13 offset:512
    ds_read_b64_tr_b16 v[42:43], v13 offset:5632
    s_waitcnt lgkmcnt(4)
    v_mfma_f32_16x16x32_bf16 v[128:131], v[44:47], v[20:23], v[128:131]
    buffer_load_dwordx4 v6, s[20:23], s56 offen offset:1024 lds
    v_mfma_f32_16x16x32_bf16 v[132:135], v[44:47], v[24:27], v[132:135]
    v_mfma_f32_16x16x32_bf16 v[136:139], v[44:47], v[28:31], v[136:139]
    v_mfma_f32_16x16x32_bf16 v[140:143], v[44:47], v[32:35], v[140:143]
    buffer_load_dwordx4 v7, s[20:23], s56 offen offset:2048 lds
    s_waitcnt lgkmcnt(2)
    v_mfma_f32_16x16x32_bf16 v[144:147], v[36:39], v[20:23], v[144:147]
    v_mfma_f32_16x16x32_bf16 v[148:151], v[36:39], v[24:27], v[148:151]
    buffer_load_dwordx4 v8, s[20:23], s56 offen offset:3072 lds
    v_mfma_f32_16x16x32_bf16 v[152:155], v[36:39], v[28:31], v[152:155]
    v_mfma_f32_16x16x32_bf16 v[156:159], v[36:39], v[32:35], v[156:159]
    s_add_u32 m0, s53, 73728
    s_waitcnt lgkmcnt(0)
    v_mfma_f32_16x16x32_bf16 v[160:163], v[40:43], v[20:23], v[160:163]
    v_mfma_f32_16x16x32_bf16 v[164:167], v[40:43], v[24:27], v[164:167]
    s_add_u32 s56, s56, 20480
    v_mfma_f32_16x16x32_bf16 v[168:171], v[40:43], v[28:31], v[168:171]
    v_mfma_f32_16x16x32_bf16 v[172:175], v[40:43], v[32:35], v[172:175]
    buffer_load_dwordx4 v9, s[20:23], s57 offen lds
    s_waitcnt vmcnt(10) lgkmcnt(0)
    s_barrier
    ds_read_b64_tr_b16 v[36:37], v14 offset:512
    ds_read_b64_tr_b16 v[38:39], v14 offset:5632
    ds_read_b64_tr_b16 v[40:41], v13 offset:768
    ds_read_b64_tr_b16 v[42:43], v13 offset:5888
    ds_read_b64_tr_b16 v[44:45], v14 offset:768
    ds_read_b64_tr_b16 v[46:47], v14 offset:5888
    s_waitcnt lgkmcnt(4)
    v_mfma_f32_16x16x32_bf16 v[176:179], v[36:39], v[20:23], v[176:179]
    v_mfma_f32_16x16x32_bf16 v[180:183], v[36:39], v[24:27], v[180:183]
    v_mfma_f32_16x16x32_bf16 v[184:187], v[36:39], v[28:31], v[184:187]
    v_mfma_f32_16x16x32_bf16 v[188:191], v[36:39], v[32:35], v[188:191]
    ds_read_b64_tr_b16 v[36:37], v13 offset:1024
    ds_read_b64_tr_b16 v[38:39], v13 offset:6144
    s_waitcnt lgkmcnt(4)
    v_mfma_f32_16x16x32_bf16 v[192:195], v[40:43], v[20:23], v[192:195]
    v_mfma_f32_16x16x32_bf16 v[196:199], v[40:43], v[24:27], v[196:199]
    v_mfma_f32_16x16x32_bf16 v[200:203], v[40:43], v[28:31], v[200:203]
    v_mfma_f32_16x16x32_bf16 v[204:207], v[40:43], v[32:35], v[204:207]
    ds_read_b64_tr_b16 v[40:41], v14 offset:1024
    ds_read_b64_tr_b16 v[42:43], v14 offset:6144
    s_waitcnt lgkmcnt(4)
    v_mfma_f32_16x16x32_bf16 v[208:211], v[44:47], v[20:23], v[208:211]
    v_mfma_f32_16x16x32_bf16 v[212:215], v[44:47], v[24:27], v[212:215]
    v_mfma_f32_16x16x32_bf16 v[216:219], v[44:47], v[28:31], v[216:219]
    v_mfma_f32_16x16x32_bf16 v[220:223], v[44:47], v[32:35], v[220:223]
    s_waitcnt lgkmcnt(2)
    v_mfma_f32_16x16x32_bf16 v[224:227], v[36:39], v[20:23], v[224:227]
    v_mfma_f32_16x16x32_bf16 v[228:231], v[36:39], v[24:27], v[228:231]
    v_mfma_f32_16x16x32_bf16 v[232:235], v[36:39], v[28:31], v[232:235]
    v_mfma_f32_16x16x32_bf16 v[236:239], v[36:39], v[32:35], v[236:239]
    s_waitcnt lgkmcnt(0)
    v_mfma_f32_16x16x32_bf16 v[240:243], v[40:43], v[20:23], v[240:243]
    v_mfma_f32_16x16x32_bf16 v[244:247], v[40:43], v[24:27], v[244:247]
    v_mfma_f32_16x16x32_bf16 v[248:251], v[40:43], v[28:31], v[248:251]
    v_mfma_f32_16x16x32_bf16 v[252:255], v[40:43], v[32:35], v[252:255]
    v_subrev_u32 v13, 40960, v13
    v_subrev_u32 v14, 40960, v14
    s_waitcnt vmcnt(0) lgkmcnt(0)
    s_barrier
    ds_read_b128 v[20:23], v16 offset:256
    ds_read_b64_tr_b16 v[36:37], v13 offset:0
    ds_read_b64_tr_b16 v[38:39], v13 offset:5120
    ds_read_b128 v[24:27], v16 offset:6400
    ds_read_b128 v[28:31], v16 offset:12544
    ds_read_b128 v[32:35], v16 offset:18688
    ds_read_b64_tr_b16 v[40:41], v14 offset:0
    ds_read_b64_tr_b16 v[42:43], v14 offset:5120
    ds_read_b64_tr_b16 v[44:45], v13 offset:256
    ds_read_b64_tr_b16 v[46:47], v13 offset:5376
    s_add_u32 m0, s53, 90112
    s_add_u32 s57, s56, 4096
    buffer_load_dwordx4 v5, s[20:23], s56 offen offset:0 lds
    buffer_load_dwordx4 v6, s[20:23], s56 offen offset:1024 lds
    buffer_load_dwordx4 v7, s[20:23], s56 offen offset:2048 lds
    buffer_load_dwordx4 v8, s[20:23], s56 offen offset:3072 lds
    s_add_u32 m0, s53, 94208
    s_add_u32 s56, s56, 20480
    buffer_load_dwordx4 v9, s[20:23], s57 offen lds
    s_waitcnt lgkmcnt(7)
    v_mfma_f32_16x16x32_bf16 v[96:99], v[36:39], v[20:23], v[96:99]
    s_waitcnt lgkmcnt(6)
    v_mfma_f32_16x16x32_bf16 v[100:103], v[36:39], v[24:27], v[100:103]
    s_waitcnt lgkmcnt(5)
    v_mfma_f32_16x16x32_bf16 v[104:107], v[36:39], v[28:31], v[104:107]
    s_add_u32 m0, s53, 110592
    s_waitcnt lgkmcnt(4)
    v_mfma_f32_16x16x32_bf16 v[108:111], v[36:39], v[32:35], v[108:111]
    ds_read_b64_tr_b16 v[36:37], v14 offset:256
    ds_read_b64_tr_b16 v[38:39], v14 offset:5376
    s_waitcnt lgkmcnt(4)
    v_mfma_f32_16x16x32_bf16 v[112:115], v[40:43], v[20:23], v[112:115]
    s_add_u32 s57, s56, 4096
    v_mfma_f32_16x16x32_bf16 v[116:119], v[40:43], v[24:27], v[116:119]
    v_mfma_f32_16x16x32_bf16 v[120:123], v[40:43], v[28:31], v[120:123]
    buffer_load_dwordx4 v5, s[20:23], s56 offen offset:0 lds
    v_mfma_f32_16x16x32_bf16 v[124:127], v[40:43], v[32:35], v[124:127]
    ds_read_b64_tr_b16 v[40:41], v13 offset:512
    ds_read_b64_tr_b16 v[42:43], v13 offset:5632
    s_waitcnt lgkmcnt(4)
    v_mfma_f32_16x16x32_bf16 v[128:131], v[44:47], v[20:23], v[128:131]
    buffer_load_dwordx4 v6, s[20:23], s56 offen offset:1024 lds
    v_mfma_f32_16x16x32_bf16 v[132:135], v[44:47], v[24:27], v[132:135]
    v_mfma_f32_16x16x32_bf16 v[136:139], v[44:47], v[28:31], v[136:139]
    v_mfma_f32_16x16x32_bf16 v[140:143], v[44:47], v[32:35], v[140:143]
    buffer_load_dwordx4 v7, s[20:23], s56 offen offset:2048 lds
    s_waitcnt lgkmcnt(2)
    v_mfma_f32_16x16x32_bf16 v[144:147], v[36:39], v[20:23], v[144:147]
    v_mfma_f32_16x16x32_bf16 v[148:151], v[36:39], v[24:27], v[148:151]
    buffer_load_dwordx4 v8, s[20:23], s56 offen offset:3072 lds
    v_mfma_f32_16x16x32_bf16 v[152:155], v[36:39], v[28:31], v[152:155]
    v_mfma_f32_16x16x32_bf16 v[156:159], v[36:39], v[32:35], v[156:159]
    s_add_u32 m0, s53, 114688
    s_waitcnt lgkmcnt(0)
    v_mfma_f32_16x16x32_bf16 v[160:163], v[40:43], v[20:23], v[160:163]
    v_mfma_f32_16x16x32_bf16 v[164:167], v[40:43], v[24:27], v[164:167]
    s_add_u32 s56, s56, 20480
    v_mfma_f32_16x16x32_bf16 v[168:171], v[40:43], v[28:31], v[168:171]
    v_mfma_f32_16x16x32_bf16 v[172:175], v[40:43], v[32:35], v[172:175]
    buffer_load_dwordx4 v9, s[20:23], s57 offen lds
    s_waitcnt vmcnt(10) lgkmcnt(0)
    s_barrier
    ds_read_b64_tr_b16 v[36:37], v14 offset:512
    ds_read_b64_tr_b16 v[38:39], v14 offset:5632
    ds_read_b64_tr_b16 v[40:41], v13 offset:768
    ds_read_b64_tr_b16 v[42:43], v13 offset:5888
    ds_read_b64_tr_b16 v[44:45], v14 offset:768
    ds_read_b64_tr_b16 v[46:47], v14 offset:5888
    s_waitcnt lgkmcnt(4)
    v_mfma_f32_16x16x32_bf16 v[176:179], v[36:39], v[20:23], v[176:179]
    v_mfma_f32_16x16x32_bf16 v[180:183], v[36:39], v[24:27], v[180:183]
    v_mfma_f32_16x16x32_bf16 v[184:187], v[36:39], v[28:31], v[184:187]
    v_mfma_f32_16x16x32_bf16 v[188:191], v[36:39], v[32:35], v[188:191]
    ds_read_b64_tr_b16 v[36:37], v13 offset:1024
    ds_read_b64_tr_b16 v[38:39], v13 offset:6144
    s_waitcnt lgkmcnt(4)
    v_mfma_f32_16x16x32_bf16 v[192:195], v[40:43], v[20:23], v[192:195]
    v_mfma_f32_16x16x32_bf16 v[196:199], v[40:43], v[24:27], v[196:199]
    v_mfma_f32_16x16x32_bf16 v[200:203], v[40:43], v[28:31], v[200:203]
    v_mfma_f32_16x16x32_bf16 v[204:207], v[40:43], v[32:35], v[204:207]
    ds_read_b64_tr_b16 v[40:41], v14 offset:1024
    ds_read_b64_tr_b16 v[42:43], v14 offset:6144
    s_waitcnt lgkmcnt(4)
    v_mfma_f32_16x16x32_bf16 v[208:211], v[44:47], v[20:23], v[208:211]
    v_mfma_f32_16x16x32_bf16 v[212:215], v[44:47], v[24:27], v[212:215]
    v_mfma_f32_16x16x32_bf16 v[216:219], v[44:47], v[28:31], v[216:219]
    v_mfma_f32_16x16x32_bf16 v[220:223], v[44:47], v[32:35], v[220:223]
    s_waitcnt lgkmcnt(2)
    v_mfma_f32_16x16x32_bf16 v[224:227], v[36:39], v[20:23], v[224:227]
    v_mfma_f32_16x16x32_bf16 v[228:231], v[36:39], v[24:27], v[228:231]
    v_mfma_f32_16x16x32_bf16 v[232:235], v[36:39], v[28:31], v[232:235]
    v_mfma_f32_16x16x32_bf16 v[236:239], v[36:39], v[32:35], v[236:239]
    s_waitcnt lgkmcnt(0)
    v_mfma_f32_16x16x32_bf16 v[240:243], v[40:43], v[20:23], v[240:243]
    v_mfma_f32_16x16x32_bf16 v[244:247], v[40:43], v[24:27], v[244:247]
    v_mfma_f32_16x16x32_bf16 v[248:251], v[40:43], v[28:31], v[248:251]
    v_mfma_f32_16x16x32_bf16 v[252:255], v[40:43], v[32:35], v[252:255]
    v_add_u32 v13, 40960, v13
    v_add_u32 v14, 40960, v14
    s_waitcnt vmcnt(0) lgkmcnt(0)
    s_barrier
    v_xor_b32 v0, 64, v16
    ds_read_b128 v[20:23], v0 offset:256
    ds_read_b64_tr_b16 v[36:37], v13 offset:0
    ds_read_b64_tr_b16 v[38:39], v13 offset:5120
    ds_read_b128 v[24:27], v0 offset:6400
    ds_read_b128 v[28:31], v0 offset:12544
    ds_read_b128 v[32:35], v0 offset:18688
    ds_read_b64_tr_b16 v[40:41], v14 offset:0
    ds_read_b64_tr_b16 v[42:43], v14 offset:5120
    ds_read_b64_tr_b16 v[44:45], v13 offset:256
    ds_read_b64_tr_b16 v[46:47], v13 offset:5376
    s_waitcnt lgkmcnt(7)
    v_mfma_f32_16x16x32_bf16 v[96:99], v[36:39], v[20:23], v[96:99]
    s_waitcnt lgkmcnt(6)
    v_mfma_f32_16x16x32_bf16 v[100:103], v[36:39], v[24:27], v[100:103]
    s_waitcnt lgkmcnt(5)
    v_mfma_f32_16x16x32_bf16 v[104:107], v[36:39], v[28:31], v[104:107]
    s_waitcnt lgkmcnt(4)
    v_mfma_f32_16x16x32_bf16 v[108:111], v[36:39], v[32:35], v[108:111]
    ds_read_b64_tr_b16 v[36:37], v14 offset:256
    ds_read_b64_tr_b16 v[38:39], v14 offset:5376
    s_waitcnt lgkmcnt(4)
    v_mfma_f32_16x16x32_bf16 v[112:115], v[40:43], v[20:23], v[112:115]
    v_mfma_f32_16x16x32_bf16 v[116:119], v[40:43], v[24:27], v[116:119]
    v_mfma_f32_16x16x32_bf16 v[120:123], v[40:43], v[28:31], v[120:123]
    v_mfma_f32_16x16x32_bf16 v[124:127], v[40:43], v[32:35], v[124:127]
    ds_read_b64_tr_b16 v[40:41], v13 offset:512
    ds_read_b64_tr_b16 v[42:43], v13 offset:5632
    s_waitcnt lgkmcnt(4)
    v_mfma_f32_16x16x32_bf16 v[128:131], v[44:47], v[20:23], v[128:131]
    v_mfma_f32_16x16x32_bf16 v[132:135], v[44:47], v[24:27], v[132:135]
    v_mfma_f32_16x16x32_bf16 v[136:139], v[44:47], v[28:31], v[136:139]
    v_mfma_f32_16x16x32_bf16 v[140:143], v[44:47], v[32:35], v[140:143]
    s_waitcnt lgkmcnt(2)
    v_mfma_f32_16x16x32_bf16 v[144:147], v[36:39], v[20:23], v[144:147]
    v_mfma_f32_16x16x32_bf16 v[148:151], v[36:39], v[24:27], v[148:151]
    v_mfma_f32_16x16x32_bf16 v[152:155], v[36:39], v[28:31], v[152:155]
    v_mfma_f32_16x16x32_bf16 v[156:159], v[36:39], v[32:35], v[156:159]
    s_waitcnt lgkmcnt(0)
    v_mfma_f32_16x16x32_bf16 v[160:163], v[40:43], v[20:23], v[160:163]
    v_mfma_f32_16x16x32_bf16 v[164:167], v[40:43], v[24:27], v[164:167]
    v_mfma_f32_16x16x32_bf16 v[168:171], v[40:43], v[28:31], v[168:171]
    v_mfma_f32_16x16x32_bf16 v[172:175], v[40:43], v[32:35], v[172:175]
    s_cmp_eq_u32 s50, 4
    s_nop 6
    s_cbranch_scc1 L_Po_b
    s_add_u32 m0, s51, 49152
    s_add_u32 s57, s55, 40960
    buffer_load_dwordx4 v1, s[16:19], s54 offen offset:0 lds
    buffer_load_dwordx4 v2, s[16:19], s54 offen offset:1024 lds
    buffer_load_dwordx4 v3, s[16:19], s54 offen offset:2048 lds
    s_add_u32 m0, s52, 81920
    s_add_u32 s54, s54, 393216
    buffer_load_dwordx4 v4, s[24:27], s55 offen lds
    s_add_u32 m0, s52, 86016
    s_add_u32 s55, s55, 128
    buffer_load_dwordx4 v4, s[24:27], s57 offen lds
    s_add_u32 m0, s51, 69632
    s_nop 0
    buffer_load_dwordx4 v1, s[16:19], s54 offen offset:0 lds
    buffer_load_dwordx4 v2, s[16:19], s54 offen offset:1024 lds
    buffer_load_dwordx4 v3, s[16:19], s54 offen offset:2048 lds
    s_add_u32 s54, s54, 393216
    s_waitcnt vmcnt(8)
    s_branch L_Po_j
L_Po_b:
    s_waitcnt vmcnt(0)
L_Po_j:
    s_waitcnt lgkmcnt(0)
    s_barrier
    ds_read_b64_tr_b16 v[36:37], v14 offset:512
    ds_read_b64_tr_b16 v[38:39], v14 offset:5632
    ds_read_b64_tr_b16 v[40:41], v13 offset:768
    ds_read_b64_tr_b16 v[42:43], v13 offset:5888
    ds_read_b64_tr_b16 v[44:45], v14 offset:768
    ds_read_b64_tr_b16 v[46:47], v14 offset:5888
    s_waitcnt lgkmcnt(4)
    v_mfma_f32_16x16x32_bf16 v[176:179], v[36:39], v[20:23], v[176:179]
    v_mfma_f32_16x16x32_bf16 v[180:183], v[36:39], v[24:27], v[180:183]
    v_mfma_f32_16x16x32_bf16 v[184:187], v[36:39], v[28:31], v[184:187]
    v_mfma_f32_16x16x32_bf16 v[188:191], v[36:39], v[32:35], v[188:191]
    ds_read_b64_tr_b16 v[36:37], v13 offset:1024
    ds_read_b64_tr_b16 v[38:39], v13 offset:6144
    s_waitcnt lgkmcnt(4)
    v_mfma_f32_16x16x32_bf16 v[192:195], v[40:43], v[20:23], v[192:195]
    v_mfma_f32_16x16x32_bf16 v[196:199], v[40:43], v[24:27], v[196:199]
    v_mfma_f32_16x16x32_bf16 v[200:203], v[40:43], v[28:31], v[200:203]
    v_mfma_f32_16x16x32_bf16 v[204:207], v[40:43], v[32:35], v[204:207]
    ds_read_b64_tr_b16 v[40:41], v14 offset:1024
    ds_read_b64_tr_b16 v[42:43], v14 offset:6144
    s_waitcnt lgkmcnt(4)
    v_mfma_f32_16x16x32_bf16 v[208:211], v[44:47], v[20:23], v[208:211]
    v_mfma_f32_16x16x32_bf16 v[212:215], v[44:47], v[24:27], v[212:215]
    v_mfma_f32_16x16x32_bf16 v[216:219], v[44:47], v[28:31], v[216:219]
    v_mfma_f32_16x16x32_bf16 v[220:223], v[44:47], v[32:35], v[220:223]
    s_waitcnt lgkmcnt(2)
    v_mfma_f32_16x16x32_bf16 v[224:227], v[36:39], v[20:23], v[224:227]
    v_mfma_f32_16x16x32_bf16 v[228:231], v[36:39], v[24:27], v[228:231]
    v_mfma_f32_16x16x32_bf16 v[232:235], v[36:39], v[28:31], v[232:235]
    v_mfma_f32_16x16x32_bf16 v[236:239], v[36:39], v[32:35], v[236:239]
    s_waitcnt lgkmcnt(0)
    v_mfma_f32_16x16x32_bf16 v[240:243], v[40:43], v[20:23], v[240:243]
    v_mfma_f32_16x16x32_bf16 v[244:247], v[40:43], v[24:27], v[244:247]
    v_mfma_f32_16x16x32_bf16 v[248:251], v[40:43], v[28:31], v[248:251]
    v_mfma_f32_16x16x32_bf16 v[252:255], v[40:43], v[32:35], v[252:255]
    v_subrev_u32 v13, 40960, v13
    v_subrev_u32 v14, 40960, v14
    s_waitcnt vmcnt(3) lgkmcnt(0)
    s_barrier
    s_cmp_eq_u32 s50, 4
    s_nop 2
    s_cbranch_scc1 L_Ptail
L_PQb:
    ds_read_b128 v[20:23], v15 offset:0
    ds_read_b64_tr_b16 v[36:37], v10 offset:0
    ds_read_b64_tr_b16 v[38:39], v10 offset:1536
    ds_read_b128 v[24:27], v15 offset:2048
    ds_read_b128 v[28:31], v15 offset:4096
    ds_read_b128 v[32:35], v15 offset:6144
    ds_read_b64_tr_b16 v[40:41], v11 offset:0
    ds_read_b64_tr_b16 v[42:43], v11 offset:1536
    ds_read_b64_tr_b16 v[44:45], v12 offset:0
    ds_read_b64_tr_b16 v[46:47], v12 offset:1536
    s_add_u32 m0, s51, 90112
    s_add_u32 s57, s55, 40960
    buffer_load_dwordx4 v1, s[16:19], s54 offen offset:0 lds
    buffer_load_dwordx4 v2, s[16:19], s54 offen offset:1024 lds
    buffer_load_dwordx4 v3, s[16:19], s54 offen offset:2048 lds
    s_add_u32 m0, s52, 122880
    s_add_u32 s54, s54, 393216
    buffer_load_dwordx4 v4, s[24:27], s55 offen lds
    s_waitcnt lgkmcnt(7)
    v_mfma_f32_16x16x32_bf16 v[48:51], v[36:39], v[20:23], v[48:51]
    s_waitcnt lgkmcnt(6)
    v_mfma_f32_16x16x32_bf16 v[52:55], v[36:39], v[24:27], v[52:55]
    s_add_u32 m0, s52, 126976
    s_waitcnt lgkmcnt(5)
    v_mfma_f32_16x16x32_bf16 v[56:59], v[36:39], v[28:31], v[56:59]
    s_add_u32 s55, s55, 128
    s_waitcnt lgkmcnt(4)
    v_mfma_f32_16x16x32_bf16 v[60:63], v[36:39], v[32:35], v[60:63]
    buffer_load_dwordx4 v4, s[24:27], s57 offen lds
    s_waitcnt lgkmcnt(2)
    v_mfma_f32_16x16x32_bf16 v[64:67], v[40:43], v[20:23], v[64:67]
    v_mfma_f32_16x16x32_bf16 v[68:71], v[40:43], v[24:27], v[68:71]
    s_add_u32 m0, s51, 110592
    v_mfma_f32_16x16x32_bf16 v[72:75], v[40:43], v[28:31], v[72:75]
    s_nop 0
    v_mfma_f32_16x16x32_bf16 v[76:79], v[40:43], v[32:35], v[76:79]
    buffer_load_dwordx4 v1, s[16:19], s54 offen offset:0 lds
    s_waitcnt lgkmcnt(0)
    v_mfma_f32_16x16x32_bf16 v[80:83], v[44:47], v[20:23], v[80:83]
    v_mfma_f32_16x16x32_bf16 v[84:87], v[44:47], v[24:27], v[84:87]
    buffer_load_dwordx4 v2, s[16:19], s54 offen offset:1024 lds
    v_mfma_f32_16x16x32_bf16 v[88:91], v[44:47], v[28:31], v[88:91]
    buffer_load_dwordx4 v3, s[16:19], s54 offen offset:2048 lds
    v_mfma_f32_16x16x32_bf16 v[92:95], v[44:47], v[32:35], v[92:95]
    s_add_u32 s54, s54, 393216
    s_waitcnt vmcnt(8) lgkmcnt(0)
    s_barrier
    v_xor_b32 v0, 64, v15
    ds_read_b128 v[20:23], v0 offset:0
    ds_read_b64_tr_b16 v[36:37], v10 offset:20480
    ds_read_b64_tr_b16 v[38:39], v10 offset:22016
    ds_read_b128 v[24:27], v0 offset:2048
    ds_read_b128 v[28:31], v0 offset:4096
    ds_read_b128 v[32:35], v0 offset:6144
    ds_read_b64_tr_b16 v[40:41], v11 offset:20480
    ds_read_b64_tr_b16 v[42:43], v11 offset:22016
    ds_read_b64_tr_b16 v[44:45], v12 offset:20480
    ds_read_b64_tr_b16 v[46:47], v12 offset:22016
    s_waitcnt lgkmcnt(7)
    v_mfma_f32_16x16x32_bf16 v[48:51], v[36:39], v[20:23], v[48:51]
    s_waitcnt lgkmcnt(6)
    v_mfma_f32_16x16x32_bf16 v[52:55], v[36:39], v[24:27], v[52:55]
    s_waitcnt lgkmcnt(5)
    v_mfma_f32_16x16x32_bf16 v[56:59], v[36:39], v[28:31], v[56:59]
    s_waitcnt lgkmcnt(4)
    v_mfma_f32_16x16x32_bf16 v[60:63], v[36:39], v[32:35], v[60:63]
    s_waitcnt lgkmcnt(2)
    v_mfma_f32_16x16x32_bf16 v[64:67], v[40:43], v[20:23], v[64:67]
    v_mfma_f32_16x16x32_bf16 v[68:71], v[40:43], v[24:27], v[68:71]
    v_mfma_f32_16x16x32_bf16 v[72:75], v[40:43], v[28:31], v[72:75]
    v_mfma_f32_16x16x32_bf16 v[76:79], v[40:43], v[32:35], v[76:79]
    s_waitcnt lgkmcnt(0)
    v_mfma_f32_16x16x32_bf16 v[80:83], v[44:47], v[20:23], v[80:83]
    v_mfma_f32_16x16x32_bf16 v[84:87], v[44:47], v[24:27], v[84:87]
    v_mfma_f32_16x16x32_bf16 v[88:91], v[44:47], v[28:31], v[88:91]
    v_mfma_f32_16x16x32_bf16 v[92:95], v[44:47], v[32:35], v[92:95]
    s_barrier
    v_add_u32 v10, 40960, v10
    v_add_u32 v11, 40960, v11
    v_add_u32 v12, 40960, v12
    v_add_u32 v15, 40960, v15
    s_waitcnt vmcnt(3) lgkmcnt(0)
    s_barrier
    ds_read_b128 v[20:23], v15 offset:0
    ds_read_b64_tr_b16 v[36:37], v10 offset:0
    ds_read_b64_tr_b16 v[38:39], v10 offset:1536
    ds_read_b128 v[24:27], v15 offset:2048
    ds_read_b128 v[28:31], v15 offset:4096
    ds_read_b128 v[32:35], v15 offset:6144
    ds_read_b64_tr_b16 v[40:41], v11 offset:0
    ds_read_b64_tr_b16 v[42:43], v11 offset:1536
    ds_read_b64_tr_b16 v[44:45], v12 offset:0
    ds_read_b64_tr_b16 v[46:47], v12 offset:1536
    s_add_u32 m0, s51, 49152
    s_add_u32 s57, s55, 40960
    buffer_load_dwordx4 v1, s[16:19], s54 offen offset:0 lds
    buffer_load_dwordx4 v2, s[16:19], s54 offen offset:1024 lds
    buffer_load_dwordx4 v3, s[16:19], s54 offen offset:2048 lds
    s_add_u32 m0, s52, 81920
    s_add_u32 s54, s54, 393216
    buffer_load_dwordx4 v4, s[24:27], s55 offen lds
    s_waitcnt lgkmcnt(7)
    v_mfma_f32_16x16x32_bf16 v[48:51], v[36:39], v[20:23], v[48:51]
    s_waitcnt lgkmcnt(6)
    v_mfma_f32_16x16x32_bf16 v[52:55], v[36:39], v[24:27], v[52:55]
    s_add_u32 m0, s52, 86016
    s_waitcnt lgkmcnt(5)
    v_mfma_f32_16x16x32_bf16 v[56:59], v[36:39], v[28:31], v[56:59]
    s_add_u32 s55, s55, 128
    s_waitcnt lgkmcnt(4)
    v_mfma_f32_16x16x32_bf16 v[60:63], v[36:39], v[32:35], v[60:63]
    buffer_load_dwordx4 v4, s[24:27], s57 offen lds
    s_waitcnt lgkmcnt(2)
    v_mfma_f32_16x16x32_bf16 v[64:67], v[40:43], v[20:23], v[64:67]
    v_mfma_f32_16x16x32_bf16 v[68:71], v[40:43], v[24:27], v[68:71]
    s_add_u32 m0, s51, 69632
    v_mfma_f32_16x16x32_bf16 v[72:75], v[40:43], v[28:31], v[72:75]
    s_nop 0
    v_mfma_f32_16x16x32_bf16 v[76:79], v[40:43], v[32:35], v[76:79]
    buffer_load_dwordx4 v1, s[16:19], s54 offen offset:0 lds
    s_waitcnt lgkmcnt(0)
    v_mfma_f32_16x16x32_bf16 v[80:83], v[44:47], v[20:23], v[80:83]
    v_mfma_f32_16x16x32_bf16 v[84:87], v[44:47], v[24:27], v[84:87]
    buffer_load_dwordx4 v2, s[16:19], s54 offen offset:1024 lds
    v_mfma_f32_16x16x32_bf16 v[88:91], v[44:47], v[28:31], v[88:91]
    buffer_load_dwordx4 v3, s[16:19], s54 offen offset:2048 lds
    v_mfma_f32_16x16x32_bf16 v[92:95], v[44:47], v[32:35], v[92:95]
    s_add_u32 s54, s54, 393216
    s_waitcnt vmcnt(8) lgkmcnt(0)
    s_barrier
    v_xor_b32 v0, 64, v15
    ds_read_b128 v[20:23], v0 offset:0
    ds_read_b64_tr_b16 v[36:37], v10 offset:20480
    ds_read_b64_tr_b16 v[38:39], v10 offset:22016
    ds_read_b128 v[24:27], v0 offset:2048
    ds_read_b128 v[28:31], v0 offset:4096
    ds_read_b128 v[32:35], v0 offset:6144
    ds_read_b64_tr_b16 v[40:41], v11 offset:20480
    ds_read_b64_tr_b16 v[42:43], v11 offset:22016
    ds_read_b64_tr_b16 v[44:45], v12 offset:20480
    ds_read_b64_tr_b16 v[46:47], v12 offset:22016
    s_waitcnt lgkmcnt(7)
    v_mfma_f32_16x16x32_bf16 v[48:51], v[36:39], v[20:23], v[48:51]
    s_waitcnt lgkmcnt(6)
    v_mfma_f32_16x16x32_bf16 v[52:55], v[36:39], v[24:27], v[52:55]
    s_waitcnt lgkmcnt(5)
    v_mfma_f32_16x16x32_bf16 v[56:59], v[36:39], v[28:31], v[56:59]
    s_waitcnt lgkmcnt(4)
    v_mfma_f32_16x16x32_bf16 v[60:63], v[36:39], v[32:35], v[60:63]
    s_waitcnt lgkmcnt(2)
    v_mfma_f32_16x16x32_bf16 v[64:67], v[40:43], v[20:23], v[64:67]
    v_mfma_f32_16x16x32_bf16 v[68:71], v[40:43], v[24:27], v[68:71]
    v_mfma_f32_16x16x32_bf16 v[72:75], v[40:43], v[28:31], v[72:75]
    v_mfma_f32_16x16x32_bf16 v[76:79], v[40:43], v[32:35], v[76:79]
    s_waitcnt lgkmcnt(0)
    v_mfma_f32_16x16x32_bf16 v[80:83], v[44:47], v[20:23], v[80:83]
    v_mfma_f32_16x16x32_bf16 v[84:87], v[44:47], v[24:27], v[84:87]
    v_mfma_f32_16x16x32_bf16 v[88:91], v[44:47], v[28:31], v[88:91]
    v_mfma_f32_16x16x32_bf16 v[92:95], v[44:47], v[32:35], v[92:95]
    v_subrev_u32 v10, 40960, v10
    v_subrev_u32 v11, 40960, v11
    v_subrev_u32 v12, 40960, v12
    v_subrev_u32 v15, 40960, v15
    s_waitcnt vmcnt(3) lgkmcnt(0)
    s_barrier
    ds_read_b128 v[20:23], v15 offset:0
    ds_read_b64_tr_b16 v[36:37], v10 offset:0
    ds_read_b64_tr_b16 v[38:39], v10 offset:1536
    ds_read_b128 v[24:27], v15 offset:2048
    ds_read_b128 v[28:31], v15 offset:4096
    ds_read_b128 v[32:35], v15 offset:6144
    ds_read_b64_tr_b16 v[40:41], v11 offset:0
    ds_read_b64_tr_b16 v[42:43], v11 offset:1536
    ds_read_b64_tr_b16 v[44:45], v12 offset:0
    ds_read_b64_tr_b16 v[46:47], v12 offset:1536
    s_add_u32 m0, s51, 90112
    s_add_u32 s57, s55, 40960
    buffer_load_dwordx4 v1, s[16:19], s54 offen offset:0 lds
    buffer_load_dwordx4 v2, s[16:19], s54 offen offset:1024 lds
    buffer_load_dwordx4 v3, s[16:19], s54 offen offset:2048 lds
    s_add_u32 m0, s52, 122880
    s_add_u32 s54, s54, 393216
    buffer_load_dwordx4 v4, s[24:27], s55 offen lds
    s_waitcnt lgkmcnt(7)
    v_mfma_f32_16x16x32_bf16 v[48:51], v[36:39], v[20:23], v[48:51]
    s_waitcnt lgkmcnt(6)
    v_mfma_f32_16x16x32_bf16 v[52:55], v[36:39], v[24:27], v[52:55]
    s_add_u32 m0, s52, 126976
    s_waitcnt lgkmcnt(5)
    v_mfma_f32_16x16x32_bf16 v[56:59], v[36:39], v[28:31], v[56:59]
    s_add_u32 s55, s55, 128
    s_waitcnt lgkmcnt(4)
    v_mfma_f32_16x16x32_bf16 v[60:63], v[36:39], v[32:35], v[60:63]
    buffer_load_dwordx4 v4, s[24:27], s57 offen lds
    s_waitcnt lgkmcnt(2)
    v_mfma_f32_16x16x32_bf16 v[64:67], v[40:43], v[20:23], v[64:67]
    v_mfma_f32_16x16x32_bf16 v[68:71], v[40:43], v[24:27], v[68:71]
    s_add_u32 m0, s51, 110592
    v_mfma_f32_16x16x32_bf16 v[72:75], v[40:43], v[28:31], v[72:75]
    s_nop 0
    v_mfma_f32_16x16x32_bf16 v[76:79], v[40:43], v[32:35], v[76:79]
    buffer_load_dwordx4 v1, s[16:19], s54 offen offset:0 lds
    s_waitcnt lgkmcnt(0)
    v_mfma_f32_16x16x32_bf16 v[80:83], v[44:47], v[20:23], v[80:83]
    v_mfma_f32_16x16x32_bf16 v[84:87], v[44:47], v[24:27], v[84:87]
    buffer_load_dwordx4 v2, s[16:19], s54 offen offset:1024 lds
    v_mfma_f32_16x16x32_bf16 v[88:91], v[44:47], v[28:31], v[88:91]
    buffer_load_dwordx4 v3, s[16:19], s54 offen offset:2048 lds
    v_mfma_f32_16x16x32_bf16 v[92:95], v[44:47], v[32:35], v[92:95]
    s_add_u32 s54, s54, 393216
    s_waitcnt vmcnt(8) lgkmcnt(0)
    s_barrier
    v_xor_b32 v0, 64, v15
    ds_read_b128 v[20:23], v0 offset:0
    ds_read_b64_tr_b16 v[36:37], v10 offset:20480
    ds_read_b64_tr_b16 v[38:39], v10 offset:22016
    ds_read_b128 v[24:27], v0 offset:2048
    ds_read_b128 v[28:31], v0 offset:4096
    ds_read_b128 v[32:35], v0 offset:6144
    ds_read_b64_tr_b16 v[40:41], v11 offset:20480
    ds_read_b64_tr_b16 v[42:43], v11 offset:22016
    ds_read_b64_tr_b16 v[44:45], v12 offset:20480
    ds_read_b64_tr_b16 v[46:47], v12 offset:22016
    s_waitcnt lgkmcnt(7)
    v_mfma_f32_16x16x32_bf16 v[48:51], v[36:39], v[20:23], v[48:51]
    s_waitcnt lgkmcnt(6)
    v_mfma_f32_16x16x32_bf16 v[52:55], v[36:39], v[24:27], v[52:55]
    s_waitcnt lgkmcnt(5)
    v_mfma_f32_16x16x32_bf16 v[56:59], v[36:39], v[28:31], v[56:59]
    s_waitcnt lgkmcnt(4)
    v_mfma_f32_16x16x32_bf16 v[60:63], v[36:39], v[32:35], v[60:63]
    s_waitcnt lgkmcnt(2)
    v_mfma_f32_16x16x32_bf16 v[64:67], v[40:43], v[20:23], v[64:67]
    v_mfma_f32_16x16x32_bf16 v[68:71], v[40:43], v[24:27], v[68:71]
    v_mfma_f32_16x16x32_bf16 v[72:75], v[40:43], v[28:31], v[72:75]
    v_mfma_f32_16x16x32_bf16 v[76:79], v[40:43], v[32:35], v[76:79]
    s_waitcnt lgkmcnt(0)
    v_mfma_f32_16x16x32_bf16 v[80:83], v[44:47], v[20:23], v[80:83]
    v_mfma_f32_16x16x32_bf16 v[84:87], v[44:47], v[24:27], v[84:87]
    v_mfma_f32_16x16x32_bf16 v[88:91], v[44:47], v[28:31], v[88:91]
    v_mfma_f32_16x16x32_bf16 v[92:95], v[44:47], v[32:35], v[92:95]
    v_add_u32 v10, 40960, v10
    v_add_u32 v11, 40960, v11
    v_add_u32 v12, 40960, v12
    v_add_u32 v15, 40960, v15
    s_waitcnt vmcnt(3) lgkmcnt(0)
    s_barrier
    ds_read_b128 v[20:23], v15 offset:0
    ds_read_b64_tr_b16 v[36:37], v10 offset:0
    ds_read_b64_tr_b16 v[38:39], v10 offset:1536
    ds_read_b128 v[24:27], v15 offset:2048
    ds_read_b128 v[28:31], v15 offset:4096
    ds_read_b128 v[32:35], v15 offset:6144
    ds_read_b64_tr_b16 v[40:41], v11 offset:0
    ds_read_b64_tr_b16 v[42:43], v11 offset:1536
    ds_read_b64_tr_b16 v[44:45], v12 offset:0
    ds_read_b64_tr_b16 v[46:47], v12 offset:1536
    s_add_u32 m0, s51, 49152
    s_add_u32 s57, s55, 40960
    buffer_load_dwordx4 v1, s[16:19], s54 offen offset:0 lds
    buffer_load_dwordx4 v2, s[16:19], s54 offen offset:1024 lds
    buffer_load_dwordx4 v3, s[16:19], s54 offen offset:2048 lds
    s_add_u32 m0, s52, 81920
    s_add_u32 s54, s54, 393216
    buffer_load_dwordx4 v4, s[24:27], s55 offen lds
    s_waitcnt lgkmcnt(7)
    v_mfma_f32_16x16x32_bf16 v[48:51], v[36:39], v[20:23], v[48:51]
    s_waitcnt lgkmcnt(6)
    v_mfma_f32_16x16x32_bf16 v[52:55], v[36:39], v[24:27], v[52:55]
    s_add_u32 m0, s52, 86016
    s_waitcnt lgkmcnt(5)
    v_mfma_f32_16x16x32_bf16 v[56:59], v[36:39], v[28:31], v[56:59]
    s_add_u32 s55, s55, 128
    s_waitcnt lgkmcnt(4)
    v_mfma_f32_16x16x32_bf16 v[60:63], v[36:39], v[32:35], v[60:63]
    buffer_load_dwordx4 v4, s[24:27], s57 offen lds
    s_waitcnt lgkmcnt(2)
    v_mfma_f32_16x16x32_bf16 v[64:67], v[40:43], v[20:23], v[64:67]
    v_mfma_f32_16x16x32_bf16 v[68:71], v[40:43], v[24:27], v[68:71]
    s_add_u32 m0, s51, 69632
    v_mfma_f32_16x16x32_bf16 v[72:75], v[40:43], v[28:31], v[72:75]
    s_nop 0
    v_mfma_f32_16x16x32_bf16 v[76:79], v[40:43], v[32:35], v[76:79]
    buffer_load_dwordx4 v1, s[16:19], s54 offen offset:0 lds
    s_waitcnt lgkmcnt(0)
    v_mfma_f32_16x16x32_bf16 v[80:83], v[44:47], v[20:23], v[80:83]
    v_mfma_f32_16x16x32_bf16 v[84:87], v[44:47], v[24:27], v[84:87]
    buffer_load_dwordx4 v2, s[16:19], s54 offen offset:1024 lds
    v_mfma_f32_16x16x32_bf16 v[88:91], v[44:47], v[28:31], v[88:91]
    buffer_load_dwordx4 v3, s[16:19], s54 offen offset:2048 lds
    v_mfma_f32_16x16x32_bf16 v[92:95], v[44:47], v[32:35], v[92:95]
    s_add_u32 s54, s54, 393216
    s_waitcnt vmcnt(8) lgkmcnt(0)
    s_barrier
    v_xor_b32 v0, 64, v15
    ds_read_b128 v[20:23], v0 offset:0
    ds_read_b64_tr_b16 v[36:37], v10 offset:20480
    ds_read_b64_tr_b16 v[38:39], v10 offset:22016
    ds_read_b128 v[24:27], v0 offset:2048
    ds_read_b128 v[28:31], v0 offset:4096
    ds_read_b128 v[32:35], v0 offset:6144
    ds_read_b64_tr_b16 v[40:41], v11 offset:20480
    ds_read_b64_tr_b16 v[42:43], v11 offset:22016
    ds_read_b64_tr_b16 v[44:45], v12 offset:20480
    ds_read_b64_tr_b16 v[46:47], v12 offset:22016
    s_waitcnt lgkmcnt(7)
    v_mfma_f32_16x16x32_bf16 v[48:51], v[36:39], v[20:23], v[48:51]
    s_waitcnt lgkmcnt(6)
    v_mfma_f32_16x16x32_bf16 v[52:55], v[36:39], v[24:27], v[52:55]
    s_waitcnt lgkmcnt(5)
    v_mfma_f32_16x16x32_bf16 v[56:59], v[36:39], v[28:31], v[56:59]
    s_waitcnt lgkmcnt(4)
    v_mfma_f32_16x16x32_bf16 v[60:63], v[36:39], v[32:35], v[60:63]
    s_waitcnt lgkmcnt(2)
    v_mfma_f32_16x16x32_bf16 v[64:67], v[40:43], v[20:23], v[64:67]
    v_mfma_f32_16x16x32_bf16 v[68:71], v[40:43], v[24:27], v[68:71]
    v_mfma_f32_16x16x32_bf16 v[72:75], v[40:43], v[28:31], v[72:75]
    v_mfma_f32_16x16x32_bf16 v[76:79], v[40:43], v[32:35], v[76:79]
    s_waitcnt lgkmcnt(0)
    v_mfma_f32_16x16x32_bf16 v[80:83], v[44:47], v[20:23], v[80:83]
    v_mfma_f32_16x16x32_bf16 v[84:87], v[44:47], v[24:27], v[84:87]
    v_mfma_f32_16x16x32_bf16 v[88:91], v[44:47], v[28:31], v[88:91]
    v_mfma_f32_16x16x32_bf16 v[92:95], v[44:47], v[32:35], v[92:95]
    v_subrev_u32 v10, 40960, v10
    v_subrev_u32 v11, 40960, v11
    v_subrev_u32 v12, 40960, v12
    v_subrev_u32 v15, 40960, v15
    s_waitcnt vmcnt(3) lgkmcnt(0)
    s_barrier
    ds_read_b128 v[20:23], v15 offset:0
    ds_read_b64_tr_b16 v[36:37], v10 offset:0
    ds_read_b64_tr_b16 v[38:39], v10 offset:1536
    ds_read_b128 v[24:27], v15 offset:2048
    ds_read_b128 v[28:31], v15 offset:4096
    ds_read_b128 v[32:35], v15 offset:6144
    ds_read_b64_tr_b16 v[40:41], v11 offset:0
    ds_read_b64_tr_b16 v[42:43], v11 offset:1536
    ds_read_b64_tr_b16 v[44:45], v12 offset:0
    ds_read_b64_tr_b16 v[46:47], v12 offset:1536
    s_add_u32 m0, s51, 90112
    s_add_u32 s57, s55, 40960
    buffer_load_dwordx4 v1, s[16:19], s54 offen offset:0 lds
    buffer_load_dwordx4 v2, s[16:19], s54 offen offset:1024 lds
    buffer_load_dwordx4 v3, s[16:19], s54 offen offset:2048 lds
    s_add_u32 m0, s52, 122880
    s_add_u32 s54, s54, 393216
    buffer_load_dwordx4 v4, s[24:27], s55 offen lds
    s_waitcnt lgkmcnt(7)
    v_mfma_f32_16x16x32_bf16 v[48:51], v[36:39], v[20:23], v[48:51]
    s_waitcnt lgkmcnt(6)
    v_mfma_f32_16x16x32_bf16 v[52:55], v[36:39], v[24:27], v[52:55]
    s_add_u32 m0, s52, 126976
    s_waitcnt lgkmcnt(5)
    v_mfma_f32_16x16x32_bf16 v[56:59], v[36:39], v[28:31], v[56:59]
    s_add_u32 s55, s55, 128
    s_waitcnt lgkmcnt(4)
    v_mfma_f32_16x16x32_bf16 v[60:63], v[36:39], v[32:35], v[60:63]
    buffer_load_dwordx4 v4, s[24:27], s57 offen lds
    s_waitcnt lgkmcnt(2)
    v_mfma_f32_16x16x32_bf16 v[64:67], v[40:43], v[20:23], v[64:67]
    v_mfma_f32_16x16x32_bf16 v[68:71], v[40:43], v[24:27], v[68:71]
    s_add_u32 m0, s51, 110592
    v_mfma_f32_16x16x32_bf16 v[72:75], v[40:43], v[28:31], v[72:75]
    s_nop 0
    v_mfma_f32_16x16x32_bf16 v[76:79], v[40:43], v[32:35], v[76:79]
    buffer_load_dwordx4 v1, s[16:19], s54 offen offset:0 lds
    s_waitcnt lgkmcnt(0)
    v_mfma_f32_16x16x32_bf16 v[80:83], v[44:47], v[20:23], v[80:83]
    v_mfma_f32_16x16x32_bf16 v[84:87], v[44:47], v[24:27], v[84:87]
    buffer_load_dwordx4 v2, s[16:19], s54 offen offset:1024 lds
    v_mfma_f32_16x16x32_bf16 v[88:91], v[44:47], v[28:31], v[88:91]
    buffer_load_dwordx4 v3, s[16:19], s54 offen offset:2048 lds
    v_mfma_f32_16x16x32_bf16 v[92:95], v[44:47], v[32:35], v[92:95]
    s_add_u32 s54, s54, 393216
    s_waitcnt vmcnt(8) lgkmcnt(0)
    s_barrier
    v_xor_b32 v0, 64, v15
    ds_read_b128 v[20:23], v0 offset:0
    ds_read_b64_tr_b16 v[36:37], v10 offset:20480
    ds_read_b64_tr_b16 v[38:39], v10 offset:22016
    ds_read_b128 v[24:27], v0 offset:2048
    ds_read_b128 v[28:31], v0 offset:4096
    ds_read_b128 v[32:35], v0 offset:6144
    ds_read_b64_tr_b16 v[40:41], v11 offset:20480
    ds_read_b64_tr_b16 v[42:43], v11 offset:22016
    ds_read_b64_tr_b16 v[44:45], v12 offset:20480
    ds_read_b64_tr_b16 v[46:47], v12 offset:22016
    s_waitcnt lgkmcnt(7)
    v_mfma_f32_16x16x32_bf16 v[48:51], v[36:39], v[20:23], v[48:51]
    s_waitcnt lgkmcnt(6)
    v_mfma_f32_16x16x32_bf16 v[52:55], v[36:39], v[24:27], v[52:55]
    s_waitcnt lgkmcnt(5)
    v_mfma_f32_16x16x32_bf16 v[56:59], v[36:39], v[28:31], v[56:59]
    s_waitcnt lgkmcnt(4)
    v_mfma_f32_16x16x32_bf16 v[60:63], v[36:39], v[32:35], v[60:63]
    s_waitcnt lgkmcnt(2)
    v_mfma_f32_16x16x32_bf16 v[64:67], v[40:43], v[20:23], v[64:67]
    v_mfma_f32_16x16x32_bf16 v[68:71], v[40:43], v[24:27], v[68:71]
    v_mfma_f32_16x16x32_bf16 v[72:75], v[40:43], v[28:31], v[72:75]
    v_mfma_f32_16x16x32_bf16 v[76:79], v[40:43], v[32:35], v[76:79]
    s_waitcnt lgkmcnt(0)
    v_mfma_f32_16x16x32_bf16 v[80:83], v[44:47], v[20:23], v[80:83]
    v_mfma_f32_16x16x32_bf16 v[84:87], v[44:47], v[24:27], v[84:87]
    v_mfma_f32_16x16x32_bf16 v[88:91], v[44:47], v[28:31], v[88:91]
    v_mfma_f32_16x16x32_bf16 v[92:95], v[44:47], v[32:35], v[92:95]
    v_add_u32 v10, 40960, v10
    v_add_u32 v11, 40960, v11
    v_add_u32 v12, 40960, v12
    v_add_u32 v15, 40960, v15
    s_waitcnt vmcnt(3) lgkmcnt(0)
    s_barrier
    ds_read_b128 v[20:23], v15 offset:0
    ds_read_b64_tr_b16 v[36:37], v10 offset:0
    ds_read_b64_tr_b16 v[38:39], v10 offset:1536
    ds_read_b128 v[24:27], v15 offset:2048
    ds_read_b128 v[28:31], v15 offset:4096
    ds_read_b128 v[32:35], v15 offset:6144
    ds_read_b64_tr_b16 v[40:41], v11 offset:0
    ds_read_b64_tr_b16 v[42:43], v11 offset:1536
    ds_read_b64_tr_b16 v[44:45], v12 offset:0
    ds_read_b64_tr_b16 v[46:47], v12 offset:1536
    s_add_u32 m0, s51, 49152
    s_add_u32 s57, s55, 40960
    buffer_load_dwordx4 v1, s[16:19], s54 offen offset:0 lds
    buffer_load_dwordx4 v2, s[16:19], s54 offen offset:1024 lds
    buffer_load_dwordx4 v3, s[16:19], s54 offen offset:2048 lds
    s_add_u32 m0, s52, 81920
    s_add_u32 s54, s54, 393216
    buffer_load_dwordx4 v4, s[24:27], s55 offen lds
    s_waitcnt lgkmcnt(7)
    v_mfma_f32_16x16x32_bf16 v[48:51], v[36:39], v[20:23], v[48:51]
    s_waitcnt lgkmcnt(6)
    v_mfma_f32_16x16x32_bf16 v[52:55], v[36:39], v[24:27], v[52:55]
    s_add_u32 m0, s52, 86016
    s_waitcnt lgkmcnt(5)
    v_mfma_f32_16x16x32_bf16 v[56:59], v[36:39], v[28:31], v[56:59]
    s_add_u32 s55, s55, 128
    s_waitcnt lgkmcnt(4)
    v_mfma_f32_16x16x32_bf16 v[60:63], v[36:39], v[32:35], v[60:63]
    buffer_load_dwordx4 v4, s[24:27], s57 offen lds
    s_waitcnt lgkmcnt(2)
    v_mfma_f32_16x16x32_bf16 v[64:67], v[40:43], v[20:23], v[64:67]
    v_mfma_f32_16x16x32_bf16 v[68:71], v[40:43], v[24:27], v[68:71]
    s_add_u32 m0, s51, 69632
    v_mfma_f32_16x16x32_bf16 v[72:75], v[40:43], v[28:31], v[72:75]
    s_nop 0
    v_mfma_f32_16x16x32_bf16 v[76:79], v[40:43], v[32:35], v[76:79]
    buffer_load_dwordx4 v1, s[16:19], s54 offen offset:0 lds
    s_waitcnt lgkmcnt(0)
    v_mfma_f32_16x16x32_bf16 v[80:83], v[44:47], v[20:23], v[80:83]
    v_mfma_f32_16x16x32_bf16 v[84:87], v[44:47], v[24:27], v[84:87]
    buffer_load_dwordx4 v2, s[16:19], s54 offen offset:1024 lds
    v_mfma_f32_16x16x32_bf16 v[88:91], v[44:47], v[28:31], v[88:91]
    buffer_load_dwordx4 v3, s[16:19], s54 offen offset:2048 lds
    v_mfma_f32_16x16x32_bf16 v[92:95], v[44:47], v[32:35], v[92:95]
    s_add_u32 s54, s54, 393216
    s_waitcnt vmcnt(8) lgkmcnt(0)
    s_barrier
    v_xor_b32 v0, 64, v15
    ds_read_b128 v[20:23], v0 offset:0
    ds_read_b64_tr_b16 v[36:37], v10 offset:20480
    ds_read_b64_tr_b16 v[38:39], v10 offset:22016
    ds_read_b128 v[24:27], v0 offset:2048
    ds_read_b128 v[28:31], v0 offset:4096
    ds_read_b128 v[32:35], v0 offset:6144
    ds_read_b64_tr_b16 v[40:41], v11 offset:20480
    ds_read_b64_tr_b16 v[42:43], v11 offset:22016
    ds_read_b64_tr_b16 v[44:45], v12 offset:20480
    ds_read_b64_tr_b16 v[46:47], v12 offset:22016
    s_waitcnt lgkmcnt(7)
    v_mfma_f32_16x16x32_bf16 v[48:51], v[36:39], v[20:23], v[48:51]
    s_waitcnt lgkmcnt(6)
    v_mfma_f32_16x16x32_bf16 v[52:55], v[36:39], v[24:27], v[52:55]
    s_waitcnt lgkmcnt(5)
    v_mfma_f32_16x16x32_bf16 v[56:59], v[36:39], v[28:31], v[56:59]
    s_waitcnt lgkmcnt(4)
    v_mfma_f32_16x16x32_bf16 v[60:63], v[36:39], v[32:35], v[60:63]
    s_waitcnt lgkmcnt(2)
    v_mfma_f32_16x16x32_bf16 v[64:67], v[40:43], v[20:23], v[64:67]
    v_mfma_f32_16x16x32_bf16 v[68:71], v[40:43], v[24:27], v[68:71]
    v_mfma_f32_16x16x32_bf16 v[72:75], v[40:43], v[28:31], v[72:75]
    v_mfma_f32_16x16x32_bf16 v[76:79], v[40:43], v[32:35], v[76:79]
    s_waitcnt lgkmcnt(0)
    v_mfma_f32_16x16x32_bf16 v[80:83], v[44:47], v[20:23], v[80:83]
    v_mfma_f32_16x16x32_bf16 v[84:87], v[44:47], v[24:27], v[84:87]
    v_mfma_f32_16x16x32_bf16 v[88:91], v[44:47], v[28:31], v[88:91]
    v_mfma_f32_16x16x32_bf16 v[92:95], v[44:47], v[32:35], v[92:95]
    v_subrev_u32 v10, 40960, v10
    v_subrev_u32 v11, 40960, v11
    v_subrev_u32 v12, 40960, v12
    v_subrev_u32 v15, 40960, v15
    s_waitcnt vmcnt(3) lgkmcnt(0)
    s_barrier
    ds_read_b128 v[20:23], v15 offset:0
    ds_read_b64_tr_b16 v[36:37], v10 offset:0
    ds_read_b64_tr_b16 v[38:39], v10 offset:1536
    ds_read_b128 v[24:27], v15 offset:2048
    ds_read_b128 v[28:31], v15 offset:4096
    ds_read_b128 v[32:35], v15 offset:6144
    ds_read_b64_tr_b16 v[40:41], v11 offset:0
    ds_read_b64_tr_b16 v[42:43], v11 offset:1536
    ds_read_b64_tr_b16 v[44:45], v12 offset:0
    ds_read_b64_tr_b16 v[46:47], v12 offset:1536
    s_add_u32 m0, s51, 90112
    s_add_u32 s57, s55, 40960
    buffer_load_dwordx4 v1, s[16:19], s54 offen offset:0 lds
    buffer_load_dwordx4 v2, s[16:19], s54 offen offset:1024 lds
    buffer_load_dwordx4 v3, s[16:19], s54 offen offset:2048 lds
    s_add_u32 m0, s52, 122880
    s_add_u32 s54, s54, 393216
    buffer_load_dwordx4 v4, s[24:27], s55 offen lds
    s_waitcnt lgkmcnt(7)
    v_mfma_f32_16x16x32_bf16 v[48:51], v[36:39], v[20:23], v[48:51]
    s_waitcnt lgkmcnt(6)
    v_mfma_f32_16x16x32_bf16 v[52:55], v[36:39], v[24:27], v[52:55]
    s_add_u32 m0, s52, 126976
    s_waitcnt lgkmcnt(5)
    v_mfma_f32_16x16x32_bf16 v[56:59], v[36:39], v[28:31], v[56:59]
    s_add_u32 s55, s55, 128
    s_waitcnt lgkmcnt(4)
    v_mfma_f32_16x16x32_bf16 v[60:63], v[36:39], v[32:35], v[60:63]
    buffer_load_dwordx4 v4, s[24:27], s57 offen lds
    s_waitcnt lgkmcnt(2)
    v_mfma_f32_16x16x32_bf16 v[64:67], v[40:43], v[20:23], v[64:67]
    v_mfma_f32_16x16x32_bf16 v[68:71], v[40:43], v[24:27], v[68:71]
    s_add_u32 m0, s51, 110592
    v_mfma_f32_16x16x32_bf16 v[72:75], v[40:43], v[28:31], v[72:75]
    s_nop 0
    v_mfma_f32_16x16x32_bf16 v[76:79], v[40:43], v[32:35], v[76:79]
    buffer_load_dwordx4 v1, s[16:19], s54 offen offset:0 lds
    s_waitcnt lgkmcnt(0)
    v_mfma_f32_16x16x32_bf16 v[80:83], v[44:47], v[20:23], v[80:83]
    v_mfma_f32_16x16x32_bf16 v[84:87], v[44:47], v[24:27], v[84:87]
    buffer_load_dwordx4 v2, s[16:19], s54 offen offset:1024 lds
    v_mfma_f32_16x16x32_bf16 v[88:91], v[44:47], v[28:31], v[88:91]
    buffer_load_dwordx4 v3, s[16:19], s54 offen offset:2048 lds
    v_mfma_f32_16x16x32_bf16 v[92:95], v[44:47], v[32:35], v[92:95]
    s_add_u32 s54, s54, 393216
    s_waitcnt vmcnt(8) lgkmcnt(0)
    s_barrier
    v_xor_b32 v0, 64, v15
    ds_read_b128 v[20:23], v0 offset:0
    ds_read_b64_tr_b16 v[36:37], v10 offset:20480
    ds_read_b64_tr_b16 v[38:39], v10 offset:22016
    ds_read_b128 v[24:27], v0 offset:2048
    ds_read_b128 v[28:31], v0 offset:4096
    ds_read_b128 v[32:35], v0 offset:6144
    ds_read_b64_tr_b16 v[40:41], v11 offset:20480
    ds_read_b64_tr_b16 v[42:43], v11 offset:22016
    ds_read_b64_tr_b16 v[44:45], v12 offset:20480
    ds_read_b64_tr_b16 v[46:47], v12 offset:22016
    s_waitcnt lgkmcnt(7)
    v_mfma_f32_16x16x32_bf16 v[48:51], v[36:39], v[20:23], v[48:51]
    s_waitcnt lgkmcnt(6)
    v_mfma_f32_16x16x32_bf16 v[52:55], v[36:39], v[24:27], v[52:55]
    s_waitcnt lgkmcnt(5)
    v_mfma_f32_16x16x32_bf16 v[56:59], v[36:39], v[28:31], v[56:59]
    s_waitcnt lgkmcnt(4)
    v_mfma_f32_16x16x32_bf16 v[60:63], v[36:39], v[32:35], v[60:63]
    s_waitcnt lgkmcnt(2)
    v_mfma_f32_16x16x32_bf16 v[64:67], v[40:43], v[20:23], v[64:67]
    v_mfma_f32_16x16x32_bf16 v[68:71], v[40:43], v[24:27], v[68:71]
    v_mfma_f32_16x16x32_bf16 v[72:75], v[40:43], v[28:31], v[72:75]
    v_mfma_f32_16x16x32_bf16 v[76:79], v[40:43], v[32:35], v[76:79]
    s_waitcnt lgkmcnt(0)
    v_mfma_f32_16x16x32_bf16 v[80:83], v[44:47], v[20:23], v[80:83]
    v_mfma_f32_16x16x32_bf16 v[84:87], v[44:47], v[24:27], v[84:87]
    v_mfma_f32_16x16x32_bf16 v[88:91], v[44:47], v[28:31], v[88:91]
    v_mfma_f32_16x16x32_bf16 v[92:95], v[44:47], v[32:35], v[92:95]
    v_add_u32 v10, 40960, v10
    v_add_u32 v11, 40960, v11
    v_add_u32 v12, 40960, v12
    v_add_u32 v15, 40960, v15
    s_waitcnt vmcnt(3) lgkmcnt(0)
    s_barrier
    ds_read_b128 v[20:23], v15 offset:0
    ds_read_b64_tr_b16 v[36:37], v10 offset:0
    ds_read_b64_tr_b16 v[38:39], v10 offset:1536
    ds_read_b128 v[24:27], v15 offset:2048
    ds_read_b128 v[28:31], v15 offset:4096
    ds_read_b128 v[32:35], v15 offset:6144
    ds_read_b64_tr_b16 v[40:41], v11 offset:0
    ds_read_b64_tr_b16 v[42:43], v11 offset:1536
    ds_read_b64_tr_b16 v[44:45], v12 offset:0
    ds_read_b64_tr_b16 v[46:47], v12 offset:1536
    s_waitcnt lgkmcnt(7)
    v_mfma_f32_16x16x32_bf16 v[48:51], v[36:39], v[20:23], v[48:51]
    s_waitcnt lgkmcnt(6)
    v_mfma_f32_16x16x32_bf16 v[52:55], v[36:39], v[24:27], v[52:55]
    s_waitcnt lgkmcnt(5)
    v_mfma_f32_16x16x32_bf16 v[56:59], v[36:39], v[28:31], v[56:59]
    s_waitcnt lgkmcnt(4)
    v_mfma_f32_16x16x32_bf16 v[60:63], v[36:39], v[32:35], v[60:63]
    s_waitcnt lgkmcnt(2)
    v_mfma_f32_16x16x32_bf16 v[64:67], v[40:43], v[20:23], v[64:67]
    v_mfma_f32_16x16x32_bf16 v[68:71], v[40:43], v[24:27], v[68:71]
    v_mfma_f32_16x16x32_bf16 v[72:75], v[40:43], v[28:31], v[72:75]
    v_mfma_f32_16x16x32_bf16 v[76:79], v[40:43], v[32:35], v[76:79]
    s_waitcnt lgkmcnt(0)
    v_mfma_f32_16x16x32_bf16 v[80:83], v[44:47], v[20:23], v[80:83]
    v_mfma_f32_16x16x32_bf16 v[84:87], v[44:47], v[24:27], v[84:87]
    v_mfma_f32_16x16x32_bf16 v[88:91], v[44:47], v[28:31], v[88:91]
    v_mfma_f32_16x16x32_bf16 v[92:95], v[44:47], v[32:35], v[92:95]
    s_add_u32 s54, s54, 4287103360
    s_sub_u32 s55, s55, 1280
    s_cmp_eq_u32 s50, 3
    s_nop 4
    s_cbranch_scc1 L_Pb_b
    s_add_u32 m0, s51, 49152
    s_add_u32 s57, s55, 40960
    buffer_load_dwordx4 v1, s[16:19], s54 offen offset:0 lds
    buffer_load_dwordx4 v2, s[16:19], s54 offen offset:1024 lds
    buffer_load_dwordx4 v3, s[16:19], s54 offen offset:2048 lds
    s_add_u32 m0, s52, 81920
    s_add_u32 s54, s54, 393216
    buffer_load_dwordx4 v4, s[24:27], s55 offen lds
    s_add_u32 m0, s52, 86016
    s_add_u32 s55, s55, 128
    buffer_load_dwordx4 v4, s[24:27], s57 offen lds
    s_add_u32 m0, s51, 69632
    s_nop 0
    buffer_load_dwordx4 v1, s[16:19], s54 offen offset:0 lds
    buffer_load_dwordx4 v2, s[16:19], s54 offen offset:1024 lds
    buffer_load_dwordx4 v3, s[16:19], s54 offen offset:2048 lds
    s_add_u32 s54, s54, 393216
    s_waitcnt vmcnt(8)
    s_branch L_Pb_j
L_Pb_b:
    s_add_u32 m0, s53, 49152
    s_add_u32 s57, s56, 4096
    buffer_load_dwordx4 v5, s[20:23], s56 offen offset:0 lds
    buffer_load_dwordx4 v6, s[20:23], s56 offen offset:1024 lds
    buffer_load_dwordx4 v7, s[20:23], s56 offen offset:2048 lds
    buffer_load_dwordx4 v8, s[20:23], s56 offen offset:3072 lds
    s_add_u32 m0, s53, 53248
    s_add_u32 s56, s56, 20480
    buffer_load_dwordx4 v9, s[20:23], s57 offen lds
    s_add_u32 m0, s53, 69632
    s_add_u32 s57, s56, 4096
    buffer_load_dwordx4 v5, s[20:23], s56 offen offset:0 lds
    buffer_load_dwordx4 v6, s[20:23], s56 offen offset:1024 lds
    buffer_load_dwordx4 v7, s[20:23], s56 offen offset:2048 lds
    buffer_load_dwordx4 v8, s[20:23], s56 offen offset:3072 lds
    s_add_u32 m0, s53, 73728
    s_add_u32 s56, s56, 20480
    buffer_load_dwordx4 v9, s[20:23], s57 offen lds
    s_waitcnt vmcnt(10)
L_Pb_j:
    s_waitcnt lgkmcnt(0)
    s_barrier
    v_xor_b32 v0, 64, v15
    ds_read_b128 v[20:23], v0 offset:0
    ds_read_b64_tr_b16 v[36:37], v10 offset:20480
    ds_read_b64_tr_b16 v[38:39], v10 offset:22016
    ds_read_b128 v[24:27], v0 offset:2048
    ds_read_b128 v[28:31], v0 offset:4096
    ds_read_b128 v[32:35], v0 offset:6144
    ds_read_b64_tr_b16 v[40:41], v11 offset:20480
    ds_read_b64_tr_b16 v[42:43], v11 offset:22016
    ds_read_b64_tr_b16 v[44:45], v12 offset:20480
    ds_read_b64_tr_b16 v[46:47], v12 offset:22016
    s_waitcnt lgkmcnt(7)
    v_mfma_f32_16x16x32_bf16 v[48:51], v[36:39], v[20:23], v[48:51]
    s_waitcnt lgkmcnt(6)
    v_mfma_f32_16x16x32_bf16 v[52:55], v[36:39], v[24:27], v[52:55]
    s_waitcnt lgkmcnt(5)
    v_mfma_f32_16x16x32_bf16 v[56:59], v[36:39], v[28:31], v[56:59]
    s_waitcnt lgkmcnt(4)
    v_mfma_f32_16x16x32_bf16 v[60:63], v[36:39], v[32:35], v[60:63]
    s_waitcnt lgkmcnt(2)
    v_mfma_f32_16x16x32_bf16 v[64:67], v[40:43], v[20:23], v[64:67]
    v_mfma_f32_16x16x32_bf16 v[68:71], v[40:43], v[24:27], v[68:71]
    v_mfma_f32_16x16x32_bf16 v[72:75], v[40:43], v[28:31], v[72:75]
    v_mfma_f32_16x16x32_bf16 v[76:79], v[40:43], v[32:35], v[76:79]
    s_waitcnt lgkmcnt(0)
    v_mfma_f32_16x16x32_bf16 v[80:83], v[44:47], v[20:23], v[80:83]
    v_mfma_f32_16x16x32_bf16 v[84:87], v[44:47], v[24:27], v[84:87]
    v_mfma_f32_16x16x32_bf16 v[88:91], v[44:47], v[28:31], v[88:91]
    v_mfma_f32_16x16x32_bf16 v[92:95], v[44:47], v[32:35], v[92:95]
    v_subrev_u32 v10, 40960, v10
    v_subrev_u32 v11, 40960, v11
    v_subrev_u32 v12, 40960, v12
    v_subrev_u32 v15, 40960, v15
    s_waitcnt vmcnt(0) lgkmcnt(0)
    s_barrier
    s_add_u32 s50, s50, 1
    s_nop 0
    s_branch L_Pcyc
L_Ptail:
    v_mbcnt_lo_u32_b32 v5, -1, 0
    v_mbcnt_hi_u32_b32 v5, -1, v5
    v_lshrrev_b32 v6, 3, v5
    v_and_b32 v6, 2, v6
    v_and_b32 v7, 7, v5
    v_xor_b32 v6, v6, v7
    v_lshrrev_b32 v7, 3, v5
    v_mul_u32_u24 v7, 1280, v7
    v_lshl_add_u32 v2, v6, 4, v7
    v_xor_b32 v3, 64, v2
    s_mul_i32 s53, s33, 6144
    s_mul_i32 s56, s6, 983040
    s_mul_i32 s59, s33, 61440
    s_add_u32 s56, s56, s59
    s_add_u32 s56, s56, 737280
    v_lshrrev_b32 v8, 4, v5
    v_and_b32 v6, 1, v8
    v_bfe_u32 v7, v5, 2, 2
    v_lshl_add_u32 v8, v8, 3, v7
    v_bfe_u32 v9, v5, 1, 1
    v_and_b32 v10, 1, v5
    v_lshlrev_b32 v10, 3, v10
    v_and_b32 v7, 2, v7
    v_lshl_or_b32 v7, v6, 2, v7
    s_lshl_b32 s57, s33, 1
    v_add_u32 v9, s57, v9
    v_xor_b32 v9, v9, v7
    v_lshl_add_u32 v9, v9, 4, v10
    v_lshl_add_u32 v4, v8, 7, v9
    v_lshlrev_b32 v1, 4, v5
    s_lshl_b32 s58, s5, 4
    s_add_u32 s58, s58, s7
    s_lshl_b32 s58, s58, 3
    s_add_u32 s58, s58, s6
    s_mul_i32 s58, s58, 81920
    s_lshl_b32 s57, s33, 11
    s_add_u32 s58, s58, s57
    s_mul_i32 s57, s6, 5
    s_sub_u32 s49, s33, s57
    s_add_u32 m0, s53, 49152
    s_add_u32 s59, s56, 0
    buffer_load_dwordx4 v2, s[20:23], s59 offen lds
    s_add_u32 m0, s53, 50176
    s_add_u32 s59, s56, 10240
    buffer_load_dwordx4 v3, s[20:23], s59 offen lds
    s_add_u32 m0, s53, 51200
    s_add_u32 s59, s56, 20480
    buffer_load_dwordx4 v2, s[20:23], s59 offen lds
    s_add_u32 m0, s53, 52224
    s_add_u32 s59, s56, 30720
    buffer_load_dwordx4 v3, s[20:23], s59 offen lds
    s_add_u32 m0, s53, 53248
    s_add_u32 s59, s56, 40960
    buffer_load_dwordx4 v2, s[20:23], s59 offen lds
    s_add_u32 m0, s53, 54272
    s_add_u32 s59, s56, 51200
    buffer_load_dwordx4 v3, s[20:23], s59 offen lds
    s_mov_b32 s57, 3
L_Pt0:
    s_barrier
    s_sub_u32 s57, s57, 1
    s_cmp_lg_u32 s57, 0
    s_cbranch_scc1 L_Pt0
    s_add_u32 m0, s53, 73728
    s_add_u32 s59, s56, 128
    buffer_load_dwordx4 v2, s[20:23], s59 offen lds
    s_add_u32 m0, s53, 74752
    s_add_u32 s59, s56, 10368
    buffer_load_dwordx4 v3, s[20:23], s59 offen lds
    s_add_u32 m0, s53, 75776
    s_add_u32 s59, s56, 20608
    buffer_load_dwordx4 v2, s[20:23], s59 offen lds
    s_add_u32 m0, s53, 76800
    s_add_u32 s59, s56, 30848
    buffer_load_dwordx4 v3, s[20:23], s59 offen lds
    s_add_u32 m0, s53, 77824
    s_add_u32 s59, s56, 41088
    buffer_load_dwordx4 v2, s[20:23], s59 offen lds
    s_add_u32 m0, s53, 78848
    s_add_u32 s59, s56, 51328
    buffer_load_dwordx4 v3, s[20:23], s59 offen lds
    s_barrier
    s_barrier
    s_add_u32 m0, s53, 98304
    s_add_u32 s59, s56, 256
    buffer_load_dwordx4 v2, s[20:23], s59 offen lds
    s_add_u32 m0, s53, 99328
    s_add_u32 s59, s56, 10496
    buffer_load_dwordx4 v3, s[20:23], s59 offen lds
    s_add_u32 m0, s53, 100352
    s_add_u32 s59, s56, 20736
    buffer_load_dwordx4 v2, s[20:23], s59 offen lds
    s_add_u32 m0, s53, 101376
    s_add_u32 s59, s56, 30976
    buffer_load_dwordx4 v3, s[20:23], s59 offen lds
    s_add_u32 m0, s53, 102400
    s_add_u32 s59, s56, 41216
    buffer_load_dwordx4 v2, s[20:23], s59 offen lds
    s_add_u32 m0, s53, 103424
    s_add_u32 s59, s56, 51456
    buffer_load_dwordx4 v3, s[20:23], s59 offen lds
    s_barrier
    s_barrier
    s_mov_b32 s57, 9
L_Pt3:
    s_barrier
    s_sub_u32 s57, s57, 1
    s_cmp_lg_u32 s57, 0
    s_cbranch_scc1 L_Pt3
    s_add_u32 m0, s53, 0
    s_add_u32 s59, s56, 384
    buffer_load_dwordx4 v2, s[20:23], s59 offen lds
    s_add_u32 m0, s53, 1024
    s_add_u32 s59, s56, 10624
    buffer_load_dwordx4 v3, s[20:23], s59 offen lds
    s_add_u32 m0, s53, 2048
    s_add_u32 s59, s56, 20864
    buffer_load_dwordx4 v2, s[20:23], s59 offen lds
    s_add_u32 m0, s53, 3072
    s_add_u32 s59, s56, 31104
    buffer_load_dwordx4 v3, s[20:23], s59 offen lds
    s_add_u32 m0, s53, 4096
    s_add_u32 s59, s56, 41344
    buffer_load_dwordx4 v2, s[20:23], s59 offen lds
    s_add_u32 m0, s53, 5120
    s_add_u32 s59, s56, 51584
    buffer_load_dwordx4 v3, s[20:23], s59 offen lds
    s_barrier
    s_waitcnt vmcnt(0) lgkmcnt(0)
    s_barrier
    v_xor_b32 v0, 64, v16
    v_mov_b32 v7, v16
    ds_read_b128 v[8:11], v0 offset:128
    ds_read_b128 v[12:15], v0 offset:6272
    ds_read_b128 v[16:19], v0 offset:12416
    ds_read_b128 v[20:23], v0 offset:18560
    v_add_u32 v5, 49152, v4
    ds_read_b64_tr_b16 v[24:25], v5 offset:12288
    ds_read_b64_tr_b16 v[26:27], v5 offset:12800
    v_add_u32 v6, 73728, v4
    ds_read_b64_tr_b16 v[28:29], v6 offset:12288
    ds_read_b64_tr_b16 v[30:31], v6 offset:12800
    ds_read_b128 v[48:51], v7 offset:0
    ds_read_b128 v[52:55], v7 offset:6144
    ds_read_b128 v[56:59], v7 offset:12288
    ds_read_b128 v[60:63], v7 offset:18432
    ds_read_b64_tr_b16 v[32:33], v5 offset:0
    ds_read_b64_tr_b16 v[34:35], v5 offset:512
    ds_read_b64_tr_b16 v[36:37], v6 offset:0
    ds_read_b64_tr_b16 v[38:39], v6 offset:512
    s_waitcnt lgkmcnt(10)
    v_mfma_f32_16x16x32_bf16 v[96:99], v[24:27], v[8:11], v[96:99]
    ds_read_b64_tr_b16 v[40:41], v5 offset:16384
    ds_read_b64_tr_b16 v[42:43], v5 offset:16896
    v_mfma_f32_16x16x32_bf16 v[100:103], v[24:27], v[12:15], v[100:103]
    v_mfma_f32_16x16x32_bf16 v[104:107], v[24:27], v[16:19], v[104:107]
    v_mfma_f32_16x16x32_bf16 v[108:111], v[24:27], v[20:23], v[108:111]
    s_waitcnt lgkmcnt(10)
    v_mfma_f32_16x16x32_bf16 v[112:115], v[28:31], v[8:11], v[112:115]
    ds_read_b128 v[8:11], v7 offset:256
    ds_read_b64_tr_b16 v[44:45], v6 offset:16384
    ds_read_b64_tr_b16 v[46:47], v6 offset:16896
    v_mfma_f32_16x16x32_bf16 v[116:119], v[28:31], v[12:15], v[116:119]
    ds_read_b128 v[12:15], v7 offset:6400
    v_mfma_f32_16x16x32_bf16 v[120:123], v[28:31], v[16:19], v[120:123]
    ds_read_b128 v[16:19], v7 offset:12544
    v_mfma_f32_16x16x32_bf16 v[124:127], v[28:31], v[20:23], v[124:127]
    ds_read_b128 v[20:23], v7 offset:18688
    s_waitcnt lgkmcnt(10)
    v_mfma_f32_16x16x32_bf16 v[96:99], v[32:35], v[48:51], v[96:99]
    ds_read_b128 v[64:67], v0 offset:0
    ds_read_b128 v[68:71], v0 offset:6144
    ds_read_b128 v[72:75], v0 offset:12288
    ds_read_b128 v[76:79], v0 offset:18432
    ds_read_b64_tr_b16 v[24:25], v5 offset:4096
    ds_read_b64_tr_b16 v[26:27], v5 offset:4608
    v_mfma_f32_16x16x32_bf16 v[100:103], v[32:35], v[52:55], v[100:103]
    v_mfma_f32_16x16x32_bf16 v[104:107], v[32:35], v[56:59], v[104:107]
    v_mfma_f32_16x16x32_bf16 v[108:111], v[32:35], v[60:63], v[108:111]
    s_waitcnt lgkmcnt(14)
    v_mfma_f32_16x16x32_bf16 v[112:115], v[36:39], v[48:51], v[112:115]
    ds_read_b64_tr_b16 v[28:29], v6 offset:4096
    ds_read_b64_tr_b16 v[30:31], v6 offset:4608
    v_mfma_f32_16x16x32_bf16 v[116:119], v[36:39], v[52:55], v[116:119]
    v_mfma_f32_16x16x32_bf16 v[120:123], v[36:39], v[56:59], v[120:123]
    v_mfma_f32_16x16x32_bf16 v[124:127], v[36:39], v[60:63], v[124:127]
    s_waitcnt lgkmcnt(8)
    v_mfma_f32_16x16x32_bf16 v[96:99], v[40:43], v[8:11], v[96:99]
    ds_read_b64_tr_b16 v[32:33], v5 offset:20480
    ds_read_b64_tr_b16 v[34:35], v5 offset:20992
    v_mfma_f32_16x16x32_bf16 v[100:103], v[40:43], v[12:15], v[100:103]
    v_mfma_f32_16x16x32_bf16 v[104:107], v[40:43], v[16:19], v[104:107]
    v_mfma_f32_16x16x32_bf16 v[108:111], v[40:43], v[20:23], v[108:111]
    v_mfma_f32_16x16x32_bf16 v[112:115], v[44:47], v[8:11], v[112:115]
    ds_read_b128 v[8:11], v0 offset:256
    ds_read_b64_tr_b16 v[36:37], v6 offset:20480
    ds_read_b64_tr_b16 v[38:39], v6 offset:20992
    v_mfma_f32_16x16x32_bf16 v[116:119], v[44:47], v[12:15], v[116:119]
    ds_read_b128 v[12:15], v0 offset:6400
    v_mfma_f32_16x16x32_bf16 v[120:123], v[44:47], v[16:19], v[120:123]
    ds_read_b128 v[16:19], v0 offset:12544
    v_mfma_f32_16x16x32_bf16 v[124:127], v[44:47], v[20:23], v[124:127]
    ds_read_b128 v[20:23], v0 offset:18688
    s_waitcnt lgkmcnt(10)
    v_mfma_f32_16x16x32_bf16 v[96:99], v[24:27], v[64:67], v[96:99]
    ds_read_b128 v[80:83], v7 offset:128
    ds_read_b128 v[84:87], v7 offset:6272
    ds_read_b128 v[88:91], v7 offset:12416
    ds_read_b128 v[92:95], v7 offset:18560
    ds_read_b64_tr_b16 v[40:41], v5 offset:8192
    ds_read_b64_tr_b16 v[42:43], v5 offset:8704
    v_mfma_f32_16x16x32_bf16 v[100:103], v[24:27], v[68:71], v[100:103]
    v_mfma_f32_16x16x32_bf16 v[104:107], v[24:27], v[72:75], v[104:107]
    v_mfma_f32_16x16x32_bf16 v[108:111], v[24:27], v[76:79], v[108:111]
    s_waitcnt lgkmcnt(14)
    v_mfma_f32_16x16x32_bf16 v[112:115], v[28:31], v[64:67], v[112:115]
    ds_read_b64_tr_b16 v[44:45], v6 offset:8192
    ds_read_b64_tr_b16 v[46:47], v6 offset:8704
    v_mfma_f32_16x16x32_bf16 v[116:119], v[28:31], v[68:71], v[116:119]
    v_mfma_f32_16x16x32_bf16 v[120:123], v[28:31], v[72:75], v[120:123]
    v_mfma_f32_16x16x32_bf16 v[124:127], v[28:31], v[76:79], v[124:127]
    s_waitcnt lgkmcnt(8)
    v_mfma_f32_16x16x32_bf16 v[96:99], v[32:35], v[8:11], v[96:99]
    v_mfma_f32_16x16x32_bf16 v[100:103], v[32:35], v[12:15], v[100:103]
    v_mfma_f32_16x16x32_bf16 v[104:107], v[32:35], v[16:19], v[104:107]
    v_mfma_f32_16x16x32_bf16 v[108:111], v[32:35], v[20:23], v[108:111]
    v_mfma_f32_16x16x32_bf16 v[112:115], v[36:39], v[8:11], v[112:115]
    ds_read_b128 v[8:11], v0 offset:128
    v_mfma_f32_16x16x32_bf16 v[116:119], v[36:39], v[12:15], v[116:119]
    ds_read_b128 v[12:15], v0 offset:6272
    v_mfma_f32_16x16x32_bf16 v[120:123], v[36:39], v[16:19], v[120:123]
    ds_read_b128 v[16:19], v0 offset:12416
    v_mfma_f32_16x16x32_bf16 v[124:127], v[36:39], v[20:23], v[124:127]
    ds_read_b128 v[20:23], v0 offset:18560
    s_waitcnt lgkmcnt(6)
    v_mfma_f32_16x16x32_bf16 v[96:99], v[40:43], v[80:83], v[96:99]
    v_mfma_f32_16x16x32_bf16 v[100:103], v[40:43], v[84:87], v[100:103]
    v_add_u32 v5, 98304, v4
    ds_read_b64_tr_b16 v[24:25], v5 offset:12288
    ds_read_b64_tr_b16 v[26:27], v5 offset:12800
    v_mfma_f32_16x16x32_bf16 v[104:107], v[40:43], v[88:91], v[104:107]
    v_mfma_f32_16x16x32_bf16 v[108:111], v[40:43], v[92:95], v[108:111]
    v_add_u32 v6, 0, v4
    ds_read_b64_tr_b16 v[28:29], v6 offset:12288
    ds_read_b64_tr_b16 v[30:31], v6 offset:12800
    s_waitcnt lgkmcnt(8)
    v_mfma_f32_16x16x32_bf16 v[112:115], v[44:47], v[80:83], v[112:115]
    v_mfma_f32_16x16x32_bf16 v[116:119], v[44:47], v[84:87], v[116:119]
    ds_read_b64_tr_b16 v[32:33], v5 offset:0
    ds_read_b64_tr_b16 v[34:35], v5 offset:512
    v_mfma_f32_16x16x32_bf16 v[120:123], v[44:47], v[88:91], v[120:123]
    v_mfma_f32_16x16x32_bf16 v[124:127], v[44:47], v[92:95], v[124:127]
    s_barrier
    ds_read_b64_tr_b16 v[36:37], v6 offset:0
    ds_read_b64_tr_b16 v[38:39], v6 offset:512
    s_waitcnt lgkmcnt(8)
    s_waitcnt lgkmcnt(6)
    v_mfma_f32_16x16x32_bf16 v[128:131], v[24:27], v[8:11], v[128:131]
    ds_read_b64_tr_b16 v[40:41], v5 offset:16384
    ds_read_b64_tr_b16 v[42:43], v5 offset:16896
    v_mfma_f32_16x16x32_bf16 v[132:135], v[24:27], v[12:15], v[132:135]
    v_mfma_f32_16x16x32_bf16 v[136:139], v[24:27], v[16:19], v[136:139]
    v_mfma_f32_16x16x32_bf16 v[140:143], v[24:27], v[20:23], v[140:143]
    s_waitcnt lgkmcnt(6)
    v_mfma_f32_16x16x32_bf16 v[144:147], v[28:31], v[8:11], v[144:147]
    ds_read_b128 v[8:11], v7 offset:256
    ds_read_b64_tr_b16 v[44:45], v6 offset:16384
    ds_read_b64_tr_b16 v[46:47], v6 offset:16896
    v_mfma_f32_16x16x32_bf16 v[148:151], v[28:31], v[12:15], v[148:151]
    ds_read_b128 v[12:15], v7 offset:6400
    v_mfma_f32_16x16x32_bf16 v[152:155], v[28:31], v[16:19], v[152:155]
    ds_read_b128 v[16:19], v7 offset:12544
    v_mfma_f32_16x16x32_bf16 v[156:159], v[28:31], v[20:23], v[156:159]
    ds_read_b128 v[20:23], v7 offset:18688
    v_cvt_pk_bf16_f32 v96, v96, v97
    s_waitcnt lgkmcnt(10)
    v_mfma_f32_16x16x32_bf16 v[128:131], v[32:35], v[48:51], v[128:131]
    ds_read_b64_tr_b16 v[24:25], v5 offset:4096
    ds_read_b64_tr_b16 v[26:27], v5 offset:4608
    v_mfma_f32_16x16x32_bf16 v[132:135], v[32:35], v[52:55], v[132:135]
    v_cvt_pk_bf16_f32 v97, v98, v99
    v_mfma_f32_16x16x32_bf16 v[136:139], v[32:35], v[56:59], v[136:139]
    v_mfma_f32_16x16x32_bf16 v[140:143], v[32:35], v[60:63], v[140:143]
    v_cvt_pk_bf16_f32 v98, v100, v101
    s_waitcnt lgkmcnt(10)
    v_mfma_f32_16x16x32_bf16 v[144:147], v[36:39], v[48:51], v[144:147]
    ds_read_b64_tr_b16 v[28:29], v6 offset:4096
    ds_read_b64_tr_b16 v[30:31], v6 offset:4608
    v_cvt_pk_bf16_f32 v99, v102, v103
    v_mfma_f32_16x16x32_bf16 v[148:151], v[36:39], v[52:55], v[148:151]
    v_mfma_f32_16x16x32_bf16 v[152:155], v[36:39], v[56:59], v[152:155]
    v_cvt_pk_bf16_f32 v100, v104, v105
    v_mfma_f32_16x16x32_bf16 v[156:159], v[36:39], v[60:63], v[156:159]
    s_waitcnt lgkmcnt(4)
    v_mfma_f32_16x16x32_bf16 v[128:131], v[40:43], v[8:11], v[128:131]
    ds_read_b64_tr_b16 v[32:33], v5 offset:20480
    ds_read_b64_tr_b16 v[34:35], v5 offset:20992
    v_cvt_pk_bf16_f32 v101, v106, v107
    v_mfma_f32_16x16x32_bf16 v[132:135], v[40:43], v[12:15], v[132:135]
    v_mfma_f32_16x16x32_bf16 v[136:139], v[40:43], v[16:19], v[136:139]
    v_cvt_pk_bf16_f32 v102, v108, v109
    v_mfma_f32_16x16x32_bf16 v[140:143], v[40:43], v[20:23], v[140:143]
    v_cvt_pk_bf16_f32 v103, v110, v111
    v_mfma_f32_16x16x32_bf16 v[144:147], v[44:47], v[8:11], v[144:147]
    ds_read_b128 v[8:11], v0 offset:256
    ds_read_b64_tr_b16 v[36:37], v6 offset:20480
    ds_read_b64_tr_b16 v[38:39], v6 offset:20992
    v_mfma_f32_16x16x32_bf16 v[148:151], v[44:47], v[12:15], v[148:151]
    ds_read_b128 v[12:15], v0 offset:6400
    v_permlane16_swap_b32 v96, v98
    v_mfma_f32_16x16x32_bf16 v[152:155], v[44:47], v[16:19], v[152:155]
    ds_read_b128 v[16:19], v0 offset:12544
    v_mfma_f32_16x16x32_bf16 v[156:159], v[44:47], v[20:23], v[156:159]
    ds_read_b128 v[20:23], v0 offset:18688
    v_permlane16_swap_b32 v97, v99
    s_waitcnt lgkmcnt(10)
    v_mfma_f32_16x16x32_bf16 v[128:131], v[24:27], v[64:67], v[128:131]
    ds_read_b64_tr_b16 v[40:41], v5 offset:8192
    ds_read_b64_tr_b16 v[42:43], v5 offset:8704
    v_mfma_f32_16x16x32_bf16 v[132:135], v[24:27], v[68:71], v[132:135]
    v_permlane16_swap_b32 v100, v102
    v_mfma_f32_16x16x32_bf16 v[136:139], v[24:27], v[72:75], v[136:139]
    v_permlane16_swap_b32 v101, v103
    v_mfma_f32_16x16x32_bf16 v[140:143], v[24:27], v[76:79], v[140:143]
    s_waitcnt lgkmcnt(10)
    v_mfma_f32_16x16x32_bf16 v[144:147], v[28:31], v[64:67], v[144:147]
    ds_read_b64_tr_b16 v[44:45], v6 offset:8192
    ds_read_b64_tr_b16 v[46:47], v6 offset:8704
    v_cvt_pk_bf16_f32 v112, v112, v113
    v_mfma_f32_16x16x32_bf16 v[148:151], v[28:31], v[68:71], v[148:151]
    v_mfma_f32_16x16x32_bf16 v[152:155], v[28:31], v[72:75], v[152:155]
    v_cvt_pk_bf16_f32 v113, v114, v115
    v_mfma_f32_16x16x32_bf16 v[156:159], v[28:31], v[76:79], v[156:159]
    s_waitcnt lgkmcnt(4)
    v_mfma_f32_16x16x32_bf16 v[128:131], v[32:35], v[8:11], v[128:131]
    v_cvt_pk_bf16_f32 v114, v116, v117
    v_mfma_f32_16x16x32_bf16 v[132:135], v[32:35], v[12:15], v[132:135]
    v_cvt_pk_bf16_f32 v115, v118, v119
    v_mfma_f32_16x16x32_bf16 v[136:139], v[32:35], v[16:19], v[136:139]
    v_mfma_f32_16x16x32_bf16 v[140:143], v[32:35], v[20:23], v[140:143]
    v_cvt_pk_bf16_f32 v116, v120, v121
    v_mfma_f32_16x16x32_bf16 v[144:147], v[36:39], v[8:11], v[144:147]
    ds_read_b128 v[8:11], v0 offset:128
    v_mfma_f32_16x16x32_bf16 v[148:151], v[36:39], v[12:15], v[148:151]
    ds_read_b128 v[12:15], v0 offset:6272
    v_cvt_pk_bf16_f32 v117, v122, v123
    v_mfma_f32_16x16x32_bf16 v[152:155], v[36:39], v[16:19], v[152:155]
    ds_read_b128 v[16:19], v0 offset:12416
    v_mfma_f32_16x16x32_bf16 v[156:159], v[36:39], v[20:23], v[156:159]
    ds_read_b128 v[20:23], v0 offset:18560
    v_cvt_pk_bf16_f32 v118, v124, v125
    s_waitcnt lgkmcnt(6)
    v_mfma_f32_16x16x32_bf16 v[128:131], v[40:43], v[80:83], v[128:131]
    v_cvt_pk_bf16_f32 v119, v126, v127
    v_mfma_f32_16x16x32_bf16 v[132:135], v[40:43], v[84:87], v[132:135]
    v_add_u32 v5, 24576, v4
    ds_read_b64_tr_b16 v[24:25], v5 offset:12288
    ds_read_b64_tr_b16 v[26:27], v5 offset:12800
    v_mfma_f32_16x16x32_bf16 v[136:139], v[40:43], v[88:91], v[136:139]
    v_permlane16_swap_b32 v112, v114
    v_mfma_f32_16x16x32_bf16 v[140:143], v[40:43], v[92:95], v[140:143]
    s_waitcnt lgkmcnt(6)
    v_mfma_f32_16x16x32_bf16 v[144:147], v[44:47], v[80:83], v[144:147]
    v_permlane16_swap_b32 v113, v115
    v_mfma_f32_16x16x32_bf16 v[148:151], v[44:47], v[84:87], v[148:151]
    v_mfma_f32_16x16x32_bf16 v[152:155], v[44:47], v[88:91], v[152:155]
    v_permlane16_swap_b32 v116, v118
    v_mfma_f32_16x16x32_bf16 v[156:159], v[44:47], v[92:95], v[156:159]
    v_permlane16_swap_b32 v117, v119
    s_barrier
    v_add_u32 v6, 49152, v4
    ds_read_b64_tr_b16 v[28:29], v6 offset:12288
    ds_read_b64_tr_b16 v[30:31], v6 offset:12800
    ds_read_b64_tr_b16 v[32:33], v5 offset:0
    ds_read_b64_tr_b16 v[34:35], v5 offset:512
    ds_read_b64_tr_b16 v[36:37], v6 offset:0
    ds_read_b64_tr_b16 v[38:39], v6 offset:512
    s_waitcnt lgkmcnt(8)
    s_waitcnt lgkmcnt(6)
    v_mfma_f32_16x16x32_bf16 v[160:163], v[24:27], v[8:11], v[160:163]
    ds_read_b64_tr_b16 v[40:41], v5 offset:16384
    ds_read_b64_tr_b16 v[42:43], v5 offset:16896
    v_mfma_f32_16x16x32_bf16 v[164:167], v[24:27], v[12:15], v[164:167]
    v_mfma_f32_16x16x32_bf16 v[168:171], v[24:27], v[16:19], v[168:171]
    v_mfma_f32_16x16x32_bf16 v[172:175], v[24:27], v[20:23], v[172:175]
    s_waitcnt lgkmcnt(6)
    v_mfma_f32_16x16x32_bf16 v[176:179], v[28:31], v[8:11], v[176:179]
    ds_read_b128 v[8:11], v7 offset:256
    ds_read_b64_tr_b16 v[44:45], v6 offset:16384
    ds_read_b64_tr_b16 v[46:47], v6 offset:16896
    v_mfma_f32_16x16x32_bf16 v[180:183], v[28:31], v[12:15], v[180:183]
    ds_read_b128 v[12:15], v7 offset:6400
    v_mfma_f32_16x16x32_bf16 v[184:187], v[28:31], v[16:19], v[184:187]
    ds_read_b128 v[16:19], v7 offset:12544
    v_mfma_f32_16x16x32_bf16 v[188:191], v[28:31], v[20:23], v[188:191]
    ds_read_b128 v[20:23], v7 offset:18688
    v_cvt_pk_bf16_f32 v128, v128, v129
    s_waitcnt lgkmcnt(10)
    v_mfma_f32_16x16x32_bf16 v[160:163], v[32:35], v[48:51], v[160:163]
    ds_read_b64_tr_b16 v[24:25], v5 offset:4096
    ds_read_b64_tr_b16 v[26:27], v5 offset:4608
    v_mfma_f32_16x16x32_bf16 v[164:167], v[32:35], v[52:55], v[164:167]
    v_cvt_pk_bf16_f32 v129, v130, v131
    v_mfma_f32_16x16x32_bf16 v[168:171], v[32:35], v[56:59], v[168:171]
    v_mfma_f32_16x16x32_bf16 v[172:175], v[32:35], v[60:63], v[172:175]
    v_cvt_pk_bf16_f32 v130, v132, v133
    s_waitcnt lgkmcnt(10)
    v_mfma_f32_16x16x32_bf16 v[176:179], v[36:39], v[48:51], v[176:179]
    ds_read_b64_tr_b16 v[28:29], v6 offset:4096
    ds_read_b64_tr_b16 v[30:31], v6 offset:4608
    v_cvt_pk_bf16_f32 v131, v134, v135
    v_mfma_f32_16x16x32_bf16 v[180:183], v[36:39], v[52:55], v[180:183]
    v_mfma_f32_16x16x32_bf16 v[184:187], v[36:39], v[56:59], v[184:187]
    v_cvt_pk_bf16_f32 v132, v136, v137
    v_mfma_f32_16x16x32_bf16 v[188:191], v[36:39], v[60:63], v[188:191]
    s_waitcnt lgkmcnt(4)
    v_mfma_f32_16x16x32_bf16 v[160:163], v[40:43], v[8:11], v[160:163]
    ds_read_b64_tr_b16 v[32:33], v5 offset:20480
    ds_read_b64_tr_b16 v[34:35], v5 offset:20992
    v_cvt_pk_bf16_f32 v133, v138, v139
    v_mfma_f32_16x16x32_bf16 v[164:167], v[40:43], v[12:15], v[164:167]
    v_mfma_f32_16x16x32_bf16 v[168:171], v[40:43], v[16:19], v[168:171]
    v_cvt_pk_bf16_f32 v134, v140, v141
    v_mfma_f32_16x16x32_bf16 v[172:175], v[40:43], v[20:23], v[172:175]
    v_cvt_pk_bf16_f32 v135, v142, v143
    v_mfma_f32_16x16x32_bf16 v[176:179], v[44:47], v[8:11], v[176:179]
    ds_read_b128 v[8:11], v0 offset:256
    ds_read_b64_tr_b16 v[36:37], v6 offset:20480
    ds_read_b64_tr_b16 v[38:39], v6 offset:20992
    v_mfma_f32_16x16x32_bf16 v[180:183], v[44:47], v[12:15], v[180:183]
    ds_read_b128 v[12:15], v0 offset:6400
    v_permlane16_swap_b32 v128, v130
    v_mfma_f32_16x16x32_bf16 v[184:187], v[44:47], v[16:19], v[184:187]
    ds_read_b128 v[16:19], v0 offset:12544
    v_mfma_f32_16x16x32_bf16 v[188:191], v[44:47], v[20:23], v[188:191]
    ds_read_b128 v[20:23], v0 offset:18688
    v_permlane16_swap_b32 v129, v131
    s_waitcnt lgkmcnt(10)
    v_mfma_f32_16x16x32_bf16 v[160:163], v[24:27], v[64:67], v[160:163]
    ds_read_b64_tr_b16 v[40:41], v5 offset:8192
    ds_read_b64_tr_b16 v[42:43], v5 offset:8704
    v_mfma_f32_16x16x32_bf16 v[164:167], v[24:27], v[68:71], v[164:167]
    v_permlane16_swap_b32 v132, v134
    v_mfma_f32_16x16x32_bf16 v[168:171], v[24:27], v[72:75], v[168:171]
    v_permlane16_swap_b32 v133, v135
    v_mfma_f32_16x16x32_bf16 v[172:175], v[24:27], v[76:79], v[172:175]
    s_waitcnt lgkmcnt(10)
    v_mfma_f32_16x16x32_bf16 v[176:179], v[28:31], v[64:67], v[176:179]
    ds_read_b64_tr_b16 v[44:45], v6 offset:8192
    ds_read_b64_tr_b16 v[46:47], v6 offset:8704
    v_cvt_pk_bf16_f32 v144, v144, v145
    v_mfma_f32_16x16x32_bf16 v[180:183], v[28:31], v[68:71], v[180:183]
    v_mfma_f32_16x16x32_bf16 v[184:187], v[28:31], v[72:75], v[184:187]
    v_cvt_pk_bf16_f32 v145, v146, v147
    v_mfma_f32_16x16x32_bf16 v[188:191], v[28:31], v[76:79], v[188:191]
    s_waitcnt lgkmcnt(4)
    v_mfma_f32_16x16x32_bf16 v[160:163], v[32:35], v[8:11], v[160:163]
    v_cvt_pk_bf16_f32 v146, v148, v149
    v_mfma_f32_16x16x32_bf16 v[164:167], v[32:35], v[12:15], v[164:167]
    v_cvt_pk_bf16_f32 v147, v150, v151
    v_mfma_f32_16x16x32_bf16 v[168:171], v[32:35], v[16:19], v[168:171]
    v_mfma_f32_16x16x32_bf16 v[172:175], v[32:35], v[20:23], v[172:175]
    v_cvt_pk_bf16_f32 v148, v152, v153
    v_mfma_f32_16x16x32_bf16 v[176:179], v[36:39], v[8:11], v[176:179]
    ds_read_b128 v[8:11], v0 offset:128
    v_mfma_f32_16x16x32_bf16 v[180:183], v[36:39], v[12:15], v[180:183]
    ds_read_b128 v[12:15], v0 offset:6272
    v_cvt_pk_bf16_f32 v149, v154, v155
    v_mfma_f32_16x16x32_bf16 v[184:187], v[36:39], v[16:19], v[184:187]
    ds_read_b128 v[16:19], v0 offset:12416
    v_mfma_f32_16x16x32_bf16 v[188:191], v[36:39], v[20:23], v[188:191]
    ds_read_b128 v[20:23], v0 offset:18560
    v_cvt_pk_bf16_f32 v150, v156, v157
    s_waitcnt lgkmcnt(6)
    v_mfma_f32_16x16x32_bf16 v[160:163], v[40:43], v[80:83], v[160:163]
    v_cvt_pk_bf16_f32 v151, v158, v159
    v_mfma_f32_16x16x32_bf16 v[164:167], v[40:43], v[84:87], v[164:167]
    v_mfma_f32_16x16x32_bf16 v[168:171], v[40:43], v[88:91], v[168:171]
    v_permlane16_swap_b32 v144, v146
    v_mfma_f32_16x16x32_bf16 v[172:175], v[40:43], v[92:95], v[172:175]
    s_waitcnt lgkmcnt(4)
    v_mfma_f32_16x16x32_bf16 v[176:179], v[44:47], v[80:83], v[176:179]
    v_permlane16_swap_b32 v145, v147
    v_mfma_f32_16x16x32_bf16 v[180:183], v[44:47], v[84:87], v[180:183]
    v_mfma_f32_16x16x32_bf16 v[184:187], v[44:47], v[88:91], v[184:187]
    v_permlane16_swap_b32 v148, v150
    v_mfma_f32_16x16x32_bf16 v[188:191], v[44:47], v[92:95], v[188:191]
    v_permlane16_swap_b32 v149, v151
    s_barrier
    v_add_u32 v5, 73728, v4
    ds_read_b64_tr_b16 v[24:25], v5 offset:12288
    ds_read_b64_tr_b16 v[26:27], v5 offset:12800
    v_add_u32 v6, 98304, v4
    ds_read_b64_tr_b16 v[28:29], v6 offset:12288
    ds_read_b64_tr_b16 v[30:31], v6 offset:12800
    ds_read_b64_tr_b16 v[32:33], v5 offset:0
    ds_read_b64_tr_b16 v[34:35], v5 offset:512
    ds_read_b64_tr_b16 v[36:37], v6 offset:0
    ds_read_b64_tr_b16 v[38:39], v6 offset:512
    s_waitcnt lgkmcnt(8)
    s_waitcnt lgkmcnt(6)
    v_mfma_f32_16x16x32_bf16 v[192:195], v[24:27], v[8:11], v[192:195]
    ds_read_b64_tr_b16 v[40:41], v5 offset:16384
    ds_read_b64_tr_b16 v[42:43], v5 offset:16896
    v_mfma_f32_16x16x32_bf16 v[196:199], v[24:27], v[12:15], v[196:199]
    v_mfma_f32_16x16x32_bf16 v[200:203], v[24:27], v[16:19], v[200:203]
    v_mfma_f32_16x16x32_bf16 v[204:207], v[24:27], v[20:23], v[204:207]
    s_waitcnt lgkmcnt(6)
    v_mfma_f32_16x16x32_bf16 v[208:211], v[28:31], v[8:11], v[208:211]
    ds_read_b128 v[8:11], v7 offset:256
    ds_read_b64_tr_b16 v[44:45], v6 offset:16384
    ds_read_b64_tr_b16 v[46:47], v6 offset:16896
    v_mfma_f32_16x16x32_bf16 v[212:215], v[28:31], v[12:15], v[212:215]
    ds_read_b128 v[12:15], v7 offset:6400
    v_mfma_f32_16x16x32_bf16 v[216:219], v[28:31], v[16:19], v[216:219]
    ds_read_b128 v[16:19], v7 offset:12544
    v_cvt_pk_bf16_f32 v160, v160, v161
    v_mfma_f32_16x16x32_bf16 v[220:223], v[28:31], v[20:23], v[220:223]
    ds_read_b128 v[20:23], v7 offset:18688
    v_cvt_pk_bf16_f32 v161, v162, v163
    s_waitcnt lgkmcnt(10)
    v_mfma_f32_16x16x32_bf16 v[192:195], v[32:35], v[48:51], v[192:195]
    ds_read_b64_tr_b16 v[24:25], v5 offset:4096
    ds_read_b64_tr_b16 v[26:27], v5 offset:4608
    v_cvt_pk_bf16_f32 v162, v164, v165
    v_mfma_f32_16x16x32_bf16 v[196:199], v[32:35], v[52:55], v[196:199]
    v_cvt_pk_bf16_f32 v163, v166, v167
    v_mfma_f32_16x16x32_bf16 v[200:203], v[32:35], v[56:59], v[200:203]
    v_cvt_pk_bf16_f32 v164, v168, v169
    v_mfma_f32_16x16x32_bf16 v[204:207], v[32:35], v[60:63], v[204:207]
    v_cvt_pk_bf16_f32 v165, v170, v171
    s_waitcnt lgkmcnt(10)
    v_mfma_f32_16x16x32_bf16 v[208:211], v[36:39], v[48:51], v[208:211]
    ds_read_b64_tr_b16 v[28:29], v6 offset:4096
    ds_read_b64_tr_b16 v[30:31], v6 offset:4608
    v_cvt_pk_bf16_f32 v166, v172, v173
    v_mfma_f32_16x16x32_bf16 v[212:215], v[36:39], v[52:55], v[212:215]
    v_cvt_pk_bf16_f32 v167, v174, v175
    v_mfma_f32_16x16x32_bf16 v[216:219], v[36:39], v[56:59], v[216:219]
    v_permlane16_swap_b32 v160, v162
    v_mfma_f32_16x16x32_bf16 v[220:223], v[36:39], v[60:63], v[220:223]
    v_permlane16_swap_b32 v161, v163
    s_waitcnt lgkmcnt(4)
    v_mfma_f32_16x16x32_bf16 v[192:195], v[40:43], v[8:11], v[192:195]
    ds_read_b64_tr_b16 v[32:33], v5 offset:20480
    ds_read_b64_tr_b16 v[34:35], v5 offset:20992
    v_permlane16_swap_b32 v164, v166
    v_mfma_f32_16x16x32_bf16 v[196:199], v[40:43], v[12:15], v[196:199]
    v_permlane16_swap_b32 v165, v167
    v_mfma_f32_16x16x32_bf16 v[200:203], v[40:43], v[16:19], v[200:203]
    v_cvt_pk_bf16_f32 v176, v176, v177
    v_mfma_f32_16x16x32_bf16 v[204:207], v[40:43], v[20:23], v[204:207]
    v_cvt_pk_bf16_f32 v177, v178, v179
    v_mfma_f32_16x16x32_bf16 v[208:211], v[44:47], v[8:11], v[208:211]
    ds_read_b128 v[8:11], v0 offset:256
    ds_read_b64_tr_b16 v[36:37], v6 offset:20480
    ds_read_b64_tr_b16 v[38:39], v6 offset:20992
    v_cvt_pk_bf16_f32 v178, v180, v181
    v_mfma_f32_16x16x32_bf16 v[212:215], v[44:47], v[12:15], v[212:215]
    ds_read_b128 v[12:15], v0 offset:6400
    v_cvt_pk_bf16_f32 v179, v182, v183
    v_mfma_f32_16x16x32_bf16 v[216:219], v[44:47], v[16:19], v[216:219]
    ds_read_b128 v[16:19], v0 offset:12544
    v_cvt_pk_bf16_f32 v180, v184, v185
    v_mfma_f32_16x16x32_bf16 v[220:223], v[44:47], v[20:23], v[220:223]
    ds_read_b128 v[20:23], v0 offset:18688
    v_cvt_pk_bf16_f32 v181, v186, v187
    s_waitcnt lgkmcnt(10)
    v_mfma_f32_16x16x32_bf16 v[192:195], v[24:27], v[64:67], v[192:195]
    ds_read_b64_tr_b16 v[40:41], v5 offset:8192
    ds_read_b64_tr_b16 v[42:43], v5 offset:8704
    v_cvt_pk_bf16_f32 v182, v188, v189
    v_mfma_f32_16x16x32_bf16 v[196:199], v[24:27], v[68:71], v[196:199]
    v_cvt_pk_bf16_f32 v183, v190, v191
    v_mfma_f32_16x16x32_bf16 v[200:203], v[24:27], v[72:75], v[200:203]
    v_permlane16_swap_b32 v176, v178
    v_mfma_f32_16x16x32_bf16 v[204:207], v[24:27], v[76:79], v[204:207]
    v_permlane16_swap_b32 v177, v179
    s_waitcnt lgkmcnt(10)
    v_mfma_f32_16x16x32_bf16 v[208:211], v[28:31], v[64:67], v[208:211]
    ds_read_b64_tr_b16 v[44:45], v6 offset:8192
    ds_read_b64_tr_b16 v[46:47], v6 offset:8704
    v_permlane16_swap_b32 v180, v182
    v_mfma_f32_16x16x32_bf16 v[212:215], v[28:31], v[68:71], v[212:215]
    v_permlane16_swap_b32 v181, v183
    v_mfma_f32_16x16x32_bf16 v[216:219], v[28:31], v[72:75], v[216:219]
    s_add_u32 s57, s49, 0
    v_mfma_f32_16x16x32_bf16 v[220:223], v[28:31], v[76:79], v[220:223]
    s_cmp_lt_u32 s57, 5
    s_waitcnt lgkmcnt(4)
    v_mfma_f32_16x16x32_bf16 v[192:195], v[32:35], v[8:11], v[192:195]
    s_cselect_b32 s57, 1073741824, s58
    v_mfma_f32_16x16x32_bf16 v[196:199], v[32:35], v[12:15], v[196:199]
    buffer_store_dwordx4 v[96:99], v1, s[28:31], s57 offen offset:0 sc1
    v_mfma_f32_16x16x32_bf16 v[200:203], v[32:35], v[16:19], v[200:203]
    buffer_store_dwordx4 v[100:103], v1, s[28:31], s57 offen offset:1024 sc1
    v_mfma_f32_16x16x32_bf16 v[204:207], v[32:35], v[20:23], v[204:207]
    s_add_u32 s58, s58, 8192
    v_mfma_f32_16x16x32_bf16 v[208:211], v[36:39], v[8:11], v[208:211]
    ds_read_b128 v[8:11], v0 offset:128
    s_add_u32 s57, s49, 4
    v_mfma_f32_16x16x32_bf16 v[212:215], v[36:39], v[12:15], v[212:215]
    ds_read_b128 v[12:15], v0 offset:6272
    s_cmp_lt_u32 s57, 5
    v_mfma_f32_16x16x32_bf16 v[216:219], v[36:39], v[16:19], v[216:219]
    ds_read_b128 v[16:19], v0 offset:12416
    s_cselect_b32 s57, 1073741824, s58
    v_mfma_f32_16x16x32_bf16 v[220:223], v[36:39], v[20:23], v[220:223]
    ds_read_b128 v[20:23], v0 offset:18560
    buffer_store_dwordx4 v[112:115], v1, s[28:31], s57 offen offset:0 sc1
    s_waitcnt lgkmcnt(6)
    v_mfma_f32_16x16x32_bf16 v[192:195], v[40:43], v[80:83], v[192:195]
    buffer_store_dwordx4 v[116:119], v1, s[28:31], s57 offen offset:1024 sc1
    v_mfma_f32_16x16x32_bf16 v[196:199], v[40:43], v[84:87], v[196:199]
    s_add_u32 s58, s58, 8192
    v_mfma_f32_16x16x32_bf16 v[200:203], v[40:43], v[88:91], v[200:203]
    s_add_u32 s57, s49, 8
    v_mfma_f32_16x16x32_bf16 v[204:207], v[40:43], v[92:95], v[204:207]
    s_cmp_lt_u32 s57, 5
    s_waitcnt lgkmcnt(4)
    v_mfma_f32_16x16x32_bf16 v[208:211], v[44:47], v[80:83], v[208:211]
    s_cselect_b32 s57, 1073741824, s58
    v_mfma_f32_16x16x32_bf16 v[212:215], v[44:47], v[84:87], v[212:215]
    buffer_store_dwordx4 v[128:131], v1, s[28:31], s57 offen offset:0 sc1
    v_mfma_f32_16x16x32_bf16 v[216:219], v[44:47], v[88:91], v[216:219]
    buffer_store_dwordx4 v[132:135], v1, s[28:31], s57 offen offset:1024 sc1
    v_mfma_f32_16x16x32_bf16 v[220:223], v[44:47], v[92:95], v[220:223]
    s_add_u32 s58, s58, 8192
    s_barrier
    v_add_u32 v5, 0, v4
    ds_read_b64_tr_b16 v[24:25], v5 offset:12288
    ds_read_b64_tr_b16 v[26:27], v5 offset:12800
    v_add_u32 v6, 24576, v4
    ds_read_b64_tr_b16 v[28:29], v6 offset:12288
    ds_read_b64_tr_b16 v[30:31], v6 offset:12800
    ds_read_b64_tr_b16 v[32:33], v5 offset:0
    ds_read_b64_tr_b16 v[34:35], v5 offset:512
    ds_read_b64_tr_b16 v[36:37], v6 offset:0
    ds_read_b64_tr_b16 v[38:39], v6 offset:512
    s_waitcnt lgkmcnt(8)
    s_waitcnt lgkmcnt(6)
    v_mfma_f32_16x16x32_bf16 v[224:227], v[24:27], v[8:11], v[224:227]
    ds_read_b64_tr_b16 v[40:41], v5 offset:16384
    ds_read_b64_tr_b16 v[42:43], v5 offset:16896
    v_mfma_f32_16x16x32_bf16 v[228:231], v[24:27], v[12:15], v[228:231]
    v_mfma_f32_16x16x32_bf16 v[232:235], v[24:27], v[16:19], v[232:235]
    v_mfma_f32_16x16x32_bf16 v[236:239], v[24:27], v[20:23], v[236:239]
    s_waitcnt lgkmcnt(6)
    v_mfma_f32_16x16x32_bf16 v[240:243], v[28:31], v[8:11], v[240:243]
    ds_read_b128 v[8:11], v7 offset:256
    ds_read_b64_tr_b16 v[44:45], v6 offset:16384
    ds_read_b64_tr_b16 v[46:47], v6 offset:16896
    v_mfma_f32_16x16x32_bf16 v[244:247], v[28:31], v[12:15], v[244:247]
    ds_read_b128 v[12:15], v7 offset:6400
    v_mfma_f32_16x16x32_bf16 v[248:251], v[28:31], v[16:19], v[248:251]
    ds_read_b128 v[16:19], v7 offset:12544
    v_cvt_pk_bf16_f32 v192, v192, v193
    v_mfma_f32_16x16x32_bf16 v[252:255], v[28:31], v[20:23], v[252:255]
    ds_read_b128 v[20:23], v7 offset:18688
    v_cvt_pk_bf16_f32 v193, v194, v195
    s_waitcnt lgkmcnt(10)
    v_mfma_f32_16x16x32_bf16 v[224:227], v[32:35], v[48:51], v[224:227]
    ds_read_b64_tr_b16 v[24:25], v5 offset:4096
    ds_read_b64_tr_b16 v[26:27], v5 offset:4608
    v_cvt_pk_bf16_f32 v194, v196, v197
    v_mfma_f32_16x16x32_bf16 v[228:231], v[32:35], v[52:55], v[228:231]
    v_cvt_pk_bf16_f32 v195, v198, v199
    v_mfma_f32_16x16x32_bf16 v[232:235], v[32:35], v[56:59], v[232:235]
    v_cvt_pk_bf16_f32 v196, v200, v201
    v_mfma_f32_16x16x32_bf16 v[236:239], v[32:35], v[60:63], v[236:239]
    v_cvt_pk_bf16_f32 v197, v202, v203
    s_waitcnt lgkmcnt(10)
    v_mfma_f32_16x16x32_bf16 v[240:243], v[36:39], v[48:51], v[240:243]
    ds_read_b64_tr_b16 v[28:29], v6 offset:4096
    ds_read_b64_tr_b16 v[30:31], v6 offset:4608
    v_cvt_pk_bf16_f32 v198, v204, v205
    v_cvt_pk_bf16_f32 v199, v206, v207
    v_mfma_f32_16x16x32_bf16 v[244:247], v[36:39], v[52:55], v[244:247]
    v_permlane16_swap_b32 v192, v194
    v_mfma_f32_16x16x32_bf16 v[248:251], v[36:39], v[56:59], v[248:251]
    v_permlane16_swap_b32 v193, v195
    v_mfma_f32_16x16x32_bf16 v[252:255], v[36:39], v[60:63], v[252:255]
    v_permlane16_swap_b32 v196, v198
    s_waitcnt lgkmcnt(4)
    v_mfma_f32_16x16x32_bf16 v[224:227], v[40:43], v[8:11], v[224:227]
    ds_read_b64_tr_b16 v[32:33], v5 offset:20480
    ds_read_b64_tr_b16 v[34:35], v5 offset:20992
    v_permlane16_swap_b32 v197, v199
    v_mfma_f32_16x16x32_bf16 v[228:231], v[40:43], v[12:15], v[228:231]
    v_cvt_pk_bf16_f32 v208, v208, v209
    v_mfma_f32_16x16x32_bf16 v[232:235], v[40:43], v[16:19], v[232:235]
    v_cvt_pk_bf16_f32 v209, v210, v211
    v_mfma_f32_16x16x32_bf16 v[236:239], v[40:43], v[20:23], v[236:239]
    v_cvt_pk_bf16_f32 v210, v212, v213
    v_cvt_pk_bf16_f32 v211, v214, v215
    v_mfma_f32_16x16x32_bf16 v[240:243], v[44:47], v[8:11], v[240:243]
    ds_read_b128 v[8:11], v0 offset:256
    ds_read_b64_tr_b16 v[36:37], v6 offset:20480
    ds_read_b64_tr_b16 v[38:39], v6 offset:20992
    v_cvt_pk_bf16_f32 v212, v216, v217
    v_mfma_f32_16x16x32_bf16 v[244:247], v[44:47], v[12:15], v[244:247]
    ds_read_b128 v[12:15], v0 offset:6400
    v_cvt_pk_bf16_f32 v213, v218, v219
    v_mfma_f32_16x16x32_bf16 v[248:251], v[44:47], v[16:19], v[248:251]
    ds_read_b128 v[16:19], v0 offset:12544
    v_cvt_pk_bf16_f32 v214, v220, v221
    v_mfma_f32_16x16x32_bf16 v[252:255], v[44:47], v[20:23], v[252:255]
    ds_read_b128 v[20:23], v0 offset:18688
    v_cvt_pk_bf16_f32 v215, v222, v223
    s_waitcnt lgkmcnt(10)
    v_mfma_f32_16x16x32_bf16 v[224:227], v[24:27], v[64:67], v[224:227]
    ds_read_b64_tr_b16 v[40:41], v5 offset:8192
    ds_read_b64_tr_b16 v[42:43], v5 offset:8704
    v_permlane16_swap_b32 v208, v210
    v_mfma_f32_16x16x32_bf16 v[228:231], v[24:27], v[68:71], v[228:231]
    v_permlane16_swap_b32 v209, v211
    v_mfma_f32_16x16x32_bf16 v[232:235], v[24:27], v[72:75], v[232:235]
    v_permlane16_swap_b32 v212, v214
    v_permlane16_swap_b32 v213, v215
    v_mfma_f32_16x16x32_bf16 v[236:239], v[24:27], v[76:79], v[236:239]
    s_add_u32 s57, s49, 12
    s_waitcnt lgkmcnt(10)
    v_mfma_f32_16x16x32_bf16 v[240:243], v[28:31], v[64:67], v[240:243]
    ds_read_b64_tr_b16 v[44:45], v6 offset:8192
    ds_read_b64_tr_b16 v[46:47], v6 offset:8704
    s_cmp_lt_u32 s57, 5
    v_mfma_f32_16x16x32_bf16 v[244:247], v[28:31], v[68:71], v[244:247]
    s_cselect_b32 s57, 1073741824, s58
    v_mfma_f32_16x16x32_bf16 v[248:251], v[28:31], v[72:75], v[248:251]
    buffer_store_dwordx4 v[144:147], v1, s[28:31], s57 offen offset:0 sc1
    v_mfma_f32_16x16x32_bf16 v[252:255], v[28:31], v[76:79], v[252:255]
    buffer_store_dwordx4 v[148:151], v1, s[28:31], s57 offen offset:1024 sc1
    s_waitcnt lgkmcnt(4)
    v_mfma_f32_16x16x32_bf16 v[224:227], v[32:35], v[8:11], v[224:227]
    s_add_u32 s58, s58, 8192
    v_mfma_f32_16x16x32_bf16 v[228:231], v[32:35], v[12:15], v[228:231]
    s_add_u32 s57, s49, 16
    s_cmp_lt_u32 s57, 5
    v_mfma_f32_16x16x32_bf16 v[232:235], v[32:35], v[16:19], v[232:235]
    s_cselect_b32 s57, 1073741824, s58
    v_mfma_f32_16x16x32_bf16 v[236:239], v[32:35], v[20:23], v[236:239]
    buffer_store_dwordx4 v[160:163], v1, s[28:31], s57 offen offset:0 sc1
    v_mfma_f32_16x16x32_bf16 v[240:243], v[36:39], v[8:11], v[240:243]
    buffer_store_dwordx4 v[164:167], v1, s[28:31], s57 offen offset:1024 sc1
    v_mfma_f32_16x16x32_bf16 v[244:247], v[36:39], v[12:15], v[244:247]
    s_add_u32 s58, s58, 8192
    v_mfma_f32_16x16x32_bf16 v[248:251], v[36:39], v[16:19], v[248:251]
    s_add_u32 s57, s49, 20
    v_mfma_f32_16x16x32_bf16 v[252:255], v[36:39], v[20:23], v[252:255]
    s_cmp_lt_u32 s57, 5
    s_waitcnt lgkmcnt(2)
    v_mfma_f32_16x16x32_bf16 v[224:227], v[40:43], v[80:83], v[224:227]
    s_cselect_b32 s57, 1073741824, s58
    buffer_store_dwordx4 v[176:179], v1, s[28:31], s57 offen offset:0 sc1
    v_mfma_f32_16x16x32_bf16 v[228:231], v[40:43], v[84:87], v[228:231]
    buffer_store_dwordx4 v[180:183], v1, s[28:31], s57 offen offset:1024 sc1
    v_mfma_f32_16x16x32_bf16 v[232:235], v[40:43], v[88:91], v[232:235]
    s_add_u32 s58, s58, 8192
    v_mfma_f32_16x16x32_bf16 v[236:239], v[40:43], v[92:95], v[236:239]
    s_add_u32 s57, s49, 24
    s_waitcnt lgkmcnt(0)
    v_mfma_f32_16x16x32_bf16 v[240:243], v[44:47], v[80:83], v[240:243]
    s_cmp_lt_u32 s57, 5
    v_mfma_f32_16x16x32_bf16 v[244:247], v[44:47], v[84:87], v[244:247]
    s_cselect_b32 s57, 1073741824, s58
    v_mfma_f32_16x16x32_bf16 v[248:251], v[44:47], v[88:91], v[248:251]
    buffer_store_dwordx4 v[192:195], v1, s[28:31], s57 offen offset:0 sc1
    v_mfma_f32_16x16x32_bf16 v[252:255], v[44:47], v[92:95], v[252:255]
    buffer_store_dwordx4 v[196:199], v1, s[28:31], s57 offen offset:1024 sc1
    s_add_u32 s58, s58, 8192
    s_add_u32 s57, s49, 28
    s_cmp_lt_u32 s57, 5
    s_cselect_b32 s57, 1073741824, s58
    buffer_store_dwordx4 v[208:211], v1, s[28:31], s57 offen offset:0 sc1
    buffer_store_dwordx4 v[212:215], v1, s[28:31], s57 offen offset:1024 sc1
    s_add_u32 s58, s58, 8192
    v_cvt_pk_bf16_f32 v224, v224, v225
    v_cvt_pk_bf16_f32 v225, v226, v227
    v_cvt_pk_bf16_f32 v226, v228, v229
    v_cvt_pk_bf16_f32 v227, v230, v231
    v_cvt_pk_bf16_f32 v228, v232, v233
    v_cvt_pk_bf16_f32 v229, v234, v235
    v_cvt_pk_bf16_f32 v230, v236, v237
    v_cvt_pk_bf16_f32 v231, v238, v239
    v_permlane16_swap_b32 v224, v226
    v_permlane16_swap_b32 v225, v227
    v_permlane16_swap_b32 v228, v230
    v_permlane16_swap_b32 v229, v231
    s_add_u32 s57, s49, 32
    s_cmp_lt_u32 s57, 5
    s_cselect_b32 s57, 1073741824, s58
    buffer_store_dwordx4 v[224:227], v1, s[28:31], s57 offen offset:0 sc1
    buffer_store_dwordx4 v[228:231], v1, s[28:31], s57 offen offset:1024 sc1
    s_add_u32 s58, s58, 8192
    v_cvt_pk_bf16_f32 v240, v240, v241
    v_cvt_pk_bf16_f32 v241, v242, v243
    v_cvt_pk_bf16_f32 v242, v244, v245
    v_cvt_pk_bf16_f32 v243, v246, v247
    v_cvt_pk_bf16_f32 v244, v248, v249
    v_cvt_pk_bf16_f32 v245, v250, v251
    v_cvt_pk_bf16_f32 v246, v252, v253
    v_cvt_pk_bf16_f32 v247, v254, v255
    v_permlane16_swap_b32 v240, v242
    v_permlane16_swap_b32 v241, v243
    v_permlane16_swap_b32 v244, v246
    v_permlane16_swap_b32 v245, v247
    s_add_u32 s57, s49, 36
    s_cmp_lt_u32 s57, 5
    s_cselect_b32 s57, 1073741824, s58
    buffer_store_dwordx4 v[240:243], v1, s[28:31], s57 offen offset:0 sc1
    buffer_store_dwordx4 v[244:247], v1, s[28:31], s57 offen offset:1024 sc1
    s_add_u32 s58, s58, 8192
    s_mul_i32 s57, s6, 10240
    s_add_u32 s57, s57, 49152
    v_add_u32 v2, s57, v1
    s_add_u32 s57, s49, 0
    s_cmp_lt_u32 s57, 5
    s_cbranch_scc0 L_keep0
    s_lshl_b32 s57, s57, 11
    v_add_u32 v3, s57, v2
    ds_write_b128 v3, v[96:99] offset:0
    ds_write_b128 v3, v[100:103] offset:1024
    s_waitcnt lgkmcnt(0)
L_keep0:
    s_add_u32 s57, s49, 4
    s_cmp_lt_u32 s57, 5
    s_cbranch_scc0 L_keep1
    s_lshl_b32 s57, s57, 11
    v_add_u32 v3, s57, v2
    ds_write_b128 v3, v[112:115] offset:0
    ds_write_b128 v3, v[116:119] offset:1024
    s_waitcnt lgkmcnt(0)
L_keep1:
    s_add_u32 s57, s49, 8
    s_cmp_lt_u32 s57, 5
    s_cbranch_scc0 L_keep2
    s_lshl_b32 s57, s57, 11
    v_add_u32 v3, s57, v2
    ds_write_b128 v3, v[128:131] offset:0
    ds_write_b128 v3, v[132:135] offset:1024
    s_waitcnt lgkmcnt(0)
L_keep2:
    s_add_u32 s57, s49, 12
    s_cmp_lt_u32 s57, 5
    s_cbranch_scc0 L_keep3
    s_lshl_b32 s57, s57, 11
    v_add_u32 v3, s57, v2
    ds_write_b128 v3, v[144:147] offset:0
    ds_write_b128 v3, v[148:151] offset:1024
    s_waitcnt lgkmcnt(0)
L_keep3:
    s_add_u32 s57, s49, 16
    s_cmp_lt_u32 s57, 5
    s_cbranch_scc0 L_keep4
    s_lshl_b32 s57, s57, 11
    v_add_u32 v3, s57, v2
    ds_write_b128 v3, v[160:163] offset:0
    ds_write_b128 v3, v[164:167] offset:1024
    s_waitcnt lgkmcnt(0)
L_keep4:
    s_add_u32 s57, s49, 20
    s_cmp_lt_u32 s57, 5
    s_cbranch_scc0 L_keep5
    s_lshl_b32 s57, s57, 11
    v_add_u32 v3, s57, v2
    ds_write_b128 v3, v[176:179] offset:0
    ds_write_b128 v3, v[180:183] offset:1024
    s_waitcnt lgkmcnt(0)
L_keep5:
    s_add_u32 s57, s49, 24
    s_cmp_lt_u32 s57, 5
    s_cbranch_scc0 L_keep6
    s_lshl_b32 s57, s57, 11
    v_add_u32 v3, s57, v2
    ds_write_b128 v3, v[192:195] offset:0
    ds_write_b128 v3, v[196:199] offset:1024
    s_waitcnt lgkmcnt(0)
L_keep6:
    s_add_u32 s57, s49, 28
    s_cmp_lt_u32 s57, 5
    s_cbranch_scc0 L_keep7
    s_lshl_b32 s57, s57, 11
    v_add_u32 v3, s57, v2
    ds_write_b128 v3, v[208:211] offset:0
    ds_write_b128 v3, v[212:215] offset:1024
    s_waitcnt lgkmcnt(0)
L_keep7:
    s_add_u32 s57, s49, 32
    s_cmp_lt_u32 s57, 5
    s_cbranch_scc0 L_keep8
    s_lshl_b32 s57, s57, 11
    v_add_u32 v3, s57, v2
    ds_write_b128 v3, v[224:227] offset:0
    ds_write_b128 v3, v[228:231] offset:1024
    s_waitcnt lgkmcnt(0)
L_keep8:
    s_add_u32 s57, s49, 36
    s_cmp_lt_u32 s57, 5
    s_cbranch_scc0 L_keep9
    s_lshl_b32 s57, s57, 11
    v_add_u32 v3, s57, v2
    ds_write_b128 v3, v[240:243] offset:0
    ds_write_b128 v3, v[244:247] offset:1024
    s_waitcnt lgkmcnt(0)
L_keep9:
    s_waitcnt vmcnt(0)
    s_branch L_red
L_end:
    s_endpgm
.section .rodata,"a"
.p2align 6
.amdhsa_kernel concat_heads__gqa_block_cached__gqa_block_cached__near_ridge_kernel
  .amdhsa_next_free_vgpr 256
  .amdhsa_next_free_sgpr 102
  .amdhsa_accum_offset 256
  .amdhsa_group_segment_fixed_size 0
  .amdhsa_kernarg_size 104
  .amdhsa_user_sgpr_count 2
  .amdhsa_user_sgpr_kernarg_segment_ptr 1
  .amdhsa_system_sgpr_workgroup_id_x 1
.end_amdhsa_kernel
```
